```python
import torch

def _softmax(x, axis=-1):
    return torch.softmax(x, dim=axis)
def _gelu(x):
    return torch.nn.functional.gelu(x, approximate="tanh")
def _silu(x):
    return torch.nn.functional.silu(x)
def _sigmoid(x):
    return torch.sigmoid(x)
def _layernorm(x, axis=-1, eps=1e-5):
    m = x.mean(dim=axis, keepdim=True)
    v = x.var(dim=axis, keepdim=True, unbiased=False)
    return (x - m) / torch.sqrt(v + eps)
def _scatter_add(tgt, idx, src, axis=0):
    return tgt.clone().index_add_(axis, idx, src)
def _segment_sum(src, seg, n):
    out = torch.zeros((n,) + src.shape[1:], dtype=src.dtype)
    return out.index_add_(0, seg, src)
def _pad(x, pw):
    flat = tuple(v for pair in reversed(pw) for v in pair)
    return torch.nn.functional.pad(x, flat)

kernel_name = 'standalone__controlnet__diffusion'

def setup_inputs():

    _w = (lambda a: (lambda t: t.to(torch.bfloat16) if t.is_floating_point() else t)(torch.as_tensor(a)))
    B, HW, C = 2, 64, 512
    sc = C ** -0.5
    return {
        "x_frozen": _w((lambda *s: torch.randn(*s, dtype=torch.bfloat16) * 0.1)(B, HW, HW, C)),
        "x": _w((lambda *s: torch.randn(*s, dtype=torch.bfloat16) * 0.2)(B, HW, HW, C)),
        "c": _w((lambda *s: torch.randn(*s, dtype=torch.bfloat16) * 0.8)(B, HW, HW, C)),
        "w_z1": _w((lambda *s: torch.randn(*s, dtype=torch.bfloat16) * 0.8)(C, C) * sc),
        "w_z2": _w((lambda *s: torch.randn(*s, dtype=torch.bfloat16) * 0.2)(C, C) * sc),
        "w_conv": _w((lambda *s: torch.randn(*s, dtype=torch.bfloat16) * 0.2)(3, 3, C, C) * sc / 3.0),
    }

def reference(x_frozen, x, c, w_z1, w_z2, w_conv):
    B, H, W, C = x.shape
    h_in = x + torch.einsum("bhwc,cd->bhwd", c, w_z1)
    h = _silu(_layernorm(h_in, axis=-1))
    hp = _pad(h, ((0, 0), (1, 1), (1, 1), (0, 0)))
    acc = h * 0.0
    for di in range(3):
        for dj in range(3):
            acc = acc + torch.einsum("bhwc,cd->bhwd", hp[:, di:di + H, dj:dj + W, :], w_conv[di, dj])
    h = h_in + acc
    return x_frozen + torch.einsum("bhwc,cd->bhwd", h, w_z2)
```

```asm
; @launch kernel=cn_prep_kernel grid=(256,1,1) block=(512,1,1) lds=139392
; @launch kernel=cn_conv_kernel grid=(256,1,1) block=(256,1,1) lds=131072
.amdgcn_target "amdgcn-amd-amdhsa--gfx950"
.text
.globl cn_prep_kernel
.p2align 8
.type cn_prep_kernel,@function
cn_prep_kernel:
L1_begin:
    s_cmp_ge_u32 s2, 256
    s_cbranch_scc1 L1_end
    s_load_dwordx4 s[4:7], s[0:1], 16
    s_load_dwordx4 s[64:67], s[0:1], 32
    s_load_dwordx2 s[68:69], s[0:1], 8
    s_load_dwordx2 s[98:99], s[0:1], 64
    v_lshrrev_b32 v13, 6, v0
    v_and_b32 v10, 63, v0
    v_lshrrev_b32 v11, 4, v10
    v_readfirstlane_b32 s63, v13
    v_and_b32 v12, 15, v10
    s_and_b32 s54, s2, 7
    s_lshr_b32 s55, s2, 3
    s_lshr_b32 s61, s55, 2
    s_lshl_b32 s62, s54, 3
    s_add_u32 s62, s62, s61
    s_and_b32 s57, s55, 3
    s_and_b32 s3, s63, 3
    s_lshr_b32 s43, s3, 1
    s_lshl_b32 s56, s62, 1
    s_add_u32 s56, s56, s43
    s_lshl_b32 s42, s3, 10
    s_cmp_ge_u32 s63, 4
    s_cbranch_scc0 L1_rows
    s_lshl_b32 s63, s57, 1
    s_add_u32 s61, s61, s63
    s_and_b32 s61, s61, 7
    s_lshl_b32 s36, s61, 16
    s_lshl_b32 s37, s61, 7
    s_lshl_b32 s41, s3, 12
    v_and_b32 v13, 2, v11
    v_lshlrev_b32 v13, 2, v13
    v_and_b32 v14, 1, v11
    v_or_b32 v13, v13, v14
    v_xor_b32 v13, v13, v12
    v_lshlrev_b32 v13, 4, v13
    v_lshl_add_u32 v13, v11, 10, v13
    s_lshl_b32 s63, s57, 8
    s_lshl_b32 s43, s3, 14
    s_add_u32 s63, s63, s43
    v_add_u32 v1, s63, v13
    v_lshrrev_b32 v14, 3, v10
    v_and_b32 v15, 7, v10
    v_xor_b32 v13, v15, v14
    v_lshlrev_b32 v13, 4, v13
    v_lshl_add_u32 v25, v14, 11, v13
    v_lshl_add_u32 v26, v14, 10, v13
    s_lshl_b32 s63, s56, 16
    s_and_b32 s43, s3, 1
    s_lshl_b32 s43, s43, 15
    s_add_u32 s43, s43, s63
    v_add_u32 v2, s43, v25
    v_add_u32 v3, 0x4000, v2
    s_waitcnt lgkmcnt(0)
    s_mov_b32 s12, s6
    s_and_b32 s13, s7, 0xffff
    s_mov_b32 s14, 0x80000
    s_mov_b32 s15, 0x00020000
    s_mov_b32 s8, s4
    s_and_b32 s9, s5, 0xffff
    s_mov_b32 s10, 0x800000
    s_mov_b32 s11, 0x00020000
    s_add_u32 m0, s41, 16384
    s_add_u32 s40, s37, 0
    buffer_load_dwordx4 v2, s[8:11], s40 offen  lds
    s_add_u32 m0, s41, 0
    s_add_u32 s40, s36, 0
    buffer_load_dwordx4 v1, s[12:15], s40 offen  lds
    s_add_u32 m0, s41, 17408
    s_add_u32 s40, s37, 0
    buffer_load_dwordx4 v3, s[8:11], s40 offen  lds
    s_add_u32 m0, s41, 1024
    s_add_u32 s40, s36, 4096
    buffer_load_dwordx4 v1, s[12:15], s40 offen  lds
    s_add_u32 m0, s41, 18432
    s_add_u32 s40, s37, 1024
    buffer_load_dwordx4 v2, s[8:11], s40 offen  lds
    s_add_u32 m0, s41, 2048
    s_add_u32 s40, s36, 8192
    buffer_load_dwordx4 v1, s[12:15], s40 offen  lds
    s_add_u32 m0, s41, 19456
    s_add_u32 s40, s37, 1024
    buffer_load_dwordx4 v3, s[8:11], s40 offen  lds
    s_add_u32 s37, s37, 128
    s_and_b32 s37, s37, 0x3ff
    s_add_u32 m0, s41, 3072
    s_add_u32 s40, s36, 12288
    buffer_load_dwordx4 v1, s[12:15], s40 offen  lds
    s_add_u32 s36, s36, 0x10000
    s_and_b32 s36, s36, 0x7ffff
    s_mov_b32 s16, s68
    s_and_b32 s17, s69, 0xffff
    s_mov_b32 s18, 0x800000
    s_mov_b32 s19, 0x00020000
    s_mov_b32 s24, s66
    s_and_b32 s25, s67, 0xffff
    s_mov_b32 s26, 0x480000
    s_mov_b32 s27, 0x00020000
    s_mov_b32 s28, s64
    s_and_b32 s29, s65, 0xffff
    s_mov_b32 s30, 0x80000
    s_mov_b32 s31, 0x00020000
    s_mov_b32 s20, s98
    s_and_b32 s21, s99, 0xffff
    s_mov_b32 s22, 0x10000000
    s_mov_b32 s23, 0x00020000
    s_lshr_b32 s58, s55, 4
    s_lshl_b32 s63, s54, 1
    s_add_u32 s58, s58, s63
    s_lshr_b32 s59, s55, 3
    s_and_b32 s59, s59, 1
    s_and_b32 s60, s55, 7
    s_lshl_b32 s63, s56, 16
    s_lshl_b32 s95, s57, 8
    s_add_u32 s63, s63, s95
    s_and_b32 s95, s3, 1
    s_lshl_b32 s95, s95, 7
    s_add_u32 s63, s63, s95
    v_add_u32 v7, s63, v25
    v_add_u32 v8, 0x4000, v7
    s_lshl_b32 s43, s3, 13
    s_add_u32 s43, s43, 98304
    s_lshr_b32 s63, s3, 1
    s_lshl_b32 s63, s63, 19
    s_lshl_b32 s95, s58, 15
    s_add_u32 s63, s63, s95
    s_lshl_b32 s95, s59, 14
    s_add_u32 s63, s63, s95
    s_and_b32 s95, s3, 1
    s_lshl_b32 s95, s95, 13
    s_add_u32 s63, s63, s95
    v_add_u32 v4, s63, v26
    s_cmp_lt_u32 s3, 2
    s_cselect_b32 s63, 0, 0x80000000
    v_or_b32 v5, s63, v4
    s_cselect_b64 vcc, -1, 0
    s_lshr_b32 s63, s55, 3
    s_lshl_b32 s63, s63, 1
    s_add_u32 s63, s63, s60
    s_and_b32 s63, s63, 7
    s_lshl_b32 s38, s63, 7
    s_lshl_b32 s39, s63, 16
    v_lshrrev_b32 v13, 3, v10
    v_lshrrev_b32 v14, 1, v13
    v_and_b32 v14, 1, v14
    v_lshlrev_b32 v14, 2, v14
    v_and_b32 v15, 7, v10
    v_xor_b32 v14, v14, v15
    v_lshlrev_b32 v14, 4, v14
    v_lshl_add_u32 v14, v13, 10, v14
    s_lshl_b32 s63, s3, 13
    s_lshl_b32 s95, s60, 7
    s_add_u32 s63, s63, s95
    v_add_u32 v6, s63, v14
    v_and_b32 v13, 7, v12
    v_xor_b32 v14, v11, v13
    v_lshlrev_b32 v14, 4, v14
    v_lshl_add_u32 v16, v12, 7, v14
    v_xor_b32 v17, 64, v16
    v_add_u32 v18, 0x10000, v16
    v_add_u32 v19, 0x10000, v17
    v_lshrrev_b32 v13, 2, v12
    v_lshl_add_u32 v15, v11, 3, v13
    v_lshrrev_b32 v13, 1, v13
    s_lshr_b32 s63, s3, 1
    v_xor_b32 v13, s63, v13
    v_lshlrev_b32 v13, 6, v13
    v_and_b32 v14, 3, v12
    v_lshl_add_u32 v13, v14, 4, v13
    v_lshl_add_u32 v13, v15, 7, v13
    s_and_b32 s63, s3, 1
    s_lshl_b32 s63, s63, 3
    s_add_u32 s63, s63, 20480
    v_add_u32 v20, s63, v13
    v_add_u32 v21, 0x10000, v20
    v_add_u32 v22, 110592, v20
    v_lshlrev_b32 v23, 4, v10
    s_mul_i32 s63, s59, 3
    s_add_u32 s95, s59, 1
    s_cmp_lt_u32 s58, 8
    s_cselect_b32 s63, s63, s95
    s_lshl_b32 s95, s60, 2
    s_add_u32 s63, s63, s95
    s_mul_i32 s63, s63, 229376
    s_and_b32 s95, s58, 7
    s_lshl_b32 s95, s95, 12
    s_add_u32 s63, s63, s95
    s_add_u32 s63, s63, s42
    s_add_u32 s86, s63, 19070976
    s_mul_i32 s87, s60, 917504
    s_mul_i32 s95, s58, 12288
    s_add_u32 s87, s87, s95
    s_add_u32 s87, s87, s42
    s_lshl_b32 s95, s59, 9
    s_add_u32 s87, s87, s95
    s_add_u32 s87, s87, 18874368
    v_and_b32 v13, 1, v11
    v_mul_u32_u24 v13, 229376, v13
    v_lshrrev_b32 v15, 1, v11
    v_lshl_add_u32 v13, v15, 8, v13
    v_lshl_add_u32 v24, v12, 4, v13
    s_lshl_b32 s88, s60, 5
    s_lshl_b32 s95, s58, 1
    s_add_u32 s88, s88, s95
    s_add_u32 s88, s88, s59
    s_lshl_b32 s88, s88, 2
    s_add_u32 s88, s88, 27262976
    s_lshl_b32 s63, s3, 2
    s_add_u32 s63, s63, 135168
    v_mov_b32 v13, s63
    v_mov_b32 v14, 0
    ds_write_b32 v13, v14
    s_waitcnt lgkmcnt(0)
    s_waitcnt vmcnt(0)
    s_barrier
    s_add_u32 m0, s41, 49152
    s_add_u32 s40, s37, 0
    buffer_load_dwordx4 v2, s[8:11], s40 offen  lds
    s_add_u32 m0, s41, 32768
    s_add_u32 s40, s36, 0
    buffer_load_dwordx4 v1, s[12:15], s40 offen  lds
    s_add_u32 m0, s41, 50176
    s_add_u32 s40, s37, 0
    buffer_load_dwordx4 v3, s[8:11], s40 offen  lds
    s_add_u32 m0, s41, 33792
    s_add_u32 s40, s36, 4096
    buffer_load_dwordx4 v1, s[12:15], s40 offen  lds
    s_add_u32 m0, s41, 51200
    s_add_u32 s40, s37, 1024
    buffer_load_dwordx4 v2, s[8:11], s40 offen  lds
    s_add_u32 m0, s41, 34816
    s_add_u32 s40, s36, 8192
    buffer_load_dwordx4 v1, s[12:15], s40 offen  lds
    s_add_u32 m0, s41, 52224
    s_add_u32 s40, s37, 1024
    buffer_load_dwordx4 v3, s[8:11], s40 offen  lds
    s_add_u32 s37, s37, 128
    s_and_b32 s37, s37, 0x3ff
    s_add_u32 m0, s41, 35840
    s_add_u32 s40, s36, 12288
    buffer_load_dwordx4 v1, s[12:15], s40 offen  lds
    s_add_u32 s36, s36, 0x10000
    s_and_b32 s36, s36, 0x7ffff
    s_add_u32 m0, s41, 81920
    s_add_u32 s40, s37, 0
    buffer_load_dwordx4 v2, s[8:11], s40 offen  lds
    s_add_u32 m0, s41, 65536
    s_add_u32 s40, s36, 0
    buffer_load_dwordx4 v1, s[12:15], s40 offen  lds
    s_add_u32 m0, s41, 82944
    s_add_u32 s40, s37, 0
    buffer_load_dwordx4 v3, s[8:11], s40 offen  lds
    s_add_u32 m0, s41, 66560
    s_add_u32 s40, s36, 4096
    buffer_load_dwordx4 v1, s[12:15], s40 offen  lds
    s_add_u32 m0, s41, 83968
    s_add_u32 s40, s37, 1024
    buffer_load_dwordx4 v2, s[8:11], s40 offen  lds
    s_add_u32 m0, s41, 67584
    s_add_u32 s40, s36, 8192
    buffer_load_dwordx4 v1, s[12:15], s40 offen  lds
    s_add_u32 m0, s41, 84992
    s_add_u32 s40, s37, 1024
    buffer_load_dwordx4 v3, s[8:11], s40 offen  lds
    s_add_u32 s37, s37, 128
    s_and_b32 s37, s37, 0x3ff
    s_add_u32 m0, s41, 68608
    s_add_u32 s40, s36, 12288
    buffer_load_dwordx4 v1, s[12:15], s40 offen  lds
    s_add_u32 s36, s36, 0x10000
    s_and_b32 s36, s36, 0x7ffff
    s_waitcnt vmcnt(8)
    s_barrier
    s_add_u32 m0, s41, 16384
    s_add_u32 s40, s37, 0
    buffer_load_dwordx4 v2, s[8:11], s40 offen  lds
    s_add_u32 m0, s41, 0
    s_add_u32 s40, s36, 0
    buffer_load_dwordx4 v1, s[12:15], s40 offen  lds
    s_add_u32 m0, s41, 17408
    s_add_u32 s40, s37, 0
    buffer_load_dwordx4 v3, s[8:11], s40 offen  lds
    s_add_u32 m0, s41, 1024
    s_add_u32 s40, s36, 4096
    buffer_load_dwordx4 v1, s[12:15], s40 offen  lds
    s_add_u32 m0, s41, 18432
    s_add_u32 s40, s37, 1024
    buffer_load_dwordx4 v2, s[8:11], s40 offen  lds
    s_add_u32 m0, s41, 2048
    s_add_u32 s40, s36, 8192
    buffer_load_dwordx4 v1, s[12:15], s40 offen  lds
    s_add_u32 m0, s41, 19456
    s_add_u32 s40, s37, 1024
    buffer_load_dwordx4 v3, s[8:11], s40 offen  lds
    s_add_u32 s37, s37, 128
    s_and_b32 s37, s37, 0x3ff
    s_add_u32 m0, s41, 3072
    s_add_u32 s40, s36, 12288
    buffer_load_dwordx4 v1, s[12:15], s40 offen  lds
    s_add_u32 s36, s36, 0x10000
    s_and_b32 s36, s36, 0x7ffff
    s_add_u32 m0, s43, 0
    s_mov_b32 s40, 0
    buffer_load_dwordx4 v7, s[16:19], s40 offen nt lds
    s_add_u32 m0, s43, 1024
    s_mov_b32 s40, 0
    buffer_load_dwordx4 v8, s[16:19], s40 offen nt lds
    s_add_u32 m0, s43, 2048
    s_mov_b32 s40, 1024
    buffer_load_dwordx4 v7, s[16:19], s40 offen nt lds
    s_add_u32 m0, s43, 3072
    s_mov_b32 s40, 1024
    buffer_load_dwordx4 v8, s[16:19], s40 offen nt lds
    s_add_u32 m0, s43, 4096
    s_mov_b32 s40, 32768
    buffer_load_dwordx4 v7, s[16:19], s40 offen nt lds
    s_add_u32 m0, s43, 5120
    s_mov_b32 s40, 32768
    buffer_load_dwordx4 v8, s[16:19], s40 offen nt lds
    s_add_u32 m0, s43, 6144
    s_mov_b32 s40, 33792
    buffer_load_dwordx4 v7, s[16:19], s40 offen nt lds
    s_add_u32 m0, s43, 7168
    s_mov_b32 s40, 33792
    buffer_load_dwordx4 v8, s[16:19], s40 offen nt lds
    s_add_u32 m0, s42, 131072
    s_lshl_b32 s40, s58, 15
    buffer_load_dwordx4 v6, s[28:31], s40 offen lds
    s_waitcnt vmcnt(17)
    s_barrier
    s_add_u32 m0, s41, 49152
    s_add_u32 s40, s37, 0
    buffer_load_dwordx4 v2, s[8:11], s40 offen  lds
    s_add_u32 m0, s41, 32768
    s_add_u32 s40, s36, 0
    buffer_load_dwordx4 v1, s[12:15], s40 offen  lds
    s_add_u32 m0, s41, 50176
    s_add_u32 s40, s37, 0
    buffer_load_dwordx4 v3, s[8:11], s40 offen  lds
    s_add_u32 m0, s41, 33792
    s_add_u32 s40, s36, 4096
    buffer_load_dwordx4 v1, s[12:15], s40 offen  lds
    s_add_u32 m0, s41, 51200
    s_add_u32 s40, s37, 1024
    buffer_load_dwordx4 v2, s[8:11], s40 offen  lds
    s_add_u32 m0, s41, 34816
    s_add_u32 s40, s36, 8192
    buffer_load_dwordx4 v1, s[12:15], s40 offen  lds
    s_add_u32 m0, s41, 52224
    s_add_u32 s40, s37, 1024
    buffer_load_dwordx4 v3, s[8:11], s40 offen  lds
    s_add_u32 s37, s37, 128
    s_and_b32 s37, s37, 0x3ff
    s_add_u32 m0, s41, 35840
    s_add_u32 s40, s36, 12288
    buffer_load_dwordx4 v1, s[12:15], s40 offen  lds
    s_add_u32 s36, s36, 0x10000
    s_and_b32 s36, s36, 0x7ffff
    s_waitcnt vmcnt(17)
    s_barrier
    s_add_u32 m0, s41, 81920
    s_add_u32 s40, s37, 0
    buffer_load_dwordx4 v2, s[8:11], s40 offen  lds
    s_add_u32 m0, s41, 65536
    s_add_u32 s40, s36, 0
    buffer_load_dwordx4 v1, s[12:15], s40 offen  lds
    s_add_u32 m0, s41, 82944
    s_add_u32 s40, s37, 0
    buffer_load_dwordx4 v3, s[8:11], s40 offen  lds
    s_add_u32 m0, s41, 66560
    s_add_u32 s40, s36, 4096
    buffer_load_dwordx4 v1, s[12:15], s40 offen  lds
    s_add_u32 m0, s41, 83968
    s_add_u32 s40, s37, 1024
    buffer_load_dwordx4 v2, s[8:11], s40 offen  lds
    s_add_u32 m0, s41, 67584
    s_add_u32 s40, s36, 8192
    buffer_load_dwordx4 v1, s[12:15], s40 offen  lds
    s_add_u32 m0, s41, 84992
    s_add_u32 s40, s37, 1024
    buffer_load_dwordx4 v3, s[8:11], s40 offen  lds
    s_add_u32 s37, s37, 128
    s_and_b32 s37, s37, 0x3ff
    s_add_u32 m0, s41, 68608
    s_add_u32 s40, s36, 12288
    buffer_load_dwordx4 v1, s[12:15], s40 offen  lds
    s_add_u32 s36, s36, 0x10000
    s_and_b32 s36, s36, 0x7ffff
    s_waitcnt vmcnt(8)
    s_barrier
    s_add_u32 m0, s41, 16384
    s_add_u32 s40, s37, 0
    buffer_load_dwordx4 v2, s[8:11], s40 offen  lds
    s_add_u32 m0, s41, 0
    s_add_u32 s40, s36, 0
    buffer_load_dwordx4 v1, s[12:15], s40 offen  lds
    s_add_u32 m0, s41, 17408
    s_add_u32 s40, s37, 0
    buffer_load_dwordx4 v3, s[8:11], s40 offen  lds
    s_add_u32 m0, s41, 1024
    s_add_u32 s40, s36, 4096
    buffer_load_dwordx4 v1, s[12:15], s40 offen  lds
    s_add_u32 m0, s41, 18432
    s_add_u32 s40, s37, 1024
    buffer_load_dwordx4 v2, s[8:11], s40 offen  lds
    s_add_u32 m0, s41, 2048
    s_add_u32 s40, s36, 8192
    buffer_load_dwordx4 v1, s[12:15], s40 offen  lds
    s_add_u32 m0, s41, 19456
    s_add_u32 s40, s37, 1024
    buffer_load_dwordx4 v3, s[8:11], s40 offen  lds
    s_add_u32 s37, s37, 128
    s_and_b32 s37, s37, 0x3ff
    s_add_u32 m0, s41, 3072
    s_add_u32 s40, s36, 12288
    buffer_load_dwordx4 v1, s[12:15], s40 offen  lds
    s_add_u32 s36, s36, 0x10000
    s_and_b32 s36, s36, 0x7ffff
    s_waitcnt vmcnt(8)
    s_barrier
    s_add_u32 m0, s41, 49152
    s_add_u32 s40, s37, 0
    buffer_load_dwordx4 v2, s[8:11], s40 offen  lds
    s_add_u32 m0, s41, 32768
    s_add_u32 s40, s36, 0
    buffer_load_dwordx4 v1, s[12:15], s40 offen  lds
    s_add_u32 m0, s41, 50176
    s_add_u32 s40, s37, 0
    buffer_load_dwordx4 v3, s[8:11], s40 offen  lds
    s_add_u32 m0, s41, 33792
    s_add_u32 s40, s36, 4096
    buffer_load_dwordx4 v1, s[12:15], s40 offen  lds
    s_add_u32 m0, s41, 51200
    s_add_u32 s40, s37, 1024
    buffer_load_dwordx4 v2, s[8:11], s40 offen  lds
    s_add_u32 m0, s41, 34816
    s_add_u32 s40, s36, 8192
    buffer_load_dwordx4 v1, s[12:15], s40 offen  lds
    s_add_u32 m0, s41, 52224
    s_add_u32 s40, s37, 1024
    buffer_load_dwordx4 v3, s[8:11], s40 offen  lds
    s_add_u32 s37, s37, 128
    s_and_b32 s37, s37, 0x3ff
    s_add_u32 m0, s41, 35840
    s_add_u32 s40, s36, 12288
    buffer_load_dwordx4 v1, s[12:15], s40 offen  lds
    s_add_u32 s36, s36, 0x10000
    s_and_b32 s36, s36, 0x7ffff
    s_waitcnt vmcnt(8)
    s_barrier
    s_add_u32 m0, s42, 65536
    s_add_u32 s40, s38, 0
    buffer_load_dwordx4 v4, s[24:27], s40 offen  lds
    s_add_u32 m0, s42, 69632
    s_add_u32 s40, s38, 1048576
    buffer_load_dwordx4 v4, s[24:27], s40 offen  lds
    s_add_u32 m0, s42, 73728
    s_add_u32 s40, s38, 2097152
    buffer_load_dwordx4 v4, s[24:27], s40 offen  lds
    s_add_u32 m0, s42, 77824
    s_add_u32 s40, s38, 3145728
    buffer_load_dwordx4 v4, s[24:27], s40 offen  lds
    s_add_u32 m0, s42, 81920
    s_add_u32 s40, s38, 4194304
    buffer_load_dwordx4 v5, s[24:27], s40 offen  lds
    s_add_u32 s38, s38, 128
    s_and_b32 s38, s38, 0x3ff
    s_add_u32 m0, s42, 86016
    s_add_u32 s40, s39, 0
    buffer_load_dwordx4 v6, s[28:31], s40 offen lds
    s_add_u32 m0, s42, 90112
    s_add_u32 s40, s39, 32768
    buffer_load_dwordx4 v6, s[28:31], s40 offen lds
    s_add_u32 s39, s39, 0x10000
    s_and_b32 s39, s39, 0x7ffff
    ds_read_b64_tr_b16 v[40:41], v22 offset:0
    ds_read_b64_tr_b16 v[42:43], v22 offset:512
    s_waitcnt lgkmcnt(0)
    buffer_store_dwordx4 v[40:43], v23, s[20:23], s86 offen
    s_waitcnt vmcnt(8)
    s_barrier
    s_add_u32 m0, s42, 0
    s_add_u32 s40, s38, 0
    buffer_load_dwordx4 v4, s[24:27], s40 offen  lds
    s_add_u32 m0, s42, 4096
    s_add_u32 s40, s38, 1048576
    buffer_load_dwordx4 v4, s[24:27], s40 offen  lds
    s_add_u32 m0, s42, 8192
    s_add_u32 s40, s38, 2097152
    buffer_load_dwordx4 v4, s[24:27], s40 offen  lds
    s_add_u32 m0, s42, 12288
    s_add_u32 s40, s38, 3145728
    buffer_load_dwordx4 v4, s[24:27], s40 offen  lds
    s_add_u32 m0, s42, 16384
    s_add_u32 s40, s38, 4194304
    buffer_load_dwordx4 v5, s[24:27], s40 offen  lds
    s_add_u32 s38, s38, 128
    s_and_b32 s38, s38, 0x3ff
    s_add_u32 m0, s42, 20480
    s_add_u32 s40, s39, 0
    buffer_load_dwordx4 v6, s[28:31], s40 offen lds
    s_add_u32 m0, s42, 24576
    s_add_u32 s40, s39, 32768
    buffer_load_dwordx4 v6, s[28:31], s40 offen lds
    s_add_u32 s39, s39, 0x10000
    s_and_b32 s39, s39, 0x7ffff
    s_waitcnt vmcnt(8)
    s_barrier
    ds_read_b64_tr_b16 v[32:33], v21 offset:0
    ds_read_b64_tr_b16 v[34:35], v21 offset:512
    ds_read_b128 v[64:67], v18 offset:0
    ds_read_b128 v[68:71], v18 offset:2048
    ds_read_b128 v[72:75], v18 offset:4096
    ds_read_b128 v[76:79], v18 offset:6144
    ds_read_b128 v[80:83], v18 offset:8192
    ds_read_b128 v[84:87], v18 offset:10240
    ds_read_b128 v[88:91], v18 offset:12288
    ds_read_b128 v[92:95], v18 offset:14336
    ds_read_b128 v[96:99], v18 offset:16384
    s_waitcnt lgkmcnt(8)
    v_mfma_f32_16x16x32_bf16 v[136:139], v[64:67], v[32:35], 0
    s_add_u32 m0, s42, 32768
    s_add_u32 s40, s38, 0
    buffer_load_dwordx4 v4, s[24:27], s40 offen  lds
    ds_read_b64_tr_b16 v[36:37], v21 offset:4096
    ds_read_b64_tr_b16 v[38:39], v21 offset:4608
    ds_read_b128 v[100:103], v19 offset:0
    s_waitcnt lgkmcnt(10)
    v_mfma_f32_16x16x32_bf16 v[140:143], v[68:71], v[32:35], 0
    s_add_u32 m0, s42, 36864
    s_add_u32 s40, s38, 1048576
    buffer_load_dwordx4 v4, s[24:27], s40 offen  lds
    ds_read_b128 v[104:107], v19 offset:2048
    s_waitcnt lgkmcnt(10)
    v_mfma_f32_16x16x32_bf16 v[144:147], v[72:75], v[32:35], 0
    s_add_u32 m0, s42, 40960
    s_add_u32 s40, s38, 2097152
    buffer_load_dwordx4 v4, s[24:27], s40 offen  lds
    ds_read_b128 v[108:111], v19 offset:4096
    s_waitcnt lgkmcnt(10)
    v_mfma_f32_16x16x32_bf16 v[148:151], v[76:79], v[32:35], 0
    s_add_u32 m0, s42, 45056
    s_add_u32 s40, s38, 3145728
    buffer_load_dwordx4 v4, s[24:27], s40 offen  lds
    ds_read_b128 v[112:115], v19 offset:6144
    s_waitcnt lgkmcnt(10)
    v_mfma_f32_16x16x32_bf16 v[152:155], v[80:83], v[32:35], 0
    s_add_u32 m0, s42, 49152
    s_add_u32 s40, s38, 4194304
    buffer_load_dwordx4 v5, s[24:27], s40 offen  lds
    s_add_u32 s38, s38, 128
    s_and_b32 s38, s38, 0x3ff
    ds_read_b128 v[116:119], v19 offset:8192
    s_waitcnt lgkmcnt(10)
    v_mfma_f32_16x16x32_bf16 v[156:159], v[84:87], v[32:35], 0
    s_add_u32 m0, s42, 53248
    s_add_u32 s40, s39, 0
    buffer_load_dwordx4 v6, s[28:31], s40 offen lds
    ds_read_b128 v[120:123], v19 offset:10240
    s_waitcnt lgkmcnt(10)
    v_mfma_f32_16x16x32_bf16 v[160:163], v[88:91], v[32:35], 0
    s_add_u32 m0, s42, 57344
    s_add_u32 s40, s39, 32768
    buffer_load_dwordx4 v6, s[28:31], s40 offen lds
    s_add_u32 s39, s39, 0x10000
    s_and_b32 s39, s39, 0x7ffff
    ds_read_b128 v[124:127], v19 offset:12288
    s_waitcnt lgkmcnt(10)
    v_mfma_f32_16x16x32_bf16 v[164:167], v[92:95], v[32:35], 0
    ds_read_b128 v[128:131], v19 offset:14336
    s_waitcnt lgkmcnt(10)
    v_mfma_f32_16x16x32_bf16 v[168:171], v[96:99], v[32:35], 0
    ds_read_b128 v[132:135], v19 offset:16384
    s_waitcnt lgkmcnt(8)
    v_mfma_f32_16x16x32_bf16 v[136:139], v[100:103], v[36:39], v[136:139]
    s_waitcnt lgkmcnt(7)
    v_mfma_f32_16x16x32_bf16 v[140:143], v[104:107], v[36:39], v[140:143]
    s_waitcnt lgkmcnt(6)
    v_mfma_f32_16x16x32_bf16 v[144:147], v[108:111], v[36:39], v[144:147]
    s_waitcnt lgkmcnt(0)
    s_waitcnt vmcnt(7)
    s_barrier
    ds_read_b64_tr_b16 v[32:33], v20 offset:0
    ds_read_b64_tr_b16 v[34:35], v20 offset:512
    ds_read_b128 v[64:67], v16 offset:0
    ds_read_b128 v[68:71], v16 offset:2048
    v_mfma_f32_16x16x32_bf16 v[148:151], v[112:115], v[36:39], v[148:151]
    s_add_u32 m0, s42, 65536
    s_add_u32 s40, s38, 0
    buffer_load_dwordx4 v4, s[24:27], s40 offen  lds
    ds_read_b128 v[72:75], v16 offset:4096
    v_mfma_f32_16x16x32_bf16 v[152:155], v[116:119], v[36:39], v[152:155]
    s_add_u32 m0, s42, 69632
    s_add_u32 s40, s38, 1048576
    buffer_load_dwordx4 v4, s[24:27], s40 offen  lds
    ds_read_b128 v[76:79], v16 offset:6144
    v_mfma_f32_16x16x32_bf16 v[156:159], v[120:123], v[36:39], v[156:159]
    s_add_u32 m0, s42, 73728
    s_add_u32 s40, s38, 2097152
    buffer_load_dwordx4 v4, s[24:27], s40 offen  lds
    ds_read_b128 v[80:83], v16 offset:8192
    ds_read_b128 v[84:87], v16 offset:10240
    v_mfma_f32_16x16x32_bf16 v[160:163], v[124:127], v[36:39], v[160:163]
    s_add_u32 m0, s42, 77824
    s_add_u32 s40, s38, 3145728
    buffer_load_dwordx4 v4, s[24:27], s40 offen  lds
    ds_read_b128 v[88:91], v16 offset:12288
    v_mfma_f32_16x16x32_bf16 v[164:167], v[128:131], v[36:39], v[164:167]
    ds_read_b128 v[92:95], v16 offset:14336
    v_mfma_f32_16x16x32_bf16 v[168:171], v[132:135], v[36:39], v[168:171]
    s_add_u32 m0, s42, 81920
    s_add_u32 s40, s38, 4194304
    buffer_load_dwordx4 v5, s[24:27], s40 offen  lds
    s_add_u32 s38, s38, 128
    s_and_b32 s38, s38, 0x3ff
    ds_read_b128 v[96:99], v16 offset:16384
    s_waitcnt lgkmcnt(8)
    v_mfma_f32_16x16x32_bf16 v[136:139], v[64:67], v[32:35], v[136:139]
    s_add_u32 m0, s42, 86016
    s_add_u32 s40, s39, 0
    buffer_load_dwordx4 v6, s[28:31], s40 offen lds
    ds_read_b64_tr_b16 v[36:37], v20 offset:4096
    ds_read_b64_tr_b16 v[38:39], v20 offset:4608
    ds_read_b128 v[100:103], v17 offset:0
    s_waitcnt lgkmcnt(10)
    v_mfma_f32_16x16x32_bf16 v[140:143], v[68:71], v[32:35], v[140:143]
    s_add_u32 m0, s42, 90112
    s_add_u32 s40, s39, 32768
    buffer_load_dwordx4 v6, s[28:31], s40 offen lds
    s_add_u32 s39, s39, 0x10000
    s_and_b32 s39, s39, 0x7ffff
    ds_read_b128 v[104:107], v17 offset:2048
    s_waitcnt lgkmcnt(10)
    v_mfma_f32_16x16x32_bf16 v[144:147], v[72:75], v[32:35], v[144:147]
    ds_read_b128 v[108:111], v17 offset:4096
    s_waitcnt lgkmcnt(10)
    v_mfma_f32_16x16x32_bf16 v[148:151], v[76:79], v[32:35], v[148:151]
    ds_read_b128 v[112:115], v17 offset:6144
    s_waitcnt lgkmcnt(10)
    v_mfma_f32_16x16x32_bf16 v[152:155], v[80:83], v[32:35], v[152:155]
    ds_read_b128 v[116:119], v17 offset:8192
    s_waitcnt lgkmcnt(10)
    v_mfma_f32_16x16x32_bf16 v[156:159], v[84:87], v[32:35], v[156:159]
    ds_read_b128 v[120:123], v17 offset:10240
    s_waitcnt lgkmcnt(10)
    v_mfma_f32_16x16x32_bf16 v[160:163], v[88:91], v[32:35], v[160:163]
    ds_read_b128 v[124:127], v17 offset:12288
    s_waitcnt lgkmcnt(10)
    v_mfma_f32_16x16x32_bf16 v[164:167], v[92:95], v[32:35], v[164:167]
    ds_read_b128 v[128:131], v17 offset:14336
    s_waitcnt lgkmcnt(10)
    v_mfma_f32_16x16x32_bf16 v[168:171], v[96:99], v[32:35], v[168:171]
    ds_read_b128 v[132:135], v17 offset:16384
    s_waitcnt lgkmcnt(8)
    v_mfma_f32_16x16x32_bf16 v[136:139], v[100:103], v[36:39], v[136:139]
    s_waitcnt lgkmcnt(7)
    v_mfma_f32_16x16x32_bf16 v[140:143], v[104:107], v[36:39], v[140:143]
    s_waitcnt lgkmcnt(6)
    v_mfma_f32_16x16x32_bf16 v[144:147], v[108:111], v[36:39], v[144:147]
    s_waitcnt lgkmcnt(0)
    s_waitcnt vmcnt(7)
    s_barrier
    ds_read_b64_tr_b16 v[32:33], v20 offset:32768
    ds_read_b64_tr_b16 v[34:35], v20 offset:33280
    ds_read_b128 v[64:67], v16 offset:32768
    ds_read_b128 v[68:71], v16 offset:34816
    v_mfma_f32_16x16x32_bf16 v[148:151], v[112:115], v[36:39], v[148:151]
    s_add_u32 m0, s42, 0
    s_add_u32 s40, s38, 0
    buffer_load_dwordx4 v4, s[24:27], s40 offen  lds
    ds_read_b128 v[72:75], v16 offset:36864
    v_mfma_f32_16x16x32_bf16 v[152:155], v[116:119], v[36:39], v[152:155]
    s_add_u32 m0, s42, 4096
    s_add_u32 s40, s38, 1048576
    buffer_load_dwordx4 v4, s[24:27], s40 offen  lds
    ds_read_b128 v[76:79], v16 offset:38912
    v_mfma_f32_16x16x32_bf16 v[156:159], v[120:123], v[36:39], v[156:159]
    s_add_u32 m0, s42, 8192
    s_add_u32 s40, s38, 2097152
    buffer_load_dwordx4 v4, s[24:27], s40 offen  lds
    ds_read_b128 v[80:83], v16 offset:40960
    ds_read_b128 v[84:87], v16 offset:43008
    v_mfma_f32_16x16x32_bf16 v[160:163], v[124:127], v[36:39], v[160:163]
    s_add_u32 m0, s42, 12288
    s_add_u32 s40, s38, 3145728
    buffer_load_dwordx4 v4, s[24:27], s40 offen  lds
    ds_read_b128 v[88:91], v16 offset:45056
    v_mfma_f32_16x16x32_bf16 v[164:167], v[128:131], v[36:39], v[164:167]
    ds_read_b128 v[92:95], v16 offset:47104
    v_mfma_f32_16x16x32_bf16 v[168:171], v[132:135], v[36:39], v[168:171]
    s_add_u32 m0, s42, 16384
    s_add_u32 s40, s38, 4194304
    buffer_load_dwordx4 v5, s[24:27], s40 offen  lds
    s_add_u32 s38, s38, 128
    s_and_b32 s38, s38, 0x3ff
    ds_read_b128 v[96:99], v16 offset:49152
    s_waitcnt lgkmcnt(8)
    v_mfma_f32_16x16x32_bf16 v[136:139], v[64:67], v[32:35], v[136:139]
    s_add_u32 m0, s42, 20480
    s_add_u32 s40, s39, 0
    buffer_load_dwordx4 v6, s[28:31], s40 offen lds
    ds_read_b64_tr_b16 v[36:37], v20 offset:36864
    ds_read_b64_tr_b16 v[38:39], v20 offset:37376
    ds_read_b128 v[100:103], v17 offset:32768
    s_waitcnt lgkmcnt(10)
    v_mfma_f32_16x16x32_bf16 v[140:143], v[68:71], v[32:35], v[140:143]
    s_add_u32 m0, s42, 24576
    s_add_u32 s40, s39, 32768
    buffer_load_dwordx4 v6, s[28:31], s40 offen lds
    s_add_u32 s39, s39, 0x10000
    s_and_b32 s39, s39, 0x7ffff
    ds_read_b128 v[104:107], v17 offset:34816
    s_waitcnt lgkmcnt(10)
    v_mfma_f32_16x16x32_bf16 v[144:147], v[72:75], v[32:35], v[144:147]
    ds_read_b128 v[108:111], v17 offset:36864
    s_waitcnt lgkmcnt(10)
    v_mfma_f32_16x16x32_bf16 v[148:151], v[76:79], v[32:35], v[148:151]
    ds_read_b128 v[112:115], v17 offset:38912
    s_waitcnt lgkmcnt(10)
    v_mfma_f32_16x16x32_bf16 v[152:155], v[80:83], v[32:35], v[152:155]
    ds_read_b128 v[116:119], v17 offset:40960
    s_waitcnt lgkmcnt(10)
    v_mfma_f32_16x16x32_bf16 v[156:159], v[84:87], v[32:35], v[156:159]
    ds_read_b128 v[120:123], v17 offset:43008
    s_waitcnt lgkmcnt(10)
    v_mfma_f32_16x16x32_bf16 v[160:163], v[88:91], v[32:35], v[160:163]
    ds_read_b128 v[124:127], v17 offset:45056
    s_waitcnt lgkmcnt(10)
    v_mfma_f32_16x16x32_bf16 v[164:167], v[92:95], v[32:35], v[164:167]
    ds_read_b128 v[128:131], v17 offset:47104
    s_waitcnt lgkmcnt(10)
    v_mfma_f32_16x16x32_bf16 v[168:171], v[96:99], v[32:35], v[168:171]
    ds_read_b128 v[132:135], v17 offset:49152
    s_waitcnt lgkmcnt(8)
    v_mfma_f32_16x16x32_bf16 v[136:139], v[100:103], v[36:39], v[136:139]
    s_waitcnt lgkmcnt(7)
    v_mfma_f32_16x16x32_bf16 v[140:143], v[104:107], v[36:39], v[140:143]
    s_waitcnt lgkmcnt(6)
    v_mfma_f32_16x16x32_bf16 v[144:147], v[108:111], v[36:39], v[144:147]
    s_waitcnt lgkmcnt(0)
    s_waitcnt vmcnt(7)
    s_barrier
    ds_read_b64_tr_b16 v[32:33], v21 offset:0
    ds_read_b64_tr_b16 v[34:35], v21 offset:512
    ds_read_b128 v[64:67], v18 offset:0
    ds_read_b128 v[68:71], v18 offset:2048
    v_mfma_f32_16x16x32_bf16 v[148:151], v[112:115], v[36:39], v[148:151]
    s_add_u32 m0, s42, 32768
    s_add_u32 s40, s38, 0
    buffer_load_dwordx4 v4, s[24:27], s40 offen  lds
    ds_read_b128 v[72:75], v18 offset:4096
    v_mfma_f32_16x16x32_bf16 v[152:155], v[116:119], v[36:39], v[152:155]
    s_add_u32 m0, s42, 36864
    s_add_u32 s40, s38, 1048576
    buffer_load_dwordx4 v4, s[24:27], s40 offen  lds
    ds_read_b128 v[76:79], v18 offset:6144
    v_mfma_f32_16x16x32_bf16 v[156:159], v[120:123], v[36:39], v[156:159]
    s_add_u32 m0, s42, 40960
    s_add_u32 s40, s38, 2097152
    buffer_load_dwordx4 v4, s[24:27], s40 offen  lds
    ds_read_b128 v[80:83], v18 offset:8192
    ds_read_b128 v[84:87], v18 offset:10240
    v_mfma_f32_16x16x32_bf16 v[160:163], v[124:127], v[36:39], v[160:163]
    s_add_u32 m0, s42, 45056
    s_add_u32 s40, s38, 3145728
    buffer_load_dwordx4 v4, s[24:27], s40 offen  lds
    ds_read_b128 v[88:91], v18 offset:12288
    v_mfma_f32_16x16x32_bf16 v[164:167], v[128:131], v[36:39], v[164:167]
    ds_read_b128 v[92:95], v18 offset:14336
    v_mfma_f32_16x16x32_bf16 v[168:171], v[132:135], v[36:39], v[168:171]
    s_add_u32 m0, s42, 49152
    s_add_u32 s40, s38, 4194304
    buffer_load_dwordx4 v5, s[24:27], s40 offen  lds
    s_add_u32 s38, s38, 128
    s_and_b32 s38, s38, 0x3ff
    ds_read_b128 v[96:99], v18 offset:16384
    s_waitcnt lgkmcnt(8)
    v_mfma_f32_16x16x32_bf16 v[136:139], v[64:67], v[32:35], v[136:139]
    s_add_u32 m0, s42, 53248
    s_add_u32 s40, s39, 0
    buffer_load_dwordx4 v6, s[28:31], s40 offen lds
    ds_read_b64_tr_b16 v[36:37], v21 offset:4096
    ds_read_b64_tr_b16 v[38:39], v21 offset:4608
    ds_read_b128 v[100:103], v19 offset:0
    s_waitcnt lgkmcnt(10)
    v_mfma_f32_16x16x32_bf16 v[140:143], v[68:71], v[32:35], v[140:143]
    s_add_u32 m0, s42, 57344
    s_add_u32 s40, s39, 32768
    buffer_load_dwordx4 v6, s[28:31], s40 offen lds
    s_add_u32 s39, s39, 0x10000
    s_and_b32 s39, s39, 0x7ffff
    ds_read_b128 v[104:107], v19 offset:2048
    s_waitcnt lgkmcnt(10)
    v_mfma_f32_16x16x32_bf16 v[144:147], v[72:75], v[32:35], v[144:147]
    ds_read_b128 v[108:111], v19 offset:4096
    s_waitcnt lgkmcnt(10)
    v_mfma_f32_16x16x32_bf16 v[148:151], v[76:79], v[32:35], v[148:151]
    ds_read_b128 v[112:115], v19 offset:6144
    s_waitcnt lgkmcnt(10)
    v_mfma_f32_16x16x32_bf16 v[152:155], v[80:83], v[32:35], v[152:155]
    ds_read_b128 v[116:119], v19 offset:8192
    s_waitcnt lgkmcnt(10)
    v_mfma_f32_16x16x32_bf16 v[156:159], v[84:87], v[32:35], v[156:159]
    ds_read_b128 v[120:123], v19 offset:10240
    s_waitcnt lgkmcnt(10)
    v_mfma_f32_16x16x32_bf16 v[160:163], v[88:91], v[32:35], v[160:163]
    ds_read_b128 v[124:127], v19 offset:12288
    s_waitcnt lgkmcnt(10)
    v_mfma_f32_16x16x32_bf16 v[164:167], v[92:95], v[32:35], v[164:167]
    ds_read_b128 v[128:131], v19 offset:14336
    s_waitcnt lgkmcnt(10)
    v_mfma_f32_16x16x32_bf16 v[168:171], v[96:99], v[32:35], v[168:171]
    ds_read_b128 v[132:135], v19 offset:16384
    s_waitcnt lgkmcnt(8)
    v_mfma_f32_16x16x32_bf16 v[136:139], v[100:103], v[36:39], v[136:139]
    s_waitcnt lgkmcnt(7)
    v_mfma_f32_16x16x32_bf16 v[140:143], v[104:107], v[36:39], v[140:143]
    s_waitcnt lgkmcnt(6)
    v_mfma_f32_16x16x32_bf16 v[144:147], v[108:111], v[36:39], v[144:147]
    s_waitcnt lgkmcnt(0)
    s_waitcnt vmcnt(7)
    s_barrier
    ds_read_b64_tr_b16 v[32:33], v20 offset:0
    ds_read_b64_tr_b16 v[34:35], v20 offset:512
    ds_read_b128 v[64:67], v16 offset:0
    ds_read_b128 v[68:71], v16 offset:2048
    v_mfma_f32_16x16x32_bf16 v[148:151], v[112:115], v[36:39], v[148:151]
    s_add_u32 m0, s42, 65536
    s_add_u32 s40, s38, 0
    buffer_load_dwordx4 v4, s[24:27], s40 offen  lds
    ds_read_b128 v[72:75], v16 offset:4096
    v_mfma_f32_16x16x32_bf16 v[152:155], v[116:119], v[36:39], v[152:155]
    s_add_u32 m0, s42, 69632
    s_add_u32 s40, s38, 1048576
    buffer_load_dwordx4 v4, s[24:27], s40 offen  lds
    ds_read_b128 v[76:79], v16 offset:6144
    v_mfma_f32_16x16x32_bf16 v[156:159], v[120:123], v[36:39], v[156:159]
    s_add_u32 m0, s42, 73728
    s_add_u32 s40, s38, 2097152
    buffer_load_dwordx4 v4, s[24:27], s40 offen  lds
    ds_read_b128 v[80:83], v16 offset:8192
    ds_read_b128 v[84:87], v16 offset:10240
    v_mfma_f32_16x16x32_bf16 v[160:163], v[124:127], v[36:39], v[160:163]
    s_add_u32 m0, s42, 77824
    s_add_u32 s40, s38, 3145728
    buffer_load_dwordx4 v4, s[24:27], s40 offen  lds
    ds_read_b128 v[88:91], v16 offset:12288
    v_mfma_f32_16x16x32_bf16 v[164:167], v[128:131], v[36:39], v[164:167]
    ds_read_b128 v[92:95], v16 offset:14336
    v_mfma_f32_16x16x32_bf16 v[168:171], v[132:135], v[36:39], v[168:171]
    s_add_u32 m0, s42, 81920
    s_add_u32 s40, s38, 4194304
    buffer_load_dwordx4 v5, s[24:27], s40 offen  lds
    s_add_u32 s38, s38, 128
    s_and_b32 s38, s38, 0x3ff
    ds_read_b128 v[96:99], v16 offset:16384
    s_waitcnt lgkmcnt(8)
    v_mfma_f32_16x16x32_bf16 v[136:139], v[64:67], v[32:35], v[136:139]
    s_add_u32 m0, s42, 86016
    s_add_u32 s40, s39, 0
    buffer_load_dwordx4 v6, s[28:31], s40 offen lds
    ds_read_b64_tr_b16 v[36:37], v20 offset:4096
    ds_read_b64_tr_b16 v[38:39], v20 offset:4608
    ds_read_b128 v[100:103], v17 offset:0
    s_waitcnt lgkmcnt(10)
    v_mfma_f32_16x16x32_bf16 v[140:143], v[68:71], v[32:35], v[140:143]
    s_add_u32 m0, s42, 90112
    s_add_u32 s40, s39, 32768
    buffer_load_dwordx4 v6, s[28:31], s40 offen lds
    s_add_u32 s39, s39, 0x10000
    s_and_b32 s39, s39, 0x7ffff
    ds_read_b128 v[104:107], v17 offset:2048
    s_waitcnt lgkmcnt(10)
    v_mfma_f32_16x16x32_bf16 v[144:147], v[72:75], v[32:35], v[144:147]
    ds_read_b128 v[108:111], v17 offset:4096
    s_waitcnt lgkmcnt(10)
    v_mfma_f32_16x16x32_bf16 v[148:151], v[76:79], v[32:35], v[148:151]
    ds_read_b128 v[112:115], v17 offset:6144
    s_waitcnt lgkmcnt(10)
    v_mfma_f32_16x16x32_bf16 v[152:155], v[80:83], v[32:35], v[152:155]
    ds_read_b128 v[116:119], v17 offset:8192
    s_waitcnt lgkmcnt(10)
    v_mfma_f32_16x16x32_bf16 v[156:159], v[84:87], v[32:35], v[156:159]
    ds_read_b128 v[120:123], v17 offset:10240
    s_waitcnt lgkmcnt(10)
    v_mfma_f32_16x16x32_bf16 v[160:163], v[88:91], v[32:35], v[160:163]
    ds_read_b128 v[124:127], v17 offset:12288
    s_waitcnt lgkmcnt(10)
    v_mfma_f32_16x16x32_bf16 v[164:167], v[92:95], v[32:35], v[164:167]
    ds_read_b128 v[128:131], v17 offset:14336
    s_waitcnt lgkmcnt(10)
    v_mfma_f32_16x16x32_bf16 v[168:171], v[96:99], v[32:35], v[168:171]
    ds_read_b128 v[132:135], v17 offset:16384
    s_waitcnt lgkmcnt(8)
    v_mfma_f32_16x16x32_bf16 v[136:139], v[100:103], v[36:39], v[136:139]
    s_waitcnt lgkmcnt(7)
    v_mfma_f32_16x16x32_bf16 v[140:143], v[104:107], v[36:39], v[140:143]
    s_waitcnt lgkmcnt(6)
    v_mfma_f32_16x16x32_bf16 v[144:147], v[108:111], v[36:39], v[144:147]
    s_waitcnt lgkmcnt(0)
    s_waitcnt vmcnt(7)
    s_barrier
    ds_read_b64_tr_b16 v[32:33], v20 offset:32768
    ds_read_b64_tr_b16 v[34:35], v20 offset:33280
    ds_read_b128 v[64:67], v16 offset:32768
    ds_read_b128 v[68:71], v16 offset:34816
    v_mfma_f32_16x16x32_bf16 v[148:151], v[112:115], v[36:39], v[148:151]
    s_add_u32 m0, s42, 0
    s_add_u32 s40, s38, 0
    buffer_load_dwordx4 v4, s[24:27], s40 offen  lds
    ds_read_b128 v[72:75], v16 offset:36864
    v_mfma_f32_16x16x32_bf16 v[152:155], v[116:119], v[36:39], v[152:155]
    s_add_u32 m0, s42, 4096
    s_add_u32 s40, s38, 1048576
    buffer_load_dwordx4 v4, s[24:27], s40 offen  lds
    ds_read_b128 v[76:79], v16 offset:38912
    v_mfma_f32_16x16x32_bf16 v[156:159], v[120:123], v[36:39], v[156:159]
    s_add_u32 m0, s42, 8192
    s_add_u32 s40, s38, 2097152
    buffer_load_dwordx4 v4, s[24:27], s40 offen  lds
    ds_read_b128 v[80:83], v16 offset:40960
    ds_read_b128 v[84:87], v16 offset:43008
    v_mfma_f32_16x16x32_bf16 v[160:163], v[124:127], v[36:39], v[160:163]
    s_add_u32 m0, s42, 12288
    s_add_u32 s40, s38, 3145728
    buffer_load_dwordx4 v4, s[24:27], s40 offen  lds
    ds_read_b128 v[88:91], v16 offset:45056
    v_mfma_f32_16x16x32_bf16 v[164:167], v[128:131], v[36:39], v[164:167]
    ds_read_b128 v[92:95], v16 offset:47104
    v_mfma_f32_16x16x32_bf16 v[168:171], v[132:135], v[36:39], v[168:171]
    s_add_u32 m0, s42, 16384
    s_add_u32 s40, s38, 4194304
    buffer_load_dwordx4 v5, s[24:27], s40 offen  lds
    s_add_u32 s38, s38, 128
    s_and_b32 s38, s38, 0x3ff
    ds_read_b128 v[96:99], v16 offset:49152
    s_waitcnt lgkmcnt(8)
    v_mfma_f32_16x16x32_bf16 v[136:139], v[64:67], v[32:35], v[136:139]
    s_add_u32 m0, s42, 20480
    s_add_u32 s40, s39, 0
    buffer_load_dwordx4 v6, s[28:31], s40 offen lds
    ds_read_b64_tr_b16 v[36:37], v20 offset:36864
    ds_read_b64_tr_b16 v[38:39], v20 offset:37376
    ds_read_b128 v[100:103], v17 offset:32768
    s_waitcnt lgkmcnt(10)
    v_mfma_f32_16x16x32_bf16 v[140:143], v[68:71], v[32:35], v[140:143]
    s_add_u32 m0, s42, 24576
    s_add_u32 s40, s39, 32768
    buffer_load_dwordx4 v6, s[28:31], s40 offen lds
    s_add_u32 s39, s39, 0x10000
    s_and_b32 s39, s39, 0x7ffff
    ds_read_b128 v[104:107], v17 offset:34816
    s_waitcnt lgkmcnt(10)
    v_mfma_f32_16x16x32_bf16 v[144:147], v[72:75], v[32:35], v[144:147]
    ds_read_b128 v[108:111], v17 offset:36864
    s_waitcnt lgkmcnt(10)
    v_mfma_f32_16x16x32_bf16 v[148:151], v[76:79], v[32:35], v[148:151]
    ds_read_b128 v[112:115], v17 offset:38912
    s_waitcnt lgkmcnt(10)
    v_mfma_f32_16x16x32_bf16 v[152:155], v[80:83], v[32:35], v[152:155]
    ds_read_b128 v[116:119], v17 offset:40960
    s_waitcnt lgkmcnt(10)
    v_mfma_f32_16x16x32_bf16 v[156:159], v[84:87], v[32:35], v[156:159]
    ds_read_b128 v[120:123], v17 offset:43008
    s_waitcnt lgkmcnt(10)
    v_mfma_f32_16x16x32_bf16 v[160:163], v[88:91], v[32:35], v[160:163]
    ds_read_b128 v[124:127], v17 offset:45056
    s_waitcnt lgkmcnt(10)
    v_mfma_f32_16x16x32_bf16 v[164:167], v[92:95], v[32:35], v[164:167]
    ds_read_b128 v[128:131], v17 offset:47104
    s_waitcnt lgkmcnt(10)
    v_mfma_f32_16x16x32_bf16 v[168:171], v[96:99], v[32:35], v[168:171]
    ds_read_b128 v[132:135], v17 offset:49152
    s_waitcnt lgkmcnt(8)
    v_mfma_f32_16x16x32_bf16 v[136:139], v[100:103], v[36:39], v[136:139]
    s_waitcnt lgkmcnt(7)
    v_mfma_f32_16x16x32_bf16 v[140:143], v[104:107], v[36:39], v[140:143]
    s_waitcnt lgkmcnt(6)
    v_mfma_f32_16x16x32_bf16 v[144:147], v[108:111], v[36:39], v[144:147]
    s_waitcnt lgkmcnt(0)
    s_waitcnt vmcnt(7)
    s_barrier
    ds_read_b64_tr_b16 v[32:33], v21 offset:0
    ds_read_b64_tr_b16 v[34:35], v21 offset:512
    ds_read_b128 v[64:67], v18 offset:0
    ds_read_b128 v[68:71], v18 offset:2048
    v_mfma_f32_16x16x32_bf16 v[148:151], v[112:115], v[36:39], v[148:151]
    ds_read_b128 v[72:75], v18 offset:4096
    v_mfma_f32_16x16x32_bf16 v[152:155], v[116:119], v[36:39], v[152:155]
    ds_read_b128 v[76:79], v18 offset:6144
    v_mfma_f32_16x16x32_bf16 v[156:159], v[120:123], v[36:39], v[156:159]
    ds_read_b128 v[80:83], v18 offset:8192
    ds_read_b128 v[84:87], v18 offset:10240
    v_mfma_f32_16x16x32_bf16 v[160:163], v[124:127], v[36:39], v[160:163]
    ds_read_b128 v[88:91], v18 offset:12288
    v_mfma_f32_16x16x32_bf16 v[164:167], v[128:131], v[36:39], v[164:167]
    ds_read_b128 v[92:95], v18 offset:14336
    v_mfma_f32_16x16x32_bf16 v[168:171], v[132:135], v[36:39], v[168:171]
    ds_read_b128 v[96:99], v18 offset:16384
    s_waitcnt lgkmcnt(8)
    v_mfma_f32_16x16x32_bf16 v[136:139], v[64:67], v[32:35], v[136:139]
    ds_read_b64_tr_b16 v[36:37], v21 offset:4096
    ds_read_b64_tr_b16 v[38:39], v21 offset:4608
    ds_read_b128 v[100:103], v19 offset:0
    s_waitcnt lgkmcnt(10)
    v_mfma_f32_16x16x32_bf16 v[140:143], v[68:71], v[32:35], v[140:143]
    ds_read_b128 v[104:107], v19 offset:2048
    s_waitcnt lgkmcnt(10)
    v_mfma_f32_16x16x32_bf16 v[144:147], v[72:75], v[32:35], v[144:147]
    ds_read_b128 v[108:111], v19 offset:4096
    s_waitcnt lgkmcnt(10)
    v_mfma_f32_16x16x32_bf16 v[148:151], v[76:79], v[32:35], v[148:151]
    ds_read_b128 v[112:115], v19 offset:6144
    s_waitcnt lgkmcnt(10)
    v_mfma_f32_16x16x32_bf16 v[152:155], v[80:83], v[32:35], v[152:155]
    ds_read_b128 v[116:119], v19 offset:8192
    s_waitcnt lgkmcnt(10)
    v_mfma_f32_16x16x32_bf16 v[156:159], v[84:87], v[32:35], v[156:159]
    ds_read_b128 v[120:123], v19 offset:10240
    s_waitcnt lgkmcnt(10)
    v_mfma_f32_16x16x32_bf16 v[160:163], v[88:91], v[32:35], v[160:163]
    ds_read_b128 v[124:127], v19 offset:12288
    s_waitcnt lgkmcnt(10)
    v_mfma_f32_16x16x32_bf16 v[164:167], v[92:95], v[32:35], v[164:167]
    ds_read_b128 v[128:131], v19 offset:14336
    s_waitcnt lgkmcnt(10)
    v_mfma_f32_16x16x32_bf16 v[168:171], v[96:99], v[32:35], v[168:171]
    ds_read_b128 v[132:135], v19 offset:16384
    s_waitcnt lgkmcnt(8)
    v_mfma_f32_16x16x32_bf16 v[136:139], v[100:103], v[36:39], v[136:139]
    s_waitcnt lgkmcnt(7)
    v_mfma_f32_16x16x32_bf16 v[140:143], v[104:107], v[36:39], v[140:143]
    s_waitcnt lgkmcnt(6)
    v_mfma_f32_16x16x32_bf16 v[144:147], v[108:111], v[36:39], v[144:147]
    s_waitcnt lgkmcnt(0)
    s_waitcnt vmcnt(0)
    s_barrier
    ds_read_b64_tr_b16 v[32:33], v20 offset:0
    ds_read_b64_tr_b16 v[34:35], v20 offset:512
    ds_read_b128 v[64:67], v16 offset:0
    ds_read_b128 v[68:71], v16 offset:2048
    v_mfma_f32_16x16x32_bf16 v[148:151], v[112:115], v[36:39], v[148:151]
    ds_read_b128 v[72:75], v16 offset:4096
    v_mfma_f32_16x16x32_bf16 v[152:155], v[116:119], v[36:39], v[152:155]
    ds_read_b128 v[76:79], v16 offset:6144
    v_mfma_f32_16x16x32_bf16 v[156:159], v[120:123], v[36:39], v[156:159]
    ds_read_b128 v[80:83], v16 offset:8192
    ds_read_b128 v[84:87], v16 offset:10240
    v_mfma_f32_16x16x32_bf16 v[160:163], v[124:127], v[36:39], v[160:163]
    ds_read_b128 v[88:91], v16 offset:12288
    v_mfma_f32_16x16x32_bf16 v[164:167], v[128:131], v[36:39], v[164:167]
    ds_read_b128 v[92:95], v16 offset:14336
    v_mfma_f32_16x16x32_bf16 v[168:171], v[132:135], v[36:39], v[168:171]
    ds_read_b128 v[96:99], v16 offset:16384
    s_waitcnt lgkmcnt(8)
    v_mfma_f32_16x16x32_bf16 v[136:139], v[64:67], v[32:35], v[136:139]
    ds_read_b64_tr_b16 v[36:37], v20 offset:4096
    ds_read_b64_tr_b16 v[38:39], v20 offset:4608
    ds_read_b128 v[100:103], v17 offset:0
    s_waitcnt lgkmcnt(10)
    v_mfma_f32_16x16x32_bf16 v[140:143], v[68:71], v[32:35], v[140:143]
    ds_read_b128 v[104:107], v17 offset:2048
    s_waitcnt lgkmcnt(10)
    v_mfma_f32_16x16x32_bf16 v[144:147], v[72:75], v[32:35], v[144:147]
    ds_read_b128 v[108:111], v17 offset:4096
    s_waitcnt lgkmcnt(10)
    v_mfma_f32_16x16x32_bf16 v[148:151], v[76:79], v[32:35], v[148:151]
    ds_read_b128 v[112:115], v17 offset:6144
    s_waitcnt lgkmcnt(10)
    v_mfma_f32_16x16x32_bf16 v[152:155], v[80:83], v[32:35], v[152:155]
    ds_read_b128 v[116:119], v17 offset:8192
    s_waitcnt lgkmcnt(10)
    v_mfma_f32_16x16x32_bf16 v[156:159], v[84:87], v[32:35], v[156:159]
    ds_read_b128 v[120:123], v17 offset:10240
    s_waitcnt lgkmcnt(10)
    v_mfma_f32_16x16x32_bf16 v[160:163], v[88:91], v[32:35], v[160:163]
    ds_read_b128 v[124:127], v17 offset:12288
    s_waitcnt lgkmcnt(10)
    v_mfma_f32_16x16x32_bf16 v[164:167], v[92:95], v[32:35], v[164:167]
    ds_read_b128 v[128:131], v17 offset:14336
    s_waitcnt lgkmcnt(10)
    v_mfma_f32_16x16x32_bf16 v[168:171], v[96:99], v[32:35], v[168:171]
    ds_read_b128 v[132:135], v17 offset:16384
    s_waitcnt lgkmcnt(8)
    v_mfma_f32_16x16x32_bf16 v[136:139], v[100:103], v[36:39], v[136:139]
    s_waitcnt lgkmcnt(7)
    v_mfma_f32_16x16x32_bf16 v[140:143], v[104:107], v[36:39], v[140:143]
    s_waitcnt lgkmcnt(6)
    v_mfma_f32_16x16x32_bf16 v[144:147], v[108:111], v[36:39], v[144:147]
    s_waitcnt lgkmcnt(5)
    v_mfma_f32_16x16x32_bf16 v[148:151], v[112:115], v[36:39], v[148:151]
    s_waitcnt lgkmcnt(4)
    v_mfma_f32_16x16x32_bf16 v[152:155], v[116:119], v[36:39], v[152:155]
    s_waitcnt lgkmcnt(3)
    v_mfma_f32_16x16x32_bf16 v[156:159], v[120:123], v[36:39], v[156:159]
    s_waitcnt lgkmcnt(2)
    v_mfma_f32_16x16x32_bf16 v[160:163], v[124:127], v[36:39], v[160:163]
    s_waitcnt lgkmcnt(1)
    v_mfma_f32_16x16x32_bf16 v[164:167], v[128:131], v[36:39], v[164:167]
    s_waitcnt lgkmcnt(0)
    v_mfma_f32_16x16x32_bf16 v[168:171], v[132:135], v[36:39], v[168:171]
    s_nop 7
    v_pk_add_f32 v[184:185], v[136:137], v[144:145]
    v_pk_mul_f32 v[184:185], v[184:185], 0.5 op_sel_hi:[1,0]
    v_pk_fma_f32 v[172:173], v[140:141], 0.5, v[184:185] op_sel_hi:[1,0,1]
    v_pk_fma_f32 v[140:141], v[140:141], -0.5, v[184:185] op_sel_hi:[1,0,1]
    v_pk_add_f32 v[184:185], v[138:139], v[146:147]
    v_pk_mul_f32 v[184:185], v[184:185], 0.5 op_sel_hi:[1,0]
    v_pk_fma_f32 v[174:175], v[142:143], 0.5, v[184:185] op_sel_hi:[1,0,1]
    v_pk_fma_f32 v[142:143], v[142:143], -0.5, v[184:185] op_sel_hi:[1,0,1]
    v_pk_add_f32 v[184:185], v[148:149], v[156:157]
    v_pk_mul_f32 v[184:185], v[184:185], 0.5 op_sel_hi:[1,0]
    v_pk_fma_f32 v[176:177], v[152:153], 0.5, v[184:185] op_sel_hi:[1,0,1]
    v_pk_fma_f32 v[152:153], v[152:153], -0.5, v[184:185] op_sel_hi:[1,0,1]
    v_pk_add_f32 v[184:185], v[150:151], v[158:159]
    v_pk_mul_f32 v[184:185], v[184:185], 0.5 op_sel_hi:[1,0]
    v_pk_fma_f32 v[178:179], v[154:155], 0.5, v[184:185] op_sel_hi:[1,0,1]
    v_pk_fma_f32 v[154:155], v[154:155], -0.5, v[184:185] op_sel_hi:[1,0,1]
    v_pk_add_f32 v[184:185], v[160:161], v[168:169]
    v_pk_mul_f32 v[184:185], v[184:185], 0.5 op_sel_hi:[1,0]
    v_pk_fma_f32 v[180:181], v[164:165], 0.5, v[184:185] op_sel_hi:[1,0,1]
    v_pk_fma_f32 v[164:165], v[164:165], -0.5, v[184:185] op_sel_hi:[1,0,1]
    v_pk_add_f32 v[184:185], v[162:163], v[170:171]
    v_pk_mul_f32 v[184:185], v[184:185], 0.5 op_sel_hi:[1,0]
    v_pk_fma_f32 v[182:183], v[166:167], 0.5, v[184:185] op_sel_hi:[1,0,1]
    v_pk_fma_f32 v[166:167], v[166:167], -0.5, v[184:185] op_sel_hi:[1,0,1]
    v_max3_f32 v184, |v136|, |v137|, |v138|
    v_max3_f32 v185, |v139|, |v140|, |v141|
    v_max3_f32 v184, |v142|, |v143|, v184
    v_max3_f32 v185, |v144|, |v145|, v185
    v_max3_f32 v184, |v146|, |v147|, v184
    v_max3_f32 v185, |v148|, |v149|, v185
    v_max3_f32 v184, |v150|, |v151|, v184
    v_max3_f32 v185, |v152|, |v153|, v185
    v_max3_f32 v184, |v154|, |v155|, v184
    v_max3_f32 v185, |v156|, |v157|, v185
    v_max3_f32 v184, |v158|, |v159|, v184
    v_max3_f32 v185, |v160|, |v161|, v185
    v_max3_f32 v184, |v162|, |v163|, v184
    v_max3_f32 v185, |v164|, |v165|, v185
    v_max3_f32 v184, |v166|, |v167|, v184
    v_max3_f32 v185, |v168|, |v169|, v185
    v_max3_f32 v184, |v170|, |v171|, v184
    v_max3_f32 v185, |v172|, |v173|, v185
    v_max3_f32 v184, |v174|, |v175|, v184
    v_max3_f32 v185, |v176|, |v177|, v185
    v_max3_f32 v184, |v178|, |v179|, v184
    v_max3_f32 v185, |v180|, |v181|, v185
    v_max3_f32 v184, |v182|, |v183|, v184
    v_max_f32 v184, v184, v185
    s_nop 1
    v_max_f32_dpp v184, v184, v184 row_ror:1 row_mask:0xf bank_mask:0xf
    s_nop 1
    v_max_f32_dpp v184, v184, v184 row_ror:2 row_mask:0xf bank_mask:0xf
    s_nop 1
    v_max_f32_dpp v184, v184, v184 row_ror:4 row_mask:0xf bank_mask:0xf
    s_nop 1
    v_max_f32_dpp v184, v184, v184 row_ror:8 row_mask:0xf bank_mask:0xf
    v_mov_b32 v185, v184
    s_nop 1
    v_permlane32_swap_b32 v184, v185
    v_max_f32 v184, v184, v185
    v_mov_b32 v185, v184
    s_nop 1
    v_permlane16_swap_b32 v184, v185
    v_max_f32 v184, v184, v185
    s_lshl_b32 s63, s3, 2
    s_add_u32 s63, s63, 135168
    v_mov_b32 v185, s63
    v_add_u32 v184, 1, v184
    ds_write_b32 v185, v184
    s_waitcnt lgkmcnt(0)
    v_mov_b32 v13, 135168
L1_mx:
    ds_read_b128 v[184:187], v13
    s_waitcnt lgkmcnt(0)
    v_min_u32 v14, v184, v185
    v_min3_u32 v14, v14, v186, v187
    v_cmp_eq_u32 vcc, 0, v14
    s_cmp_eq_u64 vcc, 0
    s_cbranch_scc0 L1_mx
    v_max_u32 v184, v184, v185
    v_max3_u32 v184, v184, v186, v187
    v_subrev_u32 v184, 1, v184
    v_mov_b32 v185, v184
    v_mov_b32 v186, v184
    v_mov_b32 v187, v184
    v_max3_f32 v184, v184, v185, v186
    v_max_f32 v184, v184, v187
    s_nop 0
    v_readfirstlane_b32 s63, v184
    s_nop 3
    s_lshr_b32 s63, s63, 23
    s_sub_i32 s63, 143, s63
    s_and_b32 s63, s63, -4
    s_sub_i32 s63, s63, 2
    s_min_i32 s63, s63, 102
    s_add_i32 s64, s63, 127
    s_lshl_b32 s64, s64, 23
    s_mov_b32 s65, s64
    s_mov_b32 s66, 0x00040004
    s_mov_b32 s67, 0xfff8fff8
    v_pk_mul_f32 v[136:137], v[136:137], s[64:65]
    v_pk_mul_f32 v[138:139], v[138:139], s[64:65]
    v_cvt_pk_f16_f32 v188, v136, v137
    v_cvt_pk_f16_f32 v189, v138, v139
    v_pk_mul_f32 v[172:173], v[172:173], s[64:65]
    v_pk_mul_f32 v[174:175], v[174:175], s[64:65]
    v_cvt_pk_f16_f32 v190, v172, v173
    v_cvt_pk_f16_f32 v191, v174, v175
    v_pk_add_u16 v188, v188, s66
    v_and_b32 v188, s67, v188
    v_pk_add_u16 v189, v189, s66
    v_and_b32 v189, s67, v189
    v_pk_add_u16 v190, v190, s66
    v_and_b32 v190, s67, v190
    v_pk_add_u16 v191, v191, s66
    v_and_b32 v191, s67, v191
    s_add_u32 s40, s87, 0
    s_nop 0
    v_permlane16_swap_b32 v188, v190
    v_permlane16_swap_b32 v189, v191
    buffer_store_dwordx4 v[188:191], v24, s[20:23], s40 offen
    v_pk_mul_f32 v[148:149], v[148:149], s[64:65]
    v_pk_mul_f32 v[150:151], v[150:151], s[64:65]
    v_cvt_pk_f16_f32 v192, v148, v149
    v_cvt_pk_f16_f32 v193, v150, v151
    v_pk_mul_f32 v[176:177], v[176:177], s[64:65]
    v_pk_mul_f32 v[178:179], v[178:179], s[64:65]
    v_cvt_pk_f16_f32 v194, v176, v177
    v_cvt_pk_f16_f32 v195, v178, v179
    v_pk_add_u16 v192, v192, s66
    v_and_b32 v192, s67, v192
    v_pk_add_u16 v193, v193, s66
    v_and_b32 v193, s67, v193
    v_pk_add_u16 v194, v194, s66
    v_and_b32 v194, s67, v194
    v_pk_add_u16 v195, v195, s66
    v_and_b32 v195, s67, v195
    s_add_u32 s40, s87, 4096
    s_nop 0
    v_permlane16_swap_b32 v192, v194
    v_permlane16_swap_b32 v193, v195
    buffer_store_dwordx4 v[192:195], v24, s[20:23], s40 offen
    v_pk_mul_f32 v[160:161], v[160:161], s[64:65]
    v_pk_mul_f32 v[162:163], v[162:163], s[64:65]
    v_cvt_pk_f16_f32 v196, v160, v161
    v_cvt_pk_f16_f32 v197, v162, v163
    v_pk_mul_f32 v[180:181], v[180:181], s[64:65]
    v_pk_mul_f32 v[182:183], v[182:183], s[64:65]
    v_cvt_pk_f16_f32 v198, v180, v181
    v_cvt_pk_f16_f32 v199, v182, v183
    v_pk_add_u16 v196, v196, s66
    v_and_b32 v196, s67, v196
    v_pk_add_u16 v197, v197, s66
    v_and_b32 v197, s67, v197
    v_pk_add_u16 v198, v198, s66
    v_and_b32 v198, s67, v198
    v_pk_add_u16 v199, v199, s66
    v_and_b32 v199, s67, v199
    s_add_u32 s40, s87, 8192
    s_nop 0
    v_permlane16_swap_b32 v196, v198
    v_permlane16_swap_b32 v197, v199
    buffer_store_dwordx4 v[196:199], v24, s[20:23], s40 offen
    v_pk_mul_f32 v[140:141], v[140:141], s[64:65]
    v_pk_mul_f32 v[142:143], v[142:143], s[64:65]
    v_cvt_pk_f16_f32 v188, v140, v141
    v_cvt_pk_f16_f32 v189, v142, v143
    v_pk_mul_f32 v[144:145], v[144:145], s[64:65]
    v_pk_mul_f32 v[146:147], v[146:147], s[64:65]
    v_cvt_pk_f16_f32 v190, v144, v145
    v_cvt_pk_f16_f32 v191, v146, v147
    v_pk_add_u16 v188, v188, s66
    v_and_b32 v188, s67, v188
    v_pk_add_u16 v189, v189, s66
    v_and_b32 v189, s67, v189
    v_pk_add_u16 v190, v190, s66
    v_and_b32 v190, s67, v190
    v_pk_add_u16 v191, v191, s66
    v_and_b32 v191, s67, v191
    s_add_u32 s40, s87, 458752
    s_nop 0
    v_permlane16_swap_b32 v188, v190
    v_permlane16_swap_b32 v189, v191
    buffer_store_dwordx4 v[188:191], v24, s[20:23], s40 offen
    v_pk_mul_f32 v[152:153], v[152:153], s[64:65]
    v_pk_mul_f32 v[154:155], v[154:155], s[64:65]
    v_cvt_pk_f16_f32 v192, v152, v153
    v_cvt_pk_f16_f32 v193, v154, v155
    v_pk_mul_f32 v[156:157], v[156:157], s[64:65]
    v_pk_mul_f32 v[158:159], v[158:159], s[64:65]
    v_cvt_pk_f16_f32 v194, v156, v157
    v_cvt_pk_f16_f32 v195, v158, v159
    v_pk_add_u16 v192, v192, s66
    v_and_b32 v192, s67, v192
    v_pk_add_u16 v193, v193, s66
    v_and_b32 v193, s67, v193
    v_pk_add_u16 v194, v194, s66
    v_and_b32 v194, s67, v194
    v_pk_add_u16 v195, v195, s66
    v_and_b32 v195, s67, v195
    s_add_u32 s40, s87, 462848
    s_nop 0
    v_permlane16_swap_b32 v192, v194
    v_permlane16_swap_b32 v193, v195
    buffer_store_dwordx4 v[192:195], v24, s[20:23], s40 offen
    v_pk_mul_f32 v[164:165], v[164:165], s[64:65]
    v_pk_mul_f32 v[166:167], v[166:167], s[64:65]
    v_cvt_pk_f16_f32 v196, v164, v165
    v_cvt_pk_f16_f32 v197, v166, v167
    v_pk_mul_f32 v[168:169], v[168:169], s[64:65]
    v_pk_mul_f32 v[170:171], v[170:171], s[64:65]
    v_cvt_pk_f16_f32 v198, v168, v169
    v_cvt_pk_f16_f32 v199, v170, v171
    v_pk_add_u16 v196, v196, s66
    v_and_b32 v196, s67, v196
    v_pk_add_u16 v197, v197, s66
    v_and_b32 v197, s67, v197
    v_pk_add_u16 v198, v198, s66
    v_and_b32 v198, s67, v198
    v_pk_add_u16 v199, v199, s66
    v_and_b32 v199, s67, v199
    s_add_u32 s40, s87, 466944
    s_nop 0
    v_permlane16_swap_b32 v196, v198
    v_permlane16_swap_b32 v197, v199
    buffer_store_dwordx4 v[196:199], v24, s[20:23], s40 offen
    v_mov_b32 v184, s63
    v_mov_b32 v185, s88
    buffer_store_dword v184, v185, s[20:23], 0 offen
L1_end:
    s_endpgm
L1_rows:
    s_setprio 1
    v_lshrrev_b32 v13, 2, v12
    v_and_b32 v14, 2, v13
    v_lshlrev_b32 v14, 2, v14
    v_and_b32 v15, 1, v13
    v_or_b32 v14, v14, v15
    v_and_b32 v15, 3, v12
    v_lshlrev_b32 v15, 1, v15
    s_and_b32 s63, s3, 1
    s_lshl_b32 s63, s63, 3
    v_or_b32 v15, s63, v15
    v_xor_b32 v14, v14, v15
    v_lshlrev_b32 v14, 4, v14
    v_lshl_add_u32 v15, v11, 3, v13
    v_lshl_add_u32 v16, v15, 8, v14
    v_xor_b32 v17, 16, v16
    v_add_u32 v18, 0x10000, v16
    v_add_u32 v19, 0x10000, v17
    v_and_b32 v1, 7, v12
    v_xor_b32 v14, v11, v1
    v_lshlrev_b32 v14, 4, v14
    v_lshl_add_u32 v14, v12, 7, v14
    s_lshr_b32 s63, s3, 1
    s_lshl_b32 s63, s63, 13
    s_add_u32 s63, s63, 16384
    v_add_u32 v20, s63, v14
    v_xor_b32 v21, 64, v20
    v_add_u32 v22, 0x10000, v20
    v_add_u32 v23, 0x10000, v21
    s_waitcnt lgkmcnt(0)
    s_mov_b32 s20, s98
    s_and_b32 s21, s99, 0xffff
    s_mov_b32 s22, 0x10000000
    s_mov_b32 s23, 0x00020000
    s_lshl_b32 s89, s56, 7
    s_add_u32 s89, s89, 30408704
    s_add_u32 s90, s98, s89
    s_addc_u32 s91, s99, 0
    s_load_dword s62, s[90:91], 0 glc
    s_getpc_b64 s[92:93]
L1_pc:
    s_sub_u32 s92, s92, L1_pc-L1_begin
    s_subb_u32 s93, s93, 0
    s_and_b32 s63, s55, 1
    s_lshl_b32 s63, s63, 2
    s_add_u32 s63, s63, s3
    s_lshl_b32 s63, s63, 13
    v_lshlrev_b32 v70, 7, v10
    v_add_u32 v70, s63, v70
    v_min_u32 v70, L2_slow-L1_begin, v70
    v_mov_b32 v71, s93
    v_add_co_u32 v70, vcc, s92, v70
    s_nop 1
    v_addc_co_u32 v71, vcc, 0, v71, vcc
    global_load_dword v8, v[70:71], off
    v_xor_b32 v14, v11, v1
    v_lshlrev_b32 v14, 4, v14
    v_lshl_add_u32 v14, v12, 7, v14
    s_lshl_b32 s63, s3, 13
    s_add_u32 s63, s63, 98304
    v_add_u32 v27, s63, v14
    v_xor_b32 v28, 64, v27
    v_and_b32 v13, 1, v12
    v_lshlrev_b32 v13, 4, v13
    v_mov_b32 v14, 0x3f80
    v_lshlrev_b32 v13, v13, v14
    v_lshrrev_b32 v14, 1, v12
    v_and_b32 v14, 1, v14
    v_lshrrev_b32 v15, 2, v12
    v_lshrrev_b32 v2, 1, v11
    v_sub_u32 v15, v15, v2
    v_lshlrev_b32 v15, 1, v15
    v_and_b32 v2, 1, v11
    v_lshl_add_u32 v15, v2, 1, v15
    v_add_u32 v15, v15, v14
    v_lshrrev_b32 v3, 2, v12
    v_lshrrev_b32 v4, 1, v11
    v_xor_b32 v3, v3, v4
    v_and_b32 v3, 1, v3
    v_lshlrev_b32 v3, 8, v3
    v_or_b32 v15, v15, v3
    v_cmp_eq_u32 vcc, 0, v15
    s_nop 1
    v_cndmask_b32 v96, 0, v13, vcc
    v_mov_b32 v98, 0
    v_cndmask_b32 v102, 0, v13, vcc
    v_mov_b32 v100, 0
    v_cmp_eq_u32 vcc, 1, v15
    s_nop 1
    v_cndmask_b32 v97, 0, v13, vcc
    v_mov_b32 v99, 0
    v_cndmask_b32 v103, 0, v13, vcc
    v_mov_b32 v101, 0
    v_cmp_eq_u32 vcc, 2, v15
    s_nop 1
    v_cndmask_b32 v104, 0, v13, vcc
    v_mov_b32 v106, 0
    v_cndmask_b32 v110, 0, v13, vcc
    v_mov_b32 v108, 0
    v_cmp_eq_u32 vcc, 3, v15
    s_nop 1
    v_cndmask_b32 v105, 0, v13, vcc
    v_mov_b32 v107, 0
    v_cndmask_b32 v111, 0, v13, vcc
    v_mov_b32 v109, 0
    v_cmp_eq_u32 vcc, 4, v15
    s_nop 1
    v_cndmask_b32 v112, 0, v13, vcc
    v_mov_b32 v114, 0
    v_cndmask_b32 v118, 0, v13, vcc
    v_mov_b32 v116, 0
    v_cmp_eq_u32 vcc, 5, v15
    s_nop 1
    v_cndmask_b32 v113, 0, v13, vcc
    v_mov_b32 v115, 0
    v_cndmask_b32 v119, 0, v13, vcc
    v_mov_b32 v117, 0
    v_cmp_eq_u32 vcc, 6, v15
    s_nop 1
    v_cndmask_b32 v120, 0, v13, vcc
    v_mov_b32 v122, 0
    v_cndmask_b32 v126, 0, v13, vcc
    v_mov_b32 v124, 0
    v_cmp_eq_u32 vcc, 7, v15
    s_nop 1
    v_cndmask_b32 v121, 0, v13, vcc
    v_mov_b32 v123, 0
    v_cndmask_b32 v127, 0, v13, vcc
    v_mov_b32 v125, 0
    s_lshl_b32 s63, s57, 1
    s_and_b32 s95, s3, 1
    s_add_u32 s94, s63, s95
    s_mul_i32 s63, s94, 1114112
    s_mul_i32 s95, s56, 1088
    s_add_u32 s63, s63, s95
    v_lshrrev_b32 v13, 1, v11
    s_mov_b32 s95, 557056
    v_mul_lo_u32 v13, s95, v13
    v_and_b32 v14, 1, v11
    v_mul_u32_u24 v14, 272, v14
    v_add3_u32 v13, v13, v14, s63
    v_lshl_add_u32 v24, v12, 4, v13
    v_mov_b32 v14, 0x80000000
    v_cmp_eq_u32 vcc, 0, v12
    v_add_u32 v15, 256, v13
    s_nop 0
    v_cndmask_b32 v14, v14, v15, vcc
    s_mov_b64 s[44:45], vcc
    v_cmp_eq_u32 vcc, 15, v12
    v_add_u32 v15, 279072, v13
    s_nop 0
    v_cndmask_b32 v14, v14, v15, vcc
    s_mov_b64 s[46:47], vcc
    v_cmp_eq_u32 vcc, 1, v12
    v_add_u32 v15, 544, v13
    s_nop 0
    v_cndmask_b32 v14, v14, v15, vcc
    v_cmp_eq_u32 vcc, 14, v12
    v_add_u32 v15, 278784, v13
    s_nop 0
    v_cndmask_b32 v14, v14, v15, vcc
    v_mov_b32 v25, v14
    s_lshl_b32 s63, s56, 16
    s_lshr_b32 s95, s57, 1
    s_lshl_b32 s95, s95, 15
    s_add_u32 s63, s63, s95
    s_and_b32 s95, s94, 3
    s_lshl_b32 s95, s95, 11
    s_add_u32 s63, s63, s95
    s_add_u32 s63, s63, 10485760
    v_lshlrev_b32 v13, 9, v11
    v_lshl_add_u32 v13, v12, 4, v13
    v_add_u32 v26, s63, v13
    s_mov_b32 s48, 139264
    s_mov_b32 s49, 278528
    s_mov_b32 s50, 417792
    s_mov_b32 s51, 0x4000
    s_mov_b32 s52, 0x2000
    s_mov_b32 s53, 0x6000
    v_lshrrev_b32 v13, 1, v11
    v_and_b32 v14, 1, v11
    v_lshl_add_u32 v13, v14, 1, v13
    v_lshlrev_b32 v13, 8, v13
    v_lshl_add_u32 v29, v12, 4, v13
    s_lshl_b32 s61, s56, 13
    s_add_u32 s61, s61, 28311552
    s_lshl_b32 s94, s94, 10
    s_add_u32 s94, s94, s61
    v_lshlrev_b32 v30, 4, v10
    s_add_u32 s63, s42, 135296
    v_add_u32 v31, s63, v30
    v_lshlrev_b32 v13, 4, v12
    v_add_u32 v9, s63, v13
    s_waitcnt lgkmcnt(0)
    s_mul_i32 s62, s62, 0x9e3779b1
    s_add_u32 s62, s62, 0x7f4a7c15
    s_add_u32 s90, s61, 4096
    s_mov_b32 s86, 0x00040004
    s_mov_b32 s87, 0xfff8fff8
    s_barrier
    ds_read_b64_tr_b16 v[32:33], v16 offset:0
    ds_read_b64_tr_b16 v[34:35], v16 offset:1024
    ds_read_b128 a[0:3], v20 offset:0
    ds_read_b128 a[4:7], v20 offset:2048
    ds_read_b128 a[8:11], v20 offset:4096
    ds_read_b128 a[12:15], v20 offset:6144
    ds_read_b64_tr_b16 v[36:37], v16 offset:8
    ds_read_b64_tr_b16 v[38:39], v16 offset:1032
    ds_read_b64_tr_b16 v[40:41], v17 offset:0
    ds_read_b64_tr_b16 v[42:43], v17 offset:1024
    ds_read_b64_tr_b16 v[44:45], v17 offset:8
    ds_read_b64_tr_b16 v[46:47], v17 offset:1032
    s_waitcnt lgkmcnt(9)
    v_mfma_f32_16x16x32_bf16 v[128:131], v[32:35], a[0:3], 0
    ds_read_b64_tr_b16 v[48:49], v16 offset:8192
    s_waitcnt lgkmcnt(9)
    v_mfma_f32_16x16x32_bf16 v[144:147], v[32:35], a[4:7], 0
    ds_read_b64_tr_b16 v[50:51], v16 offset:9216
    s_waitcnt lgkmcnt(9)
    v_mfma_f32_16x16x32_bf16 v[160:163], v[32:35], a[8:11], 0
    ds_read_b128 a[16:19], v21 offset:0
    s_waitcnt lgkmcnt(9)
    v_mfma_f32_16x16x32_bf16 v[176:179], v[32:35], a[12:15], 0
    ds_read_b128 a[20:23], v21 offset:2048
    s_waitcnt lgkmcnt(8)
    v_mfma_f32_16x16x32_bf16 v[132:135], v[36:39], a[0:3], 0
    ds_read_b128 a[24:27], v21 offset:4096
    v_mfma_f32_16x16x32_bf16 v[148:151], v[36:39], a[4:7], 0
    ds_read_b128 a[28:31], v21 offset:6144
    v_mfma_f32_16x16x32_bf16 v[164:167], v[36:39], a[8:11], 0
    ds_read_b64_tr_b16 v[52:53], v16 offset:8200
    v_mfma_f32_16x16x32_bf16 v[180:183], v[36:39], a[12:15], 0
    ds_read_b64_tr_b16 v[54:55], v16 offset:9224
    s_waitcnt lgkmcnt(10)
    v_mfma_f32_16x16x32_bf16 v[136:139], v[40:43], a[0:3], 0
    ds_read_b64_tr_b16 v[56:57], v17 offset:8192
    v_mfma_f32_16x16x32_bf16 v[152:155], v[40:43], a[4:7], 0
    ds_read_b64_tr_b16 v[58:59], v17 offset:9216
    v_mfma_f32_16x16x32_bf16 v[168:171], v[40:43], a[8:11], 0
    ds_read_b64_tr_b16 v[60:61], v17 offset:8200
    v_mfma_f32_16x16x32_bf16 v[184:187], v[40:43], a[12:15], 0
    ds_read_b64_tr_b16 v[62:63], v17 offset:9224
    s_waitcnt lgkmcnt(12)
    v_mfma_f32_16x16x32_bf16 v[140:143], v[44:47], a[0:3], 0
    v_mfma_f32_16x16x32_bf16 v[156:159], v[44:47], a[4:7], 0
    v_mfma_f32_16x16x32_bf16 v[172:175], v[44:47], a[8:11], 0
    v_mfma_f32_16x16x32_bf16 v[188:191], v[44:47], a[12:15], 0
    s_waitcnt lgkmcnt(9)
    v_mfma_f32_16x16x32_bf16 v[128:131], v[48:51], a[16:19], v[128:131]
    s_waitcnt lgkmcnt(8)
    v_mfma_f32_16x16x32_bf16 v[144:147], v[48:51], a[20:23], v[144:147]
    s_waitcnt lgkmcnt(7)
    v_mfma_f32_16x16x32_bf16 v[160:163], v[48:51], a[24:27], v[160:163]
    s_waitcnt lgkmcnt(6)
    v_mfma_f32_16x16x32_bf16 v[176:179], v[48:51], a[28:31], v[176:179]
    s_waitcnt lgkmcnt(0)
    s_barrier
    ds_read_b64_tr_b16 v[32:33], v16 offset:32768
    v_mfma_f32_16x16x32_bf16 v[132:135], v[52:55], a[16:19], v[132:135]
    ds_read_b64_tr_b16 v[34:35], v16 offset:33792
    v_mfma_f32_16x16x32_bf16 v[148:151], v[52:55], a[20:23], v[148:151]
    ds_read_b128 a[0:3], v20 offset:32768
    v_mfma_f32_16x16x32_bf16 v[164:167], v[52:55], a[24:27], v[164:167]
    ds_read_b128 a[4:7], v20 offset:34816
    v_mfma_f32_16x16x32_bf16 v[180:183], v[52:55], a[28:31], v[180:183]
    ds_read_b128 a[8:11], v20 offset:36864
    v_mfma_f32_16x16x32_bf16 v[136:139], v[56:59], a[16:19], v[136:139]
    ds_read_b128 a[12:15], v20 offset:38912
    v_mfma_f32_16x16x32_bf16 v[152:155], v[56:59], a[20:23], v[152:155]
    ds_read_b64_tr_b16 v[36:37], v16 offset:32776
    v_mfma_f32_16x16x32_bf16 v[168:171], v[56:59], a[24:27], v[168:171]
    ds_read_b64_tr_b16 v[38:39], v16 offset:33800
    v_mfma_f32_16x16x32_bf16 v[184:187], v[56:59], a[28:31], v[184:187]
    ds_read_b64_tr_b16 v[40:41], v17 offset:32768
    v_mfma_f32_16x16x32_bf16 v[140:143], v[60:63], a[16:19], v[140:143]
    ds_read_b64_tr_b16 v[42:43], v17 offset:33792
    v_mfma_f32_16x16x32_bf16 v[156:159], v[60:63], a[20:23], v[156:159]
    ds_read_b64_tr_b16 v[44:45], v17 offset:32776
    v_mfma_f32_16x16x32_bf16 v[172:175], v[60:63], a[24:27], v[172:175]
    ds_read_b64_tr_b16 v[46:47], v17 offset:33800
    v_mfma_f32_16x16x32_bf16 v[188:191], v[60:63], a[28:31], v[188:191]
    s_waitcnt lgkmcnt(9)
    v_mfma_f32_16x16x32_bf16 v[128:131], v[32:35], a[0:3], v[128:131]
    ds_read_b64_tr_b16 v[48:49], v16 offset:40960
    s_waitcnt lgkmcnt(9)
    v_mfma_f32_16x16x32_bf16 v[144:147], v[32:35], a[4:7], v[144:147]
    ds_read_b64_tr_b16 v[50:51], v16 offset:41984
    s_waitcnt lgkmcnt(9)
    v_mfma_f32_16x16x32_bf16 v[160:163], v[32:35], a[8:11], v[160:163]
    ds_read_b128 a[16:19], v21 offset:32768
    s_waitcnt lgkmcnt(9)
    v_mfma_f32_16x16x32_bf16 v[176:179], v[32:35], a[12:15], v[176:179]
    ds_read_b128 a[20:23], v21 offset:34816
    s_waitcnt lgkmcnt(8)
    v_mfma_f32_16x16x32_bf16 v[132:135], v[36:39], a[0:3], v[132:135]
    ds_read_b128 a[24:27], v21 offset:36864
    v_mfma_f32_16x16x32_bf16 v[148:151], v[36:39], a[4:7], v[148:151]
    ds_read_b128 a[28:31], v21 offset:38912
    v_mfma_f32_16x16x32_bf16 v[164:167], v[36:39], a[8:11], v[164:167]
    ds_read_b64_tr_b16 v[52:53], v16 offset:40968
    v_mfma_f32_16x16x32_bf16 v[180:183], v[36:39], a[12:15], v[180:183]
    ds_read_b64_tr_b16 v[54:55], v16 offset:41992
    s_waitcnt lgkmcnt(10)
    v_mfma_f32_16x16x32_bf16 v[136:139], v[40:43], a[0:3], v[136:139]
    ds_read_b64_tr_b16 v[56:57], v17 offset:40960
    v_mfma_f32_16x16x32_bf16 v[152:155], v[40:43], a[4:7], v[152:155]
    ds_read_b64_tr_b16 v[58:59], v17 offset:41984
    v_mfma_f32_16x16x32_bf16 v[168:171], v[40:43], a[8:11], v[168:171]
    ds_read_b64_tr_b16 v[60:61], v17 offset:40968
    v_mfma_f32_16x16x32_bf16 v[184:187], v[40:43], a[12:15], v[184:187]
    ds_read_b64_tr_b16 v[62:63], v17 offset:41992
    s_waitcnt lgkmcnt(12)
    v_mfma_f32_16x16x32_bf16 v[140:143], v[44:47], a[0:3], v[140:143]
    v_mfma_f32_16x16x32_bf16 v[156:159], v[44:47], a[4:7], v[156:159]
    v_mfma_f32_16x16x32_bf16 v[172:175], v[44:47], a[8:11], v[172:175]
    v_mfma_f32_16x16x32_bf16 v[188:191], v[44:47], a[12:15], v[188:191]
    s_waitcnt lgkmcnt(9)
    v_mfma_f32_16x16x32_bf16 v[128:131], v[48:51], a[16:19], v[128:131]
    s_waitcnt lgkmcnt(8)
    v_mfma_f32_16x16x32_bf16 v[144:147], v[48:51], a[20:23], v[144:147]
    s_waitcnt lgkmcnt(7)
    v_mfma_f32_16x16x32_bf16 v[160:163], v[48:51], a[24:27], v[160:163]
    s_waitcnt lgkmcnt(6)
    v_mfma_f32_16x16x32_bf16 v[176:179], v[48:51], a[28:31], v[176:179]
    s_waitcnt lgkmcnt(0)
    s_barrier
    ds_read_b64_tr_b16 v[32:33], v18 offset:0
    v_mfma_f32_16x16x32_bf16 v[132:135], v[52:55], a[16:19], v[132:135]
    ds_read_b64_tr_b16 v[34:35], v18 offset:1024
    v_mfma_f32_16x16x32_bf16 v[148:151], v[52:55], a[20:23], v[148:151]
    ds_read_b128 a[0:3], v22 offset:0
    v_mfma_f32_16x16x32_bf16 v[164:167], v[52:55], a[24:27], v[164:167]
    ds_read_b128 a[4:7], v22 offset:2048
    v_mfma_f32_16x16x32_bf16 v[180:183], v[52:55], a[28:31], v[180:183]
    ds_read_b128 a[8:11], v22 offset:4096
    v_mfma_f32_16x16x32_bf16 v[136:139], v[56:59], a[16:19], v[136:139]
    ds_read_b128 a[12:15], v22 offset:6144
    v_mfma_f32_16x16x32_bf16 v[152:155], v[56:59], a[20:23], v[152:155]
    ds_read_b64_tr_b16 v[36:37], v18 offset:8
    v_mfma_f32_16x16x32_bf16 v[168:171], v[56:59], a[24:27], v[168:171]
    ds_read_b64_tr_b16 v[38:39], v18 offset:1032
    v_mfma_f32_16x16x32_bf16 v[184:187], v[56:59], a[28:31], v[184:187]
    ds_read_b64_tr_b16 v[40:41], v19 offset:0
    v_mfma_f32_16x16x32_bf16 v[140:143], v[60:63], a[16:19], v[140:143]
    ds_read_b64_tr_b16 v[42:43], v19 offset:1024
    v_mfma_f32_16x16x32_bf16 v[156:159], v[60:63], a[20:23], v[156:159]
    ds_read_b64_tr_b16 v[44:45], v19 offset:8
    v_mfma_f32_16x16x32_bf16 v[172:175], v[60:63], a[24:27], v[172:175]
    ds_read_b64_tr_b16 v[46:47], v19 offset:1032
    v_mfma_f32_16x16x32_bf16 v[188:191], v[60:63], a[28:31], v[188:191]
    s_waitcnt lgkmcnt(9)
    v_mfma_f32_16x16x32_bf16 v[128:131], v[32:35], a[0:3], v[128:131]
    ds_read_b64_tr_b16 v[48:49], v18 offset:8192
    s_waitcnt lgkmcnt(9)
    v_mfma_f32_16x16x32_bf16 v[144:147], v[32:35], a[4:7], v[144:147]
    ds_read_b64_tr_b16 v[50:51], v18 offset:9216
    s_waitcnt lgkmcnt(9)
    v_mfma_f32_16x16x32_bf16 v[160:163], v[32:35], a[8:11], v[160:163]
    ds_read_b128 a[16:19], v23 offset:0
    s_waitcnt lgkmcnt(9)
    v_mfma_f32_16x16x32_bf16 v[176:179], v[32:35], a[12:15], v[176:179]
    ds_read_b128 a[20:23], v23 offset:2048
    s_waitcnt lgkmcnt(8)
    v_mfma_f32_16x16x32_bf16 v[132:135], v[36:39], a[0:3], v[132:135]
    ds_read_b128 a[24:27], v23 offset:4096
    v_mfma_f32_16x16x32_bf16 v[148:151], v[36:39], a[4:7], v[148:151]
    ds_read_b128 a[28:31], v23 offset:6144
    v_mfma_f32_16x16x32_bf16 v[164:167], v[36:39], a[8:11], v[164:167]
    ds_read_b64_tr_b16 v[52:53], v18 offset:8200
    v_mfma_f32_16x16x32_bf16 v[180:183], v[36:39], a[12:15], v[180:183]
    ds_read_b64_tr_b16 v[54:55], v18 offset:9224
    s_waitcnt lgkmcnt(10)
    v_mfma_f32_16x16x32_bf16 v[136:139], v[40:43], a[0:3], v[136:139]
    ds_read_b64_tr_b16 v[56:57], v19 offset:8192
    v_mfma_f32_16x16x32_bf16 v[152:155], v[40:43], a[4:7], v[152:155]
    ds_read_b64_tr_b16 v[58:59], v19 offset:9216
    v_mfma_f32_16x16x32_bf16 v[168:171], v[40:43], a[8:11], v[168:171]
    ds_read_b64_tr_b16 v[60:61], v19 offset:8200
    v_mfma_f32_16x16x32_bf16 v[184:187], v[40:43], a[12:15], v[184:187]
    ds_read_b64_tr_b16 v[62:63], v19 offset:9224
    s_waitcnt lgkmcnt(12)
    v_mfma_f32_16x16x32_bf16 v[140:143], v[44:47], a[0:3], v[140:143]
    v_mfma_f32_16x16x32_bf16 v[156:159], v[44:47], a[4:7], v[156:159]
    v_mfma_f32_16x16x32_bf16 v[172:175], v[44:47], a[8:11], v[172:175]
    v_mfma_f32_16x16x32_bf16 v[188:191], v[44:47], a[12:15], v[188:191]
    s_waitcnt lgkmcnt(9)
    v_mfma_f32_16x16x32_bf16 v[128:131], v[48:51], a[16:19], v[128:131]
    s_waitcnt lgkmcnt(8)
    v_mfma_f32_16x16x32_bf16 v[144:147], v[48:51], a[20:23], v[144:147]
    s_waitcnt lgkmcnt(7)
    v_mfma_f32_16x16x32_bf16 v[160:163], v[48:51], a[24:27], v[160:163]
    s_waitcnt lgkmcnt(6)
    v_mfma_f32_16x16x32_bf16 v[176:179], v[48:51], a[28:31], v[176:179]
    s_waitcnt lgkmcnt(0)
    s_barrier
    ds_read_b64_tr_b16 v[32:33], v16 offset:0
    v_mfma_f32_16x16x32_bf16 v[132:135], v[52:55], a[16:19], v[132:135]
    ds_read_b64_tr_b16 v[34:35], v16 offset:1024
    v_mfma_f32_16x16x32_bf16 v[148:151], v[52:55], a[20:23], v[148:151]
    ds_read_b128 a[0:3], v20 offset:0
    v_mfma_f32_16x16x32_bf16 v[164:167], v[52:55], a[24:27], v[164:167]
    ds_read_b128 a[4:7], v20 offset:2048
    v_mfma_f32_16x16x32_bf16 v[180:183], v[52:55], a[28:31], v[180:183]
    ds_read_b128 a[8:11], v20 offset:4096
    v_mfma_f32_16x16x32_bf16 v[136:139], v[56:59], a[16:19], v[136:139]
    ds_read_b128 a[12:15], v20 offset:6144
    v_mfma_f32_16x16x32_bf16 v[152:155], v[56:59], a[20:23], v[152:155]
    ds_read_b64_tr_b16 v[36:37], v16 offset:8
    v_mfma_f32_16x16x32_bf16 v[168:171], v[56:59], a[24:27], v[168:171]
    ds_read_b64_tr_b16 v[38:39], v16 offset:1032
    v_mfma_f32_16x16x32_bf16 v[184:187], v[56:59], a[28:31], v[184:187]
    ds_read_b64_tr_b16 v[40:41], v17 offset:0
    v_mfma_f32_16x16x32_bf16 v[140:143], v[60:63], a[16:19], v[140:143]
    ds_read_b64_tr_b16 v[42:43], v17 offset:1024
    v_mfma_f32_16x16x32_bf16 v[156:159], v[60:63], a[20:23], v[156:159]
    ds_read_b64_tr_b16 v[44:45], v17 offset:8
    v_mfma_f32_16x16x32_bf16 v[172:175], v[60:63], a[24:27], v[172:175]
    ds_read_b64_tr_b16 v[46:47], v17 offset:1032
    v_mfma_f32_16x16x32_bf16 v[188:191], v[60:63], a[28:31], v[188:191]
    s_waitcnt lgkmcnt(9)
    v_mfma_f32_16x16x32_bf16 v[128:131], v[32:35], a[0:3], v[128:131]
    ds_read_b64_tr_b16 v[48:49], v16 offset:8192
    s_waitcnt lgkmcnt(9)
    v_mfma_f32_16x16x32_bf16 v[144:147], v[32:35], a[4:7], v[144:147]
    ds_read_b64_tr_b16 v[50:51], v16 offset:9216
    s_waitcnt lgkmcnt(9)
    v_mfma_f32_16x16x32_bf16 v[160:163], v[32:35], a[8:11], v[160:163]
    ds_read_b128 a[16:19], v21 offset:0
    s_waitcnt lgkmcnt(9)
    v_mfma_f32_16x16x32_bf16 v[176:179], v[32:35], a[12:15], v[176:179]
    ds_read_b128 a[20:23], v21 offset:2048
    s_waitcnt lgkmcnt(8)
    v_mfma_f32_16x16x32_bf16 v[132:135], v[36:39], a[0:3], v[132:135]
    ds_read_b128 a[24:27], v21 offset:4096
    v_mfma_f32_16x16x32_bf16 v[148:151], v[36:39], a[4:7], v[148:151]
    ds_read_b128 a[28:31], v21 offset:6144
    v_mfma_f32_16x16x32_bf16 v[164:167], v[36:39], a[8:11], v[164:167]
    ds_read_b64_tr_b16 v[52:53], v16 offset:8200
    v_mfma_f32_16x16x32_bf16 v[180:183], v[36:39], a[12:15], v[180:183]
    ds_read_b64_tr_b16 v[54:55], v16 offset:9224
    s_waitcnt lgkmcnt(10)
    v_mfma_f32_16x16x32_bf16 v[136:139], v[40:43], a[0:3], v[136:139]
    ds_read_b64_tr_b16 v[56:57], v17 offset:8192
    v_mfma_f32_16x16x32_bf16 v[152:155], v[40:43], a[4:7], v[152:155]
    ds_read_b64_tr_b16 v[58:59], v17 offset:9216
    v_mfma_f32_16x16x32_bf16 v[168:171], v[40:43], a[8:11], v[168:171]
    ds_read_b64_tr_b16 v[60:61], v17 offset:8200
    v_mfma_f32_16x16x32_bf16 v[184:187], v[40:43], a[12:15], v[184:187]
    ds_read_b64_tr_b16 v[62:63], v17 offset:9224
    s_waitcnt lgkmcnt(12)
    v_mfma_f32_16x16x32_bf16 v[140:143], v[44:47], a[0:3], v[140:143]
    v_mfma_f32_16x16x32_bf16 v[156:159], v[44:47], a[4:7], v[156:159]
    v_mfma_f32_16x16x32_bf16 v[172:175], v[44:47], a[8:11], v[172:175]
    v_mfma_f32_16x16x32_bf16 v[188:191], v[44:47], a[12:15], v[188:191]
    s_waitcnt lgkmcnt(9)
    v_mfma_f32_16x16x32_bf16 v[128:131], v[48:51], a[16:19], v[128:131]
    s_waitcnt lgkmcnt(8)
    v_mfma_f32_16x16x32_bf16 v[144:147], v[48:51], a[20:23], v[144:147]
    s_waitcnt lgkmcnt(7)
    v_mfma_f32_16x16x32_bf16 v[160:163], v[48:51], a[24:27], v[160:163]
    s_waitcnt lgkmcnt(6)
    v_mfma_f32_16x16x32_bf16 v[176:179], v[48:51], a[28:31], v[176:179]
    s_waitcnt lgkmcnt(0)
    s_barrier
    ds_read_b64_tr_b16 v[32:33], v16 offset:32768
    v_mfma_f32_16x16x32_bf16 v[132:135], v[52:55], a[16:19], v[132:135]
    ds_read_b64_tr_b16 v[34:35], v16 offset:33792
    v_mfma_f32_16x16x32_bf16 v[148:151], v[52:55], a[20:23], v[148:151]
    ds_read_b128 a[0:3], v20 offset:32768
    v_mfma_f32_16x16x32_bf16 v[164:167], v[52:55], a[24:27], v[164:167]
    ds_read_b128 a[4:7], v20 offset:34816
    v_mfma_f32_16x16x32_bf16 v[180:183], v[52:55], a[28:31], v[180:183]
    ds_read_b128 a[8:11], v20 offset:36864
    v_mfma_f32_16x16x32_bf16 v[136:139], v[56:59], a[16:19], v[136:139]
    ds_read_b128 a[12:15], v20 offset:38912
    v_mfma_f32_16x16x32_bf16 v[152:155], v[56:59], a[20:23], v[152:155]
    ds_read_b64_tr_b16 v[36:37], v16 offset:32776
    v_mfma_f32_16x16x32_bf16 v[168:171], v[56:59], a[24:27], v[168:171]
    ds_read_b64_tr_b16 v[38:39], v16 offset:33800
    v_mfma_f32_16x16x32_bf16 v[184:187], v[56:59], a[28:31], v[184:187]
    ds_read_b64_tr_b16 v[40:41], v17 offset:32768
    v_mfma_f32_16x16x32_bf16 v[140:143], v[60:63], a[16:19], v[140:143]
    ds_read_b64_tr_b16 v[42:43], v17 offset:33792
    v_mfma_f32_16x16x32_bf16 v[156:159], v[60:63], a[20:23], v[156:159]
    ds_read_b64_tr_b16 v[44:45], v17 offset:32776
    v_mfma_f32_16x16x32_bf16 v[172:175], v[60:63], a[24:27], v[172:175]
    ds_read_b64_tr_b16 v[46:47], v17 offset:33800
    v_mfma_f32_16x16x32_bf16 v[188:191], v[60:63], a[28:31], v[188:191]
    s_waitcnt lgkmcnt(9)
    v_mfma_f32_16x16x32_bf16 v[128:131], v[32:35], a[0:3], v[128:131]
    ds_read_b64_tr_b16 v[48:49], v16 offset:40960
    s_waitcnt lgkmcnt(9)
    v_mfma_f32_16x16x32_bf16 v[144:147], v[32:35], a[4:7], v[144:147]
    ds_read_b64_tr_b16 v[50:51], v16 offset:41984
    s_waitcnt lgkmcnt(9)
    v_mfma_f32_16x16x32_bf16 v[160:163], v[32:35], a[8:11], v[160:163]
    ds_read_b128 a[16:19], v21 offset:32768
    s_waitcnt lgkmcnt(9)
    v_mfma_f32_16x16x32_bf16 v[176:179], v[32:35], a[12:15], v[176:179]
    ds_read_b128 a[20:23], v21 offset:34816
    s_waitcnt lgkmcnt(8)
    v_mfma_f32_16x16x32_bf16 v[132:135], v[36:39], a[0:3], v[132:135]
    ds_read_b128 a[24:27], v21 offset:36864
    v_mfma_f32_16x16x32_bf16 v[148:151], v[36:39], a[4:7], v[148:151]
    ds_read_b128 a[28:31], v21 offset:38912
    v_mfma_f32_16x16x32_bf16 v[164:167], v[36:39], a[8:11], v[164:167]
    ds_read_b64_tr_b16 v[52:53], v16 offset:40968
    v_mfma_f32_16x16x32_bf16 v[180:183], v[36:39], a[12:15], v[180:183]
    ds_read_b64_tr_b16 v[54:55], v16 offset:41992
    s_waitcnt lgkmcnt(10)
    v_mfma_f32_16x16x32_bf16 v[136:139], v[40:43], a[0:3], v[136:139]
    ds_read_b64_tr_b16 v[56:57], v17 offset:40960
    v_mfma_f32_16x16x32_bf16 v[152:155], v[40:43], a[4:7], v[152:155]
    ds_read_b64_tr_b16 v[58:59], v17 offset:41984
    v_mfma_f32_16x16x32_bf16 v[168:171], v[40:43], a[8:11], v[168:171]
    ds_read_b64_tr_b16 v[60:61], v17 offset:40968
    v_mfma_f32_16x16x32_bf16 v[184:187], v[40:43], a[12:15], v[184:187]
    ds_read_b64_tr_b16 v[62:63], v17 offset:41992
    s_waitcnt lgkmcnt(12)
    v_mfma_f32_16x16x32_bf16 v[140:143], v[44:47], a[0:3], v[140:143]
    v_mfma_f32_16x16x32_bf16 v[156:159], v[44:47], a[4:7], v[156:159]
    v_mfma_f32_16x16x32_bf16 v[172:175], v[44:47], a[8:11], v[172:175]
    v_mfma_f32_16x16x32_bf16 v[188:191], v[44:47], a[12:15], v[188:191]
    ds_read_b128 v[64:67], v27 offset:0
    ds_read_b128 v[68:71], v28 offset:0
    s_waitcnt lgkmcnt(11)
    v_mfma_f32_16x16x32_bf16 v[128:131], v[48:51], a[16:19], v[128:131]
    s_waitcnt lgkmcnt(10)
    v_mfma_f32_16x16x32_bf16 v[144:147], v[48:51], a[20:23], v[144:147]
    s_waitcnt lgkmcnt(9)
    v_mfma_f32_16x16x32_bf16 v[160:163], v[48:51], a[24:27], v[160:163]
    s_waitcnt lgkmcnt(8)
    v_mfma_f32_16x16x32_bf16 v[176:179], v[48:51], a[28:31], v[176:179]
    s_waitcnt lgkmcnt(2)
    s_barrier
    ds_read_b64_tr_b16 v[32:33], v18 offset:0
    v_mfma_f32_16x16x32_bf16 v[132:135], v[52:55], a[16:19], v[132:135]
    ds_read_b64_tr_b16 v[34:35], v18 offset:1024
    v_mfma_f32_16x16x32_bf16 v[148:151], v[52:55], a[20:23], v[148:151]
    ds_read_b128 a[0:3], v22 offset:0
    v_mfma_f32_16x16x32_bf16 v[164:167], v[52:55], a[24:27], v[164:167]
    ds_read_b128 a[4:7], v22 offset:2048
    v_mfma_f32_16x16x32_bf16 v[180:183], v[52:55], a[28:31], v[180:183]
    s_waitcnt lgkmcnt(4)
    ds_read_b128 a[8:11], v22 offset:4096
    v_mfma_f32_16x16x32_bf16 v[136:139], v[56:59], a[16:19], v[136:139]
    ds_read_b128 a[12:15], v22 offset:6144
    v_mfma_f32_16x16x32_bf16 v[152:155], v[56:59], a[20:23], v[152:155]
    ds_read_b64_tr_b16 v[36:37], v18 offset:8
    v_mfma_f32_16x16x32_bf16 v[168:171], v[56:59], a[24:27], v[168:171]
    ds_read_b64_tr_b16 v[38:39], v18 offset:1032
    v_mfma_f32_16x16x32_bf16 v[184:187], v[56:59], a[28:31], v[184:187]
    ds_read_b64_tr_b16 v[40:41], v19 offset:0
    v_mfma_f32_16x16x32_bf16 v[140:143], v[60:63], a[16:19], v[140:143]
    ds_read_b64_tr_b16 v[42:43], v19 offset:1024
    v_mfma_f32_16x16x32_bf16 v[156:159], v[60:63], a[20:23], v[156:159]
    ds_read_b64_tr_b16 v[44:45], v19 offset:8
    v_mfma_f32_16x16x32_bf16 v[172:175], v[60:63], a[24:27], v[172:175]
    ds_read_b64_tr_b16 v[46:47], v19 offset:1032
    v_mfma_f32_16x16x32_bf16 v[188:191], v[60:63], a[28:31], v[188:191]
    v_mfma_f32_16x16x32_bf16 v[128:131], v[96:99], v[64:67], v[128:131]
    v_mfma_f32_16x16x32_bf16 v[132:135], v[100:103], v[64:67], v[132:135]
    v_mfma_f32_16x16x32_bf16 v[136:139], v[104:107], v[64:67], v[136:139]
    v_mfma_f32_16x16x32_bf16 v[140:143], v[108:111], v[64:67], v[140:143]
    v_mfma_f32_16x16x32_bf16 v[128:131], v[112:115], v[68:71], v[128:131]
    v_mfma_f32_16x16x32_bf16 v[132:135], v[116:119], v[68:71], v[132:135]
    v_mfma_f32_16x16x32_bf16 v[136:139], v[120:123], v[68:71], v[136:139]
    v_mfma_f32_16x16x32_bf16 v[140:143], v[124:127], v[68:71], v[140:143]
    ds_read_b128 v[72:75], v27 offset:2048
    ds_read_b128 v[76:79], v28 offset:2048
    s_waitcnt lgkmcnt(11)
    v_mfma_f32_16x16x32_bf16 v[128:131], v[32:35], a[0:3], v[128:131]
    ds_read_b64_tr_b16 v[48:49], v18 offset:8192
    s_waitcnt lgkmcnt(11)
    v_mfma_f32_16x16x32_bf16 v[144:147], v[32:35], a[4:7], v[144:147]
    ds_read_b64_tr_b16 v[50:51], v18 offset:9216
    s_waitcnt lgkmcnt(11)
    v_mfma_f32_16x16x32_bf16 v[160:163], v[32:35], a[8:11], v[160:163]
    ds_read_b128 a[16:19], v23 offset:0
    s_waitcnt lgkmcnt(11)
    v_mfma_f32_16x16x32_bf16 v[176:179], v[32:35], a[12:15], v[176:179]
    ds_read_b128 a[20:23], v23 offset:2048
    s_waitcnt lgkmcnt(10)
    v_mfma_f32_16x16x32_bf16 v[132:135], v[36:39], a[0:3], v[132:135]
    ds_read_b128 a[24:27], v23 offset:4096
    v_mfma_f32_16x16x32_bf16 v[148:151], v[36:39], a[4:7], v[148:151]
    ds_read_b128 a[28:31], v23 offset:6144
    v_mfma_f32_16x16x32_bf16 v[164:167], v[36:39], a[8:11], v[164:167]
    ds_read_b64_tr_b16 v[52:53], v18 offset:8200
    v_mfma_f32_16x16x32_bf16 v[180:183], v[36:39], a[12:15], v[180:183]
    s_waitcnt lgkmcnt(7)
    ds_read_b64_tr_b16 v[54:55], v18 offset:9224
    v_mfma_f32_16x16x32_bf16 v[136:139], v[40:43], a[0:3], v[136:139]
    ds_read_b64_tr_b16 v[56:57], v19 offset:8192
    v_mfma_f32_16x16x32_bf16 v[152:155], v[40:43], a[4:7], v[152:155]
    ds_read_b64_tr_b16 v[58:59], v19 offset:9216
    v_mfma_f32_16x16x32_bf16 v[168:171], v[40:43], a[8:11], v[168:171]
    ds_read_b64_tr_b16 v[60:61], v19 offset:8200
    v_mfma_f32_16x16x32_bf16 v[184:187], v[40:43], a[12:15], v[184:187]
    ds_read_b64_tr_b16 v[62:63], v19 offset:9224
    v_mfma_f32_16x16x32_bf16 v[140:143], v[44:47], a[0:3], v[140:143]
    v_mfma_f32_16x16x32_bf16 v[156:159], v[44:47], a[4:7], v[156:159]
    v_mfma_f32_16x16x32_bf16 v[172:175], v[44:47], a[8:11], v[172:175]
    v_mfma_f32_16x16x32_bf16 v[188:191], v[44:47], a[12:15], v[188:191]
    v_mfma_f32_16x16x32_bf16 v[144:147], v[96:99], v[72:75], v[144:147]
    v_mfma_f32_16x16x32_bf16 v[148:151], v[100:103], v[72:75], v[148:151]
    v_mfma_f32_16x16x32_bf16 v[152:155], v[104:107], v[72:75], v[152:155]
    v_mfma_f32_16x16x32_bf16 v[156:159], v[108:111], v[72:75], v[156:159]
    v_mfma_f32_16x16x32_bf16 v[144:147], v[112:115], v[76:79], v[144:147]
    v_mfma_f32_16x16x32_bf16 v[148:151], v[116:119], v[76:79], v[148:151]
    v_mfma_f32_16x16x32_bf16 v[152:155], v[120:123], v[76:79], v[152:155]
    v_mfma_f32_16x16x32_bf16 v[156:159], v[124:127], v[76:79], v[156:159]
    ds_read_b128 v[80:83], v27 offset:4096
    ds_read_b128 v[84:87], v28 offset:4096
    s_waitcnt lgkmcnt(11)
    v_mfma_f32_16x16x32_bf16 v[128:131], v[48:51], a[16:19], v[128:131]
    s_waitcnt lgkmcnt(10)
    v_mfma_f32_16x16x32_bf16 v[144:147], v[48:51], a[20:23], v[144:147]
    s_waitcnt lgkmcnt(9)
    v_mfma_f32_16x16x32_bf16 v[160:163], v[48:51], a[24:27], v[160:163]
    s_waitcnt lgkmcnt(8)
    v_mfma_f32_16x16x32_bf16 v[176:179], v[48:51], a[28:31], v[176:179]
    s_waitcnt lgkmcnt(2)
    s_barrier
    ds_read_b64_tr_b16 v[32:33], v16 offset:0
    v_mfma_f32_16x16x32_bf16 v[132:135], v[52:55], a[16:19], v[132:135]
    ds_read_b64_tr_b16 v[34:35], v16 offset:1024
    v_mfma_f32_16x16x32_bf16 v[148:151], v[52:55], a[20:23], v[148:151]
    ds_read_b128 a[0:3], v20 offset:0
    v_mfma_f32_16x16x32_bf16 v[164:167], v[52:55], a[24:27], v[164:167]
    ds_read_b128 a[4:7], v20 offset:2048
    v_mfma_f32_16x16x32_bf16 v[180:183], v[52:55], a[28:31], v[180:183]
    s_waitcnt lgkmcnt(4)
    ds_read_b128 a[8:11], v20 offset:4096
    v_mfma_f32_16x16x32_bf16 v[136:139], v[56:59], a[16:19], v[136:139]
    ds_read_b128 a[12:15], v20 offset:6144
    v_mfma_f32_16x16x32_bf16 v[152:155], v[56:59], a[20:23], v[152:155]
    ds_read_b64_tr_b16 v[36:37], v16 offset:8
    v_mfma_f32_16x16x32_bf16 v[168:171], v[56:59], a[24:27], v[168:171]
    ds_read_b64_tr_b16 v[38:39], v16 offset:1032
    v_mfma_f32_16x16x32_bf16 v[184:187], v[56:59], a[28:31], v[184:187]
    ds_read_b64_tr_b16 v[40:41], v17 offset:0
    v_mfma_f32_16x16x32_bf16 v[140:143], v[60:63], a[16:19], v[140:143]
    ds_read_b64_tr_b16 v[42:43], v17 offset:1024
    v_mfma_f32_16x16x32_bf16 v[156:159], v[60:63], a[20:23], v[156:159]
    ds_read_b64_tr_b16 v[44:45], v17 offset:8
    v_mfma_f32_16x16x32_bf16 v[172:175], v[60:63], a[24:27], v[172:175]
    ds_read_b64_tr_b16 v[46:47], v17 offset:1032
    v_mfma_f32_16x16x32_bf16 v[188:191], v[60:63], a[28:31], v[188:191]
    v_mfma_f32_16x16x32_bf16 v[160:163], v[96:99], v[80:83], v[160:163]
    v_mfma_f32_16x16x32_bf16 v[164:167], v[100:103], v[80:83], v[164:167]
    v_mfma_f32_16x16x32_bf16 v[168:171], v[104:107], v[80:83], v[168:171]
    v_mfma_f32_16x16x32_bf16 v[172:175], v[108:111], v[80:83], v[172:175]
    v_mfma_f32_16x16x32_bf16 v[160:163], v[112:115], v[84:87], v[160:163]
    v_mfma_f32_16x16x32_bf16 v[164:167], v[116:119], v[84:87], v[164:167]
    v_mfma_f32_16x16x32_bf16 v[168:171], v[120:123], v[84:87], v[168:171]
    v_mfma_f32_16x16x32_bf16 v[172:175], v[124:127], v[84:87], v[172:175]
    ds_read_b128 v[88:91], v27 offset:6144
    ds_read_b128 v[92:95], v28 offset:6144
    s_waitcnt lgkmcnt(11)
    v_mfma_f32_16x16x32_bf16 v[128:131], v[32:35], a[0:3], v[128:131]
    ds_read_b64_tr_b16 v[48:49], v16 offset:8192
    s_waitcnt lgkmcnt(11)
    v_mfma_f32_16x16x32_bf16 v[144:147], v[32:35], a[4:7], v[144:147]
    ds_read_b64_tr_b16 v[50:51], v16 offset:9216
    s_waitcnt lgkmcnt(11)
    v_mfma_f32_16x16x32_bf16 v[160:163], v[32:35], a[8:11], v[160:163]
    ds_read_b128 a[16:19], v21 offset:0
    s_waitcnt lgkmcnt(11)
    v_mfma_f32_16x16x32_bf16 v[176:179], v[32:35], a[12:15], v[176:179]
    ds_read_b128 a[20:23], v21 offset:2048
    s_waitcnt lgkmcnt(10)
    v_mfma_f32_16x16x32_bf16 v[132:135], v[36:39], a[0:3], v[132:135]
    ds_read_b128 a[24:27], v21 offset:4096
    v_mfma_f32_16x16x32_bf16 v[148:151], v[36:39], a[4:7], v[148:151]
    ds_read_b128 a[28:31], v21 offset:6144
    v_mfma_f32_16x16x32_bf16 v[164:167], v[36:39], a[8:11], v[164:167]
    ds_read_b64_tr_b16 v[52:53], v16 offset:8200
    v_mfma_f32_16x16x32_bf16 v[180:183], v[36:39], a[12:15], v[180:183]
    s_waitcnt lgkmcnt(7)
    ds_read_b64_tr_b16 v[54:55], v16 offset:9224
    v_mfma_f32_16x16x32_bf16 v[136:139], v[40:43], a[0:3], v[136:139]
    ds_read_b64_tr_b16 v[56:57], v17 offset:8192
    v_mfma_f32_16x16x32_bf16 v[152:155], v[40:43], a[4:7], v[152:155]
    ds_read_b64_tr_b16 v[58:59], v17 offset:9216
    v_mfma_f32_16x16x32_bf16 v[168:171], v[40:43], a[8:11], v[168:171]
    ds_read_b64_tr_b16 v[60:61], v17 offset:8200
    v_mfma_f32_16x16x32_bf16 v[184:187], v[40:43], a[12:15], v[184:187]
    ds_read_b64_tr_b16 v[62:63], v17 offset:9224
    v_mfma_f32_16x16x32_bf16 v[140:143], v[44:47], a[0:3], v[140:143]
    v_mfma_f32_16x16x32_bf16 v[156:159], v[44:47], a[4:7], v[156:159]
    v_mfma_f32_16x16x32_bf16 v[172:175], v[44:47], a[8:11], v[172:175]
    v_mfma_f32_16x16x32_bf16 v[188:191], v[44:47], a[12:15], v[188:191]
    v_mfma_f32_16x16x32_bf16 v[176:179], v[96:99], v[88:91], v[176:179]
    v_mfma_f32_16x16x32_bf16 v[180:183], v[100:103], v[88:91], v[180:183]
    v_mfma_f32_16x16x32_bf16 v[184:187], v[104:107], v[88:91], v[184:187]
    v_mfma_f32_16x16x32_bf16 v[188:191], v[108:111], v[88:91], v[188:191]
    v_mfma_f32_16x16x32_bf16 v[176:179], v[112:115], v[92:95], v[176:179]
    v_mfma_f32_16x16x32_bf16 v[180:183], v[116:119], v[92:95], v[180:183]
    v_mfma_f32_16x16x32_bf16 v[184:187], v[120:123], v[92:95], v[184:187]
    v_mfma_f32_16x16x32_bf16 v[188:191], v[124:127], v[92:95], v[188:191]
    s_waitcnt lgkmcnt(9)
    v_mfma_f32_16x16x32_bf16 v[128:131], v[48:51], a[16:19], v[128:131]
    s_waitcnt lgkmcnt(8)
    v_mfma_f32_16x16x32_bf16 v[144:147], v[48:51], a[20:23], v[144:147]
    s_waitcnt lgkmcnt(7)
    v_mfma_f32_16x16x32_bf16 v[160:163], v[48:51], a[24:27], v[160:163]
    s_waitcnt lgkmcnt(6)
    v_mfma_f32_16x16x32_bf16 v[176:179], v[48:51], a[28:31], v[176:179]
    s_waitcnt lgkmcnt(0)
    s_barrier
    ds_read_b64_tr_b16 v[32:33], v16 offset:32768
    v_mfma_f32_16x16x32_bf16 v[132:135], v[52:55], a[16:19], v[132:135]
    ds_read_b64_tr_b16 v[34:35], v16 offset:33792
    v_mfma_f32_16x16x32_bf16 v[148:151], v[52:55], a[20:23], v[148:151]
    ds_read_b128 a[0:3], v20 offset:32768
    v_mfma_f32_16x16x32_bf16 v[164:167], v[52:55], a[24:27], v[164:167]
    ds_read_b128 a[4:7], v20 offset:34816
    v_mfma_f32_16x16x32_bf16 v[180:183], v[52:55], a[28:31], v[180:183]
    ds_read_b128 a[8:11], v20 offset:36864
    v_mfma_f32_16x16x32_bf16 v[136:139], v[56:59], a[16:19], v[136:139]
    ds_read_b128 a[12:15], v20 offset:38912
    v_mfma_f32_16x16x32_bf16 v[152:155], v[56:59], a[20:23], v[152:155]
    ds_read_b64_tr_b16 v[36:37], v16 offset:32776
    v_mfma_f32_16x16x32_bf16 v[168:171], v[56:59], a[24:27], v[168:171]
    ds_read_b64_tr_b16 v[38:39], v16 offset:33800
    v_mfma_f32_16x16x32_bf16 v[184:187], v[56:59], a[28:31], v[184:187]
    ds_read_b64_tr_b16 v[40:41], v17 offset:32768
    v_mfma_f32_16x16x32_bf16 v[140:143], v[60:63], a[16:19], v[140:143]
    ds_read_b64_tr_b16 v[42:43], v17 offset:33792
    v_mfma_f32_16x16x32_bf16 v[156:159], v[60:63], a[20:23], v[156:159]
    ds_read_b64_tr_b16 v[44:45], v17 offset:32776
    v_mfma_f32_16x16x32_bf16 v[172:175], v[60:63], a[24:27], v[172:175]
    ds_read_b64_tr_b16 v[46:47], v17 offset:33800
    v_mfma_f32_16x16x32_bf16 v[188:191], v[60:63], a[28:31], v[188:191]
    s_waitcnt lgkmcnt(9)
    v_mfma_f32_16x16x32_bf16 v[128:131], v[32:35], a[0:3], v[128:131]
    ds_read_b64_tr_b16 v[48:49], v16 offset:40960
    s_waitcnt lgkmcnt(9)
    v_mfma_f32_16x16x32_bf16 v[144:147], v[32:35], a[4:7], v[144:147]
    ds_read_b64_tr_b16 v[50:51], v16 offset:41984
    s_waitcnt lgkmcnt(9)
    v_mfma_f32_16x16x32_bf16 v[160:163], v[32:35], a[8:11], v[160:163]
    ds_read_b128 a[16:19], v21 offset:32768
    s_waitcnt lgkmcnt(9)
    v_mfma_f32_16x16x32_bf16 v[176:179], v[32:35], a[12:15], v[176:179]
    ds_read_b128 a[20:23], v21 offset:34816
    s_waitcnt lgkmcnt(8)
    v_mfma_f32_16x16x32_bf16 v[132:135], v[36:39], a[0:3], v[132:135]
    ds_read_b128 a[24:27], v21 offset:36864
    v_mfma_f32_16x16x32_bf16 v[148:151], v[36:39], a[4:7], v[148:151]
    ds_read_b128 a[28:31], v21 offset:38912
    v_mfma_f32_16x16x32_bf16 v[164:167], v[36:39], a[8:11], v[164:167]
    ds_read_b64_tr_b16 v[52:53], v16 offset:40968
    v_mfma_f32_16x16x32_bf16 v[180:183], v[36:39], a[12:15], v[180:183]
    ds_read_b64_tr_b16 v[54:55], v16 offset:41992
    s_waitcnt lgkmcnt(10)
    v_mfma_f32_16x16x32_bf16 v[136:139], v[40:43], a[0:3], v[136:139]
    ds_read_b64_tr_b16 v[56:57], v17 offset:40960
    v_mfma_f32_16x16x32_bf16 v[152:155], v[40:43], a[4:7], v[152:155]
    ds_read_b64_tr_b16 v[58:59], v17 offset:41984
    v_mfma_f32_16x16x32_bf16 v[168:171], v[40:43], a[8:11], v[168:171]
    ds_read_b64_tr_b16 v[60:61], v17 offset:40968
    v_mfma_f32_16x16x32_bf16 v[184:187], v[40:43], a[12:15], v[184:187]
    ds_read_b64_tr_b16 v[62:63], v17 offset:41992
    s_waitcnt lgkmcnt(12)
    v_mfma_f32_16x16x32_bf16 v[140:143], v[44:47], a[0:3], v[140:143]
    v_mfma_f32_16x16x32_bf16 v[156:159], v[44:47], a[4:7], v[156:159]
    v_mfma_f32_16x16x32_bf16 v[172:175], v[44:47], a[8:11], v[172:175]
    v_mfma_f32_16x16x32_bf16 v[188:191], v[44:47], a[12:15], v[188:191]
    s_waitcnt lgkmcnt(9)
    v_mfma_f32_16x16x32_bf16 v[128:131], v[48:51], a[16:19], v[128:131]
    s_waitcnt lgkmcnt(8)
    v_mfma_f32_16x16x32_bf16 v[144:147], v[48:51], a[20:23], v[144:147]
    s_waitcnt lgkmcnt(7)
    v_mfma_f32_16x16x32_bf16 v[160:163], v[48:51], a[24:27], v[160:163]
    s_waitcnt lgkmcnt(6)
    v_mfma_f32_16x16x32_bf16 v[176:179], v[48:51], a[28:31], v[176:179]
    s_waitcnt lgkmcnt(0)
    s_barrier
    v_mfma_f32_16x16x32_bf16 v[132:135], v[52:55], a[16:19], v[132:135]
    v_mfma_f32_16x16x32_bf16 v[148:151], v[52:55], a[20:23], v[148:151]
    v_mfma_f32_16x16x32_bf16 v[164:167], v[52:55], a[24:27], v[164:167]
    v_mfma_f32_16x16x32_bf16 v[180:183], v[52:55], a[28:31], v[180:183]
    v_mfma_f32_16x16x32_bf16 v[136:139], v[56:59], a[16:19], v[136:139]
    v_mfma_f32_16x16x32_bf16 v[152:155], v[56:59], a[20:23], v[152:155]
    v_mfma_f32_16x16x32_bf16 v[168:171], v[56:59], a[24:27], v[168:171]
    v_mfma_f32_16x16x32_bf16 v[184:187], v[56:59], a[28:31], v[184:187]
    v_mfma_f32_16x16x32_bf16 v[140:143], v[60:63], a[16:19], v[140:143]
    v_mfma_f32_16x16x32_bf16 v[156:159], v[60:63], a[20:23], v[156:159]
    v_mfma_f32_16x16x32_bf16 v[172:175], v[60:63], a[24:27], v[172:175]
    v_mfma_f32_16x16x32_bf16 v[188:191], v[60:63], a[28:31], v[188:191]
    s_nop 7
    v_add_f32 v32, v128, v129
    v_add_f32 v33, v130, v131
    v_add_f32 v32, v32, v132
    v_add_f32 v33, v33, v133
    v_add_f32 v32, v32, v134
    v_add_f32 v33, v33, v135
    v_add_f32 v32, v32, v136
    v_add_f32 v33, v33, v137
    v_add_f32 v32, v32, v138
    v_add_f32 v33, v33, v139
    v_add_f32 v32, v32, v140
    v_add_f32 v33, v33, v141
    v_add_f32 v32, v32, v142
    v_add_f32 v33, v33, v143
    v_add_f32 v32, v32, v33
    v_add_f32 v36, v144, v145
    v_add_f32 v37, v146, v147
    v_add_f32 v36, v36, v148
    v_add_f32 v37, v37, v149
    v_add_f32 v36, v36, v150
    v_add_f32 v37, v37, v151
    v_add_f32 v36, v36, v152
    v_add_f32 v37, v37, v153
    v_add_f32 v36, v36, v154
    v_add_f32 v37, v37, v155
    v_add_f32 v36, v36, v156
    v_add_f32 v37, v37, v157
    v_add_f32 v36, v36, v158
    v_add_f32 v37, v37, v159
    v_add_f32 v36, v36, v37
    v_add_f32 v40, v160, v161
    v_add_f32 v41, v162, v163
    v_add_f32 v40, v40, v164
    v_add_f32 v41, v41, v165
    v_add_f32 v40, v40, v166
    v_add_f32 v41, v41, v167
    v_add_f32 v40, v40, v168
    v_add_f32 v41, v41, v169
    v_add_f32 v40, v40, v170
    v_add_f32 v41, v41, v171
    v_add_f32 v40, v40, v172
    v_add_f32 v41, v41, v173
    v_add_f32 v40, v40, v174
    v_add_f32 v41, v41, v175
    v_add_f32 v40, v40, v41
    v_add_f32 v44, v176, v177
    v_add_f32 v45, v178, v179
    v_add_f32 v44, v44, v180
    v_add_f32 v45, v45, v181
    v_add_f32 v44, v44, v182
    v_add_f32 v45, v45, v183
    v_add_f32 v44, v44, v184
    v_add_f32 v45, v45, v185
    v_add_f32 v44, v44, v186
    v_add_f32 v45, v45, v187
    v_add_f32 v44, v44, v188
    v_add_f32 v45, v45, v189
    v_add_f32 v44, v44, v190
    v_add_f32 v45, v45, v191
    v_add_f32 v44, v44, v45
    v_mov_b32 v33, v32
    v_mov_b32 v37, v36
    v_mov_b32 v41, v40
    v_mov_b32 v45, v44
    s_nop 0
    v_permlane32_swap_b32 v32, v33
    v_permlane32_swap_b32 v36, v37
    v_permlane32_swap_b32 v40, v41
    v_permlane32_swap_b32 v44, v45
    v_add_f32 v32, v32, v33
    v_add_f32 v36, v36, v37
    v_add_f32 v40, v40, v41
    v_add_f32 v44, v44, v45
    v_mov_b32 v33, v32
    v_mov_b32 v37, v36
    v_mov_b32 v41, v40
    v_mov_b32 v45, v44
    s_nop 0
    v_permlane16_swap_b32 v32, v33
    v_permlane16_swap_b32 v36, v37
    v_permlane16_swap_b32 v40, v41
    v_permlane16_swap_b32 v44, v45
    v_add_f32 v32, v32, v33
    v_add_f32 v36, v36, v37
    v_add_f32 v40, v40, v41
    v_add_f32 v44, v44, v45
    v_mul_f32 v192, 0xbc800000, v32
    v_mul_f32 v194, 0xbc800000, v36
    v_mul_f32 v196, 0xbc800000, v40
    v_mul_f32 v198, 0xbc800000, v44
    s_barrier
    s_cmp_ge_u32 s57, 2
    s_cbranch_scc1 L1_hz_sd
    v_cvt_pk_bf16_f32 v64, v128, v129
    v_cvt_pk_bf16_f32 v65, v130, v131
    v_cvt_pk_bf16_f32 v66, v132, v133
    v_cvt_pk_bf16_f32 v67, v134, v135
    buffer_store_dwordx4 v[64:67], v26, s[20:23], 0 offen offset:0
    v_cvt_pk_bf16_f32 v68, v136, v137
    v_cvt_pk_bf16_f32 v69, v138, v139
    v_cvt_pk_bf16_f32 v70, v140, v141
    v_cvt_pk_bf16_f32 v71, v142, v143
    buffer_store_dwordx4 v[68:71], v26, s[20:23], 0 offen offset:256
    v_cvt_pk_bf16_f32 v72, -v144, -v145
    v_cvt_pk_bf16_f32 v73, -v146, -v147
    v_cvt_pk_bf16_f32 v74, -v148, -v149
    v_cvt_pk_bf16_f32 v75, -v150, -v151
    buffer_store_dwordx4 v[72:75], v26, s[20:23], s51 offen offset:0
    v_cvt_pk_bf16_f32 v76, -v152, -v153
    v_cvt_pk_bf16_f32 v77, -v154, -v155
    v_cvt_pk_bf16_f32 v78, -v156, -v157
    v_cvt_pk_bf16_f32 v79, -v158, -v159
    buffer_store_dwordx4 v[76:79], v26, s[20:23], s51 offen offset:256
    v_cvt_pk_bf16_f32 v80, v160, v161
    v_cvt_pk_bf16_f32 v81, v162, v163
    v_cvt_pk_bf16_f32 v82, v164, v165
    v_cvt_pk_bf16_f32 v83, v166, v167
    buffer_store_dwordx4 v[80:83], v26, s[20:23], s52 offen offset:0
    v_cvt_pk_bf16_f32 v84, v168, v169
    v_cvt_pk_bf16_f32 v85, v170, v171
    v_cvt_pk_bf16_f32 v86, v172, v173
    v_cvt_pk_bf16_f32 v87, v174, v175
    buffer_store_dwordx4 v[84:87], v26, s[20:23], s52 offen offset:256
    v_cvt_pk_bf16_f32 v88, -v176, -v177
    v_cvt_pk_bf16_f32 v89, -v178, -v179
    v_cvt_pk_bf16_f32 v90, -v180, -v181
    v_cvt_pk_bf16_f32 v91, -v182, -v183
    buffer_store_dwordx4 v[88:91], v26, s[20:23], s53 offen offset:0
    v_cvt_pk_bf16_f32 v92, -v184, -v185
    v_cvt_pk_bf16_f32 v93, -v186, -v187
    v_cvt_pk_bf16_f32 v94, -v188, -v189
    v_cvt_pk_bf16_f32 v95, -v190, -v191
    buffer_store_dwordx4 v[92:95], v26, s[20:23], s53 offen offset:256
    s_branch L1_hz_done
L1_hz_sd:
    v_add_f32 v96, v128, v144
    v_add_f32 v97, v129, v145
    v_sub_f32 v98, v128, v144
    v_sub_f32 v99, v129, v145
    v_cvt_pk_bf16_f32 v64, v96, v97
    v_cvt_pk_bf16_f32 v72, v98, v99
    v_add_f32 v100, v130, v146
    v_add_f32 v101, v131, v147
    v_sub_f32 v102, v130, v146
    v_sub_f32 v103, v131, v147
    v_cvt_pk_bf16_f32 v65, v100, v101
    v_cvt_pk_bf16_f32 v73, v102, v103
    v_add_f32 v96, v132, v148
    v_add_f32 v97, v133, v149
    v_sub_f32 v98, v132, v148
    v_sub_f32 v99, v133, v149
    v_cvt_pk_bf16_f32 v66, v96, v97
    v_cvt_pk_bf16_f32 v74, v98, v99
    v_add_f32 v100, v134, v150
    v_add_f32 v101, v135, v151
    v_sub_f32 v102, v134, v150
    v_sub_f32 v103, v135, v151
    v_cvt_pk_bf16_f32 v67, v100, v101
    v_cvt_pk_bf16_f32 v75, v102, v103
    buffer_store_dwordx4 v[64:67], v26, s[20:23], 0 offen offset:0
    buffer_store_dwordx4 v[72:75], v26, s[20:23], s51 offen offset:0
    v_add_f32 v96, v136, v152
    v_add_f32 v97, v137, v153
    v_sub_f32 v98, v136, v152
    v_sub_f32 v99, v137, v153
    v_cvt_pk_bf16_f32 v68, v96, v97
    v_cvt_pk_bf16_f32 v76, v98, v99
    v_add_f32 v100, v138, v154
    v_add_f32 v101, v139, v155
    v_sub_f32 v102, v138, v154
    v_sub_f32 v103, v139, v155
    v_cvt_pk_bf16_f32 v69, v100, v101
    v_cvt_pk_bf16_f32 v77, v102, v103
    v_add_f32 v96, v140, v156
    v_add_f32 v97, v141, v157
    v_sub_f32 v98, v140, v156
    v_sub_f32 v99, v141, v157
    v_cvt_pk_bf16_f32 v70, v96, v97
    v_cvt_pk_bf16_f32 v78, v98, v99
    v_add_f32 v100, v142, v158
    v_add_f32 v101, v143, v159
    v_sub_f32 v102, v142, v158
    v_sub_f32 v103, v143, v159
    v_cvt_pk_bf16_f32 v71, v100, v101
    v_cvt_pk_bf16_f32 v79, v102, v103
    buffer_store_dwordx4 v[68:71], v26, s[20:23], 0 offen offset:256
    buffer_store_dwordx4 v[76:79], v26, s[20:23], s51 offen offset:256
    v_add_f32 v96, v160, v176
    v_add_f32 v97, v161, v177
    v_sub_f32 v98, v160, v176
    v_sub_f32 v99, v161, v177
    v_cvt_pk_bf16_f32 v80, v96, v97
    v_cvt_pk_bf16_f32 v88, v98, v99
    v_add_f32 v100, v162, v178
    v_add_f32 v101, v163, v179
    v_sub_f32 v102, v162, v178
    v_sub_f32 v103, v163, v179
    v_cvt_pk_bf16_f32 v81, v100, v101
    v_cvt_pk_bf16_f32 v89, v102, v103
    v_add_f32 v96, v164, v180
    v_add_f32 v97, v165, v181
    v_sub_f32 v98, v164, v180
    v_sub_f32 v99, v165, v181
    v_cvt_pk_bf16_f32 v82, v96, v97
    v_cvt_pk_bf16_f32 v90, v98, v99
    v_add_f32 v100, v166, v182
    v_add_f32 v101, v167, v183
    v_sub_f32 v102, v166, v182
    v_sub_f32 v103, v167, v183
    v_cvt_pk_bf16_f32 v83, v100, v101
    v_cvt_pk_bf16_f32 v91, v102, v103
    buffer_store_dwordx4 v[80:83], v26, s[20:23], s52 offen offset:0
    buffer_store_dwordx4 v[88:91], v26, s[20:23], s53 offen offset:0
    v_add_f32 v96, v168, v184
    v_add_f32 v97, v169, v185
    v_sub_f32 v98, v168, v184
    v_sub_f32 v99, v169, v185
    v_cvt_pk_bf16_f32 v84, v96, v97
    v_cvt_pk_bf16_f32 v92, v98, v99
    v_add_f32 v100, v170, v186
    v_add_f32 v101, v171, v187
    v_sub_f32 v102, v170, v186
    v_sub_f32 v103, v171, v187
    v_cvt_pk_bf16_f32 v85, v100, v101
    v_cvt_pk_bf16_f32 v93, v102, v103
    v_add_f32 v96, v172, v188
    v_add_f32 v97, v173, v189
    v_sub_f32 v98, v172, v188
    v_sub_f32 v99, v173, v189
    v_cvt_pk_bf16_f32 v86, v96, v97
    v_cvt_pk_bf16_f32 v94, v98, v99
    v_add_f32 v100, v174, v190
    v_add_f32 v101, v175, v191
    v_sub_f32 v102, v174, v190
    v_sub_f32 v103, v175, v191
    v_cvt_pk_bf16_f32 v87, v100, v101
    v_cvt_pk_bf16_f32 v95, v102, v103
    buffer_store_dwordx4 v[84:87], v26, s[20:23], s52 offen offset:256
    buffer_store_dwordx4 v[92:95], v26, s[20:23], s53 offen offset:256
L1_hz_done:
    s_barrier
    v_add_f32 v128, v128, v192
    v_mul_f32 v32, v128, v128
    v_add_f32 v129, v129, v192
    v_mul_f32 v33, v129, v129
    v_add_f32 v130, v130, v192
    v_fmac_f32 v32, v130, v130
    v_add_f32 v131, v131, v192
    v_fmac_f32 v33, v131, v131
    v_add_f32 v132, v132, v192
    v_fmac_f32 v32, v132, v132
    v_add_f32 v133, v133, v192
    v_fmac_f32 v33, v133, v133
    v_add_f32 v134, v134, v192
    v_fmac_f32 v32, v134, v134
    v_add_f32 v135, v135, v192
    v_fmac_f32 v33, v135, v135
    v_add_f32 v136, v136, v192
    v_fmac_f32 v32, v136, v136
    v_add_f32 v137, v137, v192
    v_fmac_f32 v33, v137, v137
    v_add_f32 v138, v138, v192
    v_fmac_f32 v32, v138, v138
    v_add_f32 v139, v139, v192
    v_fmac_f32 v33, v139, v139
    v_add_f32 v140, v140, v192
    v_fmac_f32 v32, v140, v140
    v_add_f32 v141, v141, v192
    v_fmac_f32 v33, v141, v141
    v_add_f32 v142, v142, v192
    v_fmac_f32 v32, v142, v142
    v_add_f32 v143, v143, v192
    v_fmac_f32 v33, v143, v143
    v_add_f32 v32, v32, v33
    v_add_f32 v144, v144, v194
    v_mul_f32 v36, v144, v144
    v_add_f32 v145, v145, v194
    v_mul_f32 v37, v145, v145
    v_add_f32 v146, v146, v194
    v_fmac_f32 v36, v146, v146
    v_add_f32 v147, v147, v194
    v_fmac_f32 v37, v147, v147
    v_add_f32 v148, v148, v194
    v_fmac_f32 v36, v148, v148
    v_add_f32 v149, v149, v194
    v_fmac_f32 v37, v149, v149
    v_add_f32 v150, v150, v194
    v_fmac_f32 v36, v150, v150
    v_add_f32 v151, v151, v194
    v_fmac_f32 v37, v151, v151
    v_add_f32 v152, v152, v194
    v_fmac_f32 v36, v152, v152
    v_add_f32 v153, v153, v194
    v_fmac_f32 v37, v153, v153
    v_add_f32 v154, v154, v194
    v_fmac_f32 v36, v154, v154
    v_add_f32 v155, v155, v194
    v_fmac_f32 v37, v155, v155
    v_add_f32 v156, v156, v194
    v_fmac_f32 v36, v156, v156
    v_add_f32 v157, v157, v194
    v_fmac_f32 v37, v157, v157
    v_add_f32 v158, v158, v194
    v_fmac_f32 v36, v158, v158
    v_add_f32 v159, v159, v194
    v_fmac_f32 v37, v159, v159
    v_add_f32 v36, v36, v37
    v_add_f32 v160, v160, v196
    v_mul_f32 v40, v160, v160
    v_add_f32 v161, v161, v196
    v_mul_f32 v41, v161, v161
    v_add_f32 v162, v162, v196
    v_fmac_f32 v40, v162, v162
    v_add_f32 v163, v163, v196
    v_fmac_f32 v41, v163, v163
    v_add_f32 v164, v164, v196
    v_fmac_f32 v40, v164, v164
    v_add_f32 v165, v165, v196
    v_fmac_f32 v41, v165, v165
    v_add_f32 v166, v166, v196
    v_fmac_f32 v40, v166, v166
    v_add_f32 v167, v167, v196
    v_fmac_f32 v41, v167, v167
    v_add_f32 v168, v168, v196
    v_fmac_f32 v40, v168, v168
    v_add_f32 v169, v169, v196
    v_fmac_f32 v41, v169, v169
    v_add_f32 v170, v170, v196
    v_fmac_f32 v40, v170, v170
    v_add_f32 v171, v171, v196
    v_fmac_f32 v41, v171, v171
    v_add_f32 v172, v172, v196
    v_fmac_f32 v40, v172, v172
    v_add_f32 v173, v173, v196
    v_fmac_f32 v41, v173, v173
    v_add_f32 v174, v174, v196
    v_fmac_f32 v40, v174, v174
    v_add_f32 v175, v175, v196
    v_fmac_f32 v41, v175, v175
    v_add_f32 v40, v40, v41
    v_add_f32 v176, v176, v198
    v_mul_f32 v44, v176, v176
    v_add_f32 v177, v177, v198
    v_mul_f32 v45, v177, v177
    v_add_f32 v178, v178, v198
    v_fmac_f32 v44, v178, v178
    v_add_f32 v179, v179, v198
    v_fmac_f32 v45, v179, v179
    v_add_f32 v180, v180, v198
    v_fmac_f32 v44, v180, v180
    v_add_f32 v181, v181, v198
    v_fmac_f32 v45, v181, v181
    v_add_f32 v182, v182, v198
    v_fmac_f32 v44, v182, v182
    v_add_f32 v183, v183, v198
    v_fmac_f32 v45, v183, v183
    v_add_f32 v184, v184, v198
    v_fmac_f32 v44, v184, v184
    v_add_f32 v185, v185, v198
    v_fmac_f32 v45, v185, v185
    v_add_f32 v186, v186, v198
    v_fmac_f32 v44, v186, v186
    v_add_f32 v187, v187, v198
    v_fmac_f32 v45, v187, v187
    v_add_f32 v188, v188, v198
    v_fmac_f32 v44, v188, v188
    v_add_f32 v189, v189, v198
    v_fmac_f32 v45, v189, v189
    v_add_f32 v190, v190, v198
    v_fmac_f32 v44, v190, v190
    v_add_f32 v191, v191, v198
    v_fmac_f32 v45, v191, v191
    v_add_f32 v44, v44, v45
    v_cmp_eq_u32 vcc, 1, v11
    v_mov_b32 v60, v192
    v_permlane32_swap_b32 v32, v36
    v_cndmask_b32 v60, v60, v196, vcc
    v_cmp_eq_u32 vcc, 2, v11
    v_permlane32_swap_b32 v40, v44
    v_add_f32 v32, v32, v36
    v_add_f32 v40, v40, v44
    v_cndmask_b32 v60, v60, v194, vcc
    v_cmp_eq_u32 vcc, 3, v11
    v_permlane16_swap_b32 v32, v40
    v_add_f32 v62, v32, v40
    v_cndmask_b32 v60, v60, v198, vcc
    v_mov_b32 v61, s62
    v_mov_b32 v63, s62
    buffer_store_dwordx4 v[60:63], v29, s[20:23], s94 offen sc1
    s_barrier
    s_mul_i32 s63, s55, 768
    s_add_u32 s63, s63, L2_begin-L1_begin
    v_min_u32 v2, 5, v10
    v_lshlrev_b32 v2, 7, v2
    v_add_u32 v2, s63, v2
    v_min_u32 v2, L2_slow-L1_begin, v2
    v_mov_b32 v3, s93
    v_add_co_u32 v2, vcc, s92, v2
    s_nop 1
    v_addc_co_u32 v3, vcc, 0, v3, vcc
    s_cmp_eq_u32 s3, 0
    s_cbranch_scc0 L1_nocp
    global_load_dword v8, v[2:3], off
L1_nocp:
    s_barrier
    s_barrier
    s_barrier
    s_barrier
    buffer_load_dwordx4 v[96:99], v30, s[20:23], s61 offen offset:0 sc1
    buffer_load_dwordx4 v[100:103], v30, s[20:23], s61 offen offset:1024 sc1
    buffer_load_dwordx4 v[104:107], v30, s[20:23], s61 offen offset:2048 sc1
    buffer_load_dwordx4 v[108:111], v30, s[20:23], s61 offen offset:3072 sc1
    buffer_load_dwordx4 v[112:115], v30, s[20:23], s90 offen offset:0 sc1
    buffer_load_dwordx4 v[116:119], v30, s[20:23], s90 offen offset:1024 sc1
    buffer_load_dwordx4 v[120:123], v30, s[20:23], s90 offen offset:2048 sc1
    buffer_load_dwordx4 v[124:127], v30, s[20:23], s90 offen offset:3072 sc1
    s_branch L1_first
L1_poll:
    buffer_load_dwordx4 v[96:99], v30, s[20:23], s61 offen offset:0 sc1
    buffer_load_dwordx4 v[100:103], v30, s[20:23], s61 offen offset:1024 sc1
    buffer_load_dwordx4 v[104:107], v30, s[20:23], s61 offen offset:2048 sc1
    buffer_load_dwordx4 v[108:111], v30, s[20:23], s61 offen offset:3072 sc1
    buffer_load_dwordx4 v[112:115], v30, s[20:23], s90 offen offset:0 sc1
    buffer_load_dwordx4 v[116:119], v30, s[20:23], s90 offen offset:1024 sc1
    buffer_load_dwordx4 v[120:123], v30, s[20:23], s90 offen offset:2048 sc1
    buffer_load_dwordx4 v[124:127], v30, s[20:23], s90 offen offset:3072 sc1
L1_first:
    v_and_b32 v15, 7, v10
    v_lshlrev_b32 v15, 10, v15
    v_add_u32 v15, 1012, v15
    s_waitcnt vmcnt(0)
    v_and_b32 v13, v97, v99
    v_or_b32 v14, v97, v99
    v_bitop3_b32 v13, v13, v101, v103 bitop3:0x80
    v_or3_b32 v14, v14, v101, v103
    v_bitop3_b32 v13, v13, v105, v107 bitop3:0x80
    v_or3_b32 v14, v14, v105, v107
    v_bitop3_b32 v13, v13, v109, v111 bitop3:0x80
    v_or3_b32 v14, v14, v109, v111
    v_bitop3_b32 v13, v13, v113, v115 bitop3:0x80
    v_or3_b32 v14, v14, v113, v115
    v_bitop3_b32 v13, v13, v117, v119 bitop3:0x80
    v_or3_b32 v14, v14, v117, v119
    v_bitop3_b32 v13, v13, v121, v123 bitop3:0x80
    v_or3_b32 v14, v14, v121, v123
    v_bitop3_b32 v13, v13, v125, v127 bitop3:0x80
    v_or3_b32 v14, v14, v125, v127
    v_xor_b32 v13, s62, v13
    v_xor_b32 v14, s62, v14
    v_or_b32 v13, v13, v14
    v_cmp_ne_u32 vcc, 0, v13
    s_cmp_eq_u64 vcc, 0
    s_cbranch_scc1 L1_polled
L1_probe:
    s_sleep 4
    buffer_load_dword v13, v15, s[20:23], s61 offen sc1
    s_waitcnt vmcnt(0)
    v_cmp_ne_u32 vcc, s62, v13
    s_cmp_eq_u64 vcc, 0
    s_cbranch_scc0 L1_probe
    s_branch L1_poll
L1_polled:
    v_mov_b32 v36, s62
    v_mov_b32 v37, s89
    buffer_store_dword v36, v37, s[20:23], 0 offen
    v_add_f32 v32, v96, v100
    v_add_f32 v33, v104, v108
    v_add_f32 v32, v32, v112
    v_add_f32 v33, v33, v116
    v_add_f32 v32, v32, v120
    v_add_f32 v33, v33, v124
    v_add_f32 v32, v32, v33
    v_add_f32 v34, v98, v102
    v_add_f32 v35, v106, v110
    v_add_f32 v34, v34, v114
    v_add_f32 v35, v35, v118
    v_add_f32 v34, v34, v122
    v_add_f32 v35, v35, v126
    v_add_f32 v34, v34, v35
    v_mul_f32 v60, 0x3e000000, v32
    v_sub_f32 v96, v96, v60
    v_sub_f32 v100, v100, v60
    v_sub_f32 v104, v104, v60
    v_sub_f32 v108, v108, v60
    v_sub_f32 v112, v112, v60
    v_sub_f32 v116, v116, v60
    v_sub_f32 v120, v120, v60
    v_sub_f32 v124, v124, v60
    v_mul_f32 v32, v96, v96
    v_mul_f32 v33, v100, v100
    v_fmac_f32 v32, v104, v104
    v_fmac_f32 v33, v108, v108
    v_fmac_f32 v32, v112, v112
    v_fmac_f32 v33, v116, v116
    v_fmac_f32 v32, v120, v120
    v_fmac_f32 v33, v124, v124
    v_add_f32 v32, v32, v33
    v_fmac_f32 v34, 0x42800000, v32
    v_mov_b32 v63, 0x3727c5ac
    v_fmac_f32 v63, 0x3b000000, v34
    v_rsq_f32 v61, v63
    v_sqrt_f32 v62, v63
    s_nop 0
    v_mul_f32 v61, 0xbfb8aa3b, v61
    v_mul_f32 v62, 0x3a800000, v62
    ds_write_b128 v31, v[60:63]
    ds_read_b128 v[32:35], v9 offset:0
    ds_read_b128 v[36:39], v9 offset:256
    ds_read_b128 v[40:43], v9 offset:512
    ds_read_b128 v[44:47], v9 offset:768
    s_waitcnt lgkmcnt(3)
    v_sub_f32 v32, v32, v192
    v_pk_add_f32 v[128:129], v[128:129], v[32:33] op_sel_hi:[1,0]
    v_pk_mul_f32 v[96:97], v[128:129], v[32:33] op_sel:[0,1] op_sel_hi:[1,1]
    v_pk_add_f32 v[130:131], v[130:131], v[32:33] op_sel_hi:[1,0]
    v_pk_mul_f32 v[98:99], v[130:131], v[32:33] op_sel:[0,1] op_sel_hi:[1,1]
    v_pk_add_f32 v[132:133], v[132:133], v[32:33] op_sel_hi:[1,0]
    v_pk_mul_f32 v[100:101], v[132:133], v[32:33] op_sel:[0,1] op_sel_hi:[1,1]
    v_pk_add_f32 v[134:135], v[134:135], v[32:33] op_sel_hi:[1,0]
    v_pk_mul_f32 v[102:103], v[134:135], v[32:33] op_sel:[0,1] op_sel_hi:[1,1]
    v_pk_add_f32 v[136:137], v[136:137], v[32:33] op_sel_hi:[1,0]
    v_pk_mul_f32 v[104:105], v[136:137], v[32:33] op_sel:[0,1] op_sel_hi:[1,1]
    v_pk_add_f32 v[138:139], v[138:139], v[32:33] op_sel_hi:[1,0]
    v_pk_mul_f32 v[106:107], v[138:139], v[32:33] op_sel:[0,1] op_sel_hi:[1,1]
    v_pk_add_f32 v[140:141], v[140:141], v[32:33] op_sel_hi:[1,0]
    v_pk_mul_f32 v[108:109], v[140:141], v[32:33] op_sel:[0,1] op_sel_hi:[1,1]
    v_pk_add_f32 v[142:143], v[142:143], v[32:33] op_sel_hi:[1,0]
    v_pk_mul_f32 v[110:111], v[142:143], v[32:33] op_sel:[0,1] op_sel_hi:[1,1]
    v_exp_f32 v96, v96
    v_exp_f32 v97, v97
    v_exp_f32 v98, v98
    v_exp_f32 v99, v99
    v_exp_f32 v100, v100
    v_exp_f32 v101, v101
    v_exp_f32 v102, v102
    v_exp_f32 v103, v103
    v_exp_f32 v104, v104
    v_exp_f32 v105, v105
    v_exp_f32 v106, v106
    v_exp_f32 v107, v107
    v_exp_f32 v108, v108
    v_exp_f32 v109, v109
    v_exp_f32 v110, v110
    v_exp_f32 v111, v111
    v_pk_fma_f32 v[96:97], v[96:97], v[34:35], v[34:35] op_sel_hi:[1,0,0]
    v_pk_fma_f32 v[98:99], v[98:99], v[34:35], v[34:35] op_sel_hi:[1,0,0]
    v_pk_fma_f32 v[100:101], v[100:101], v[34:35], v[34:35] op_sel_hi:[1,0,0]
    v_pk_fma_f32 v[102:103], v[102:103], v[34:35], v[34:35] op_sel_hi:[1,0,0]
    v_pk_fma_f32 v[104:105], v[104:105], v[34:35], v[34:35] op_sel_hi:[1,0,0]
    v_pk_fma_f32 v[106:107], v[106:107], v[34:35], v[34:35] op_sel_hi:[1,0,0]
    v_pk_fma_f32 v[108:109], v[108:109], v[34:35], v[34:35] op_sel_hi:[1,0,0]
    v_pk_fma_f32 v[110:111], v[110:111], v[34:35], v[34:35] op_sel_hi:[1,0,0]
    v_rcp_f32 v96, v96
    v_rcp_f32 v97, v97
    v_rcp_f32 v98, v98
    v_rcp_f32 v99, v99
    v_rcp_f32 v100, v100
    v_rcp_f32 v101, v101
    v_rcp_f32 v102, v102
    v_rcp_f32 v103, v103
    v_rcp_f32 v104, v104
    v_rcp_f32 v105, v105
    v_rcp_f32 v106, v106
    v_rcp_f32 v107, v107
    v_rcp_f32 v108, v108
    v_rcp_f32 v109, v109
    v_rcp_f32 v110, v110
    v_rcp_f32 v111, v111
    v_pk_mul_f32 v[96:97], v[96:97], v[128:129]
    v_pk_mul_f32 v[98:99], v[98:99], v[130:131]
    v_pk_mul_f32 v[100:101], v[100:101], v[132:133]
    v_pk_mul_f32 v[102:103], v[102:103], v[134:135]
    v_pk_mul_f32 v[104:105], v[104:105], v[136:137]
    v_pk_mul_f32 v[106:107], v[106:107], v[138:139]
    v_pk_mul_f32 v[108:109], v[108:109], v[140:141]
    v_pk_mul_f32 v[110:111], v[110:111], v[142:143]
    v_cvt_pk_f16_f32 v200, v96, v97
    v_cvt_pk_f16_f32 v201, v98, v99
    v_cvt_pk_f16_f32 v202, v100, v101
    v_cvt_pk_f16_f32 v203, v102, v103
    v_pk_add_u16 v200, v200, s86
    v_pk_add_u16 v201, v201, s86
    v_pk_add_u16 v202, v202, s86
    v_pk_add_u16 v203, v203, s86
    v_and_b32 v200, s87, v200
    v_and_b32 v201, s87, v201
    v_and_b32 v202, s87, v202
    v_and_b32 v203, s87, v203
    buffer_store_dwordx4 v[200:203], v24, s[20:23], 0 offen offset:0
    v_cvt_pk_f16_f32 v204, v104, v105
    v_cvt_pk_f16_f32 v205, v106, v107
    v_cvt_pk_f16_f32 v206, v108, v109
    v_cvt_pk_f16_f32 v207, v110, v111
    v_pk_add_u16 v204, v204, s86
    v_pk_add_u16 v205, v205, s86
    v_pk_add_u16 v206, v206, s86
    v_pk_add_u16 v207, v207, s86
    v_and_b32 v204, s87, v204
    v_and_b32 v205, s87, v205
    v_and_b32 v206, s87, v206
    v_and_b32 v207, s87, v207
    buffer_store_dwordx4 v[204:207], v24, s[20:23], s48 offen offset:0
    s_waitcnt lgkmcnt(2)
    v_sub_f32 v36, v36, v194
    v_pk_add_f32 v[144:145], v[144:145], v[36:37] op_sel_hi:[1,0]
    v_pk_mul_f32 v[96:97], v[144:145], v[36:37] op_sel:[0,1] op_sel_hi:[1,1]
    v_pk_add_f32 v[146:147], v[146:147], v[36:37] op_sel_hi:[1,0]
    v_pk_mul_f32 v[98:99], v[146:147], v[36:37] op_sel:[0,1] op_sel_hi:[1,1]
    v_pk_add_f32 v[148:149], v[148:149], v[36:37] op_sel_hi:[1,0]
    v_pk_mul_f32 v[100:101], v[148:149], v[36:37] op_sel:[0,1] op_sel_hi:[1,1]
    v_pk_add_f32 v[150:151], v[150:151], v[36:37] op_sel_hi:[1,0]
    v_pk_mul_f32 v[102:103], v[150:151], v[36:37] op_sel:[0,1] op_sel_hi:[1,1]
    v_pk_add_f32 v[152:153], v[152:153], v[36:37] op_sel_hi:[1,0]
    v_pk_mul_f32 v[104:105], v[152:153], v[36:37] op_sel:[0,1] op_sel_hi:[1,1]
    v_pk_add_f32 v[154:155], v[154:155], v[36:37] op_sel_hi:[1,0]
    v_pk_mul_f32 v[106:107], v[154:155], v[36:37] op_sel:[0,1] op_sel_hi:[1,1]
    v_pk_add_f32 v[156:157], v[156:157], v[36:37] op_sel_hi:[1,0]
    v_pk_mul_f32 v[108:109], v[156:157], v[36:37] op_sel:[0,1] op_sel_hi:[1,1]
    v_pk_add_f32 v[158:159], v[158:159], v[36:37] op_sel_hi:[1,0]
    v_pk_mul_f32 v[110:111], v[158:159], v[36:37] op_sel:[0,1] op_sel_hi:[1,1]
    v_exp_f32 v96, v96
    v_exp_f32 v97, v97
    v_exp_f32 v98, v98
    v_exp_f32 v99, v99
    v_exp_f32 v100, v100
    v_exp_f32 v101, v101
    v_exp_f32 v102, v102
    v_exp_f32 v103, v103
    v_exp_f32 v104, v104
    v_exp_f32 v105, v105
    v_exp_f32 v106, v106
    v_exp_f32 v107, v107
    v_exp_f32 v108, v108
    v_exp_f32 v109, v109
    v_exp_f32 v110, v110
    v_exp_f32 v111, v111
    v_pk_fma_f32 v[96:97], v[96:97], v[38:39], v[38:39] op_sel_hi:[1,0,0]
    v_pk_fma_f32 v[98:99], v[98:99], v[38:39], v[38:39] op_sel_hi:[1,0,0]
    v_pk_fma_f32 v[100:101], v[100:101], v[38:39], v[38:39] op_sel_hi:[1,0,0]
    v_pk_fma_f32 v[102:103], v[102:103], v[38:39], v[38:39] op_sel_hi:[1,0,0]
    v_pk_fma_f32 v[104:105], v[104:105], v[38:39], v[38:39] op_sel_hi:[1,0,0]
    v_pk_fma_f32 v[106:107], v[106:107], v[38:39], v[38:39] op_sel_hi:[1,0,0]
    v_pk_fma_f32 v[108:109], v[108:109], v[38:39], v[38:39] op_sel_hi:[1,0,0]
    v_pk_fma_f32 v[110:111], v[110:111], v[38:39], v[38:39] op_sel_hi:[1,0,0]
    v_rcp_f32 v96, v96
    v_rcp_f32 v97, v97
    v_rcp_f32 v98, v98
    v_rcp_f32 v99, v99
    v_rcp_f32 v100, v100
    v_rcp_f32 v101, v101
    v_rcp_f32 v102, v102
    v_rcp_f32 v103, v103
    v_rcp_f32 v104, v104
    v_rcp_f32 v105, v105
    v_rcp_f32 v106, v106
    v_rcp_f32 v107, v107
    v_rcp_f32 v108, v108
    v_rcp_f32 v109, v109
    v_rcp_f32 v110, v110
    v_rcp_f32 v111, v111
    v_pk_mul_f32 v[96:97], v[96:97], v[144:145]
    v_pk_mul_f32 v[98:99], v[98:99], v[146:147]
    v_pk_mul_f32 v[100:101], v[100:101], v[148:149]
    v_pk_mul_f32 v[102:103], v[102:103], v[150:151]
    v_pk_mul_f32 v[104:105], v[104:105], v[152:153]
    v_pk_mul_f32 v[106:107], v[106:107], v[154:155]
    v_pk_mul_f32 v[108:109], v[108:109], v[156:157]
    v_pk_mul_f32 v[110:111], v[110:111], v[158:159]
    v_cvt_pk_f16_f32 v208, v96, v97
    v_cvt_pk_f16_f32 v209, v98, v99
    v_cvt_pk_f16_f32 v210, v100, v101
    v_cvt_pk_f16_f32 v211, v102, v103
    v_pk_add_u16 v208, v208, s86
    v_pk_add_u16 v209, v209, s86
    v_pk_add_u16 v210, v210, s86
    v_pk_add_u16 v211, v211, s86
    v_and_b32 v208, s87, v208
    v_and_b32 v209, s87, v209
    v_and_b32 v210, s87, v210
    v_and_b32 v211, s87, v211
    buffer_store_dwordx4 v[208:211], v24, s[20:23], 0 offen offset:560
    v_cvt_pk_f16_f32 v212, v104, v105
    v_cvt_pk_f16_f32 v213, v106, v107
    v_cvt_pk_f16_f32 v214, v108, v109
    v_cvt_pk_f16_f32 v215, v110, v111
    v_pk_add_u16 v212, v212, s86
    v_pk_add_u16 v213, v213, s86
    v_pk_add_u16 v214, v214, s86
    v_pk_add_u16 v215, v215, s86
    v_and_b32 v212, s87, v212
    v_and_b32 v213, s87, v213
    v_and_b32 v214, s87, v214
    v_and_b32 v215, s87, v215
    buffer_store_dwordx4 v[212:215], v24, s[20:23], s48 offen offset:560
    s_waitcnt lgkmcnt(1)
    v_sub_f32 v40, v40, v196
    v_pk_add_f32 v[160:161], v[160:161], v[40:41] op_sel_hi:[1,0]
    v_pk_mul_f32 v[96:97], v[160:161], v[40:41] op_sel:[0,1] op_sel_hi:[1,1]
    v_pk_add_f32 v[162:163], v[162:163], v[40:41] op_sel_hi:[1,0]
    v_pk_mul_f32 v[98:99], v[162:163], v[40:41] op_sel:[0,1] op_sel_hi:[1,1]
    v_pk_add_f32 v[164:165], v[164:165], v[40:41] op_sel_hi:[1,0]
    v_pk_mul_f32 v[100:101], v[164:165], v[40:41] op_sel:[0,1] op_sel_hi:[1,1]
    v_pk_add_f32 v[166:167], v[166:167], v[40:41] op_sel_hi:[1,0]
    v_pk_mul_f32 v[102:103], v[166:167], v[40:41] op_sel:[0,1] op_sel_hi:[1,1]
    v_pk_add_f32 v[168:169], v[168:169], v[40:41] op_sel_hi:[1,0]
    v_pk_mul_f32 v[104:105], v[168:169], v[40:41] op_sel:[0,1] op_sel_hi:[1,1]
    v_pk_add_f32 v[170:171], v[170:171], v[40:41] op_sel_hi:[1,0]
    v_pk_mul_f32 v[106:107], v[170:171], v[40:41] op_sel:[0,1] op_sel_hi:[1,1]
    v_pk_add_f32 v[172:173], v[172:173], v[40:41] op_sel_hi:[1,0]
    v_pk_mul_f32 v[108:109], v[172:173], v[40:41] op_sel:[0,1] op_sel_hi:[1,1]
    v_pk_add_f32 v[174:175], v[174:175], v[40:41] op_sel_hi:[1,0]
    v_pk_mul_f32 v[110:111], v[174:175], v[40:41] op_sel:[0,1] op_sel_hi:[1,1]
    v_exp_f32 v96, v96
    v_exp_f32 v97, v97
    v_exp_f32 v98, v98
    v_exp_f32 v99, v99
    v_exp_f32 v100, v100
    v_exp_f32 v101, v101
    v_exp_f32 v102, v102
    v_exp_f32 v103, v103
    v_exp_f32 v104, v104
    v_exp_f32 v105, v105
    v_exp_f32 v106, v106
    v_exp_f32 v107, v107
    v_exp_f32 v108, v108
    v_exp_f32 v109, v109
    v_exp_f32 v110, v110
    v_exp_f32 v111, v111
    v_pk_fma_f32 v[96:97], v[96:97], v[42:43], v[42:43] op_sel_hi:[1,0,0]
    v_pk_fma_f32 v[98:99], v[98:99], v[42:43], v[42:43] op_sel_hi:[1,0,0]
    v_pk_fma_f32 v[100:101], v[100:101], v[42:43], v[42:43] op_sel_hi:[1,0,0]
    v_pk_fma_f32 v[102:103], v[102:103], v[42:43], v[42:43] op_sel_hi:[1,0,0]
    v_pk_fma_f32 v[104:105], v[104:105], v[42:43], v[42:43] op_sel_hi:[1,0,0]
    v_pk_fma_f32 v[106:107], v[106:107], v[42:43], v[42:43] op_sel_hi:[1,0,0]
    v_pk_fma_f32 v[108:109], v[108:109], v[42:43], v[42:43] op_sel_hi:[1,0,0]
    v_pk_fma_f32 v[110:111], v[110:111], v[42:43], v[42:43] op_sel_hi:[1,0,0]
    v_rcp_f32 v96, v96
    v_rcp_f32 v97, v97
    v_rcp_f32 v98, v98
    v_rcp_f32 v99, v99
    v_rcp_f32 v100, v100
    v_rcp_f32 v101, v101
    v_rcp_f32 v102, v102
    v_rcp_f32 v103, v103
    v_rcp_f32 v104, v104
    v_rcp_f32 v105, v105
    v_rcp_f32 v106, v106
    v_rcp_f32 v107, v107
    v_rcp_f32 v108, v108
    v_rcp_f32 v109, v109
    v_rcp_f32 v110, v110
    v_rcp_f32 v111, v111
    v_pk_mul_f32 v[96:97], v[96:97], v[160:161]
    v_pk_mul_f32 v[98:99], v[98:99], v[162:163]
    v_pk_mul_f32 v[100:101], v[100:101], v[164:165]
    v_pk_mul_f32 v[102:103], v[102:103], v[166:167]
    v_pk_mul_f32 v[104:105], v[104:105], v[168:169]
    v_pk_mul_f32 v[106:107], v[106:107], v[170:171]
    v_pk_mul_f32 v[108:109], v[108:109], v[172:173]
    v_pk_mul_f32 v[110:111], v[110:111], v[174:175]
    v_cvt_pk_f16_f32 v216, v96, v97
    v_cvt_pk_f16_f32 v217, v98, v99
    v_cvt_pk_f16_f32 v218, v100, v101
    v_cvt_pk_f16_f32 v219, v102, v103
    v_pk_add_u16 v216, v216, s86
    v_pk_add_u16 v217, v217, s86
    v_pk_add_u16 v218, v218, s86
    v_pk_add_u16 v219, v219, s86
    v_and_b32 v216, s87, v216
    v_and_b32 v217, s87, v217
    v_and_b32 v218, s87, v218
    v_and_b32 v219, s87, v219
    buffer_store_dwordx4 v[216:219], v24, s[20:23], s49 offen offset:0
    v_cndmask_b32 v128, 0, v216, s[44:45]
    v_cndmask_b32 v128, v128, v208, s[46:47]
    v_cndmask_b32 v129, 0, v217, s[44:45]
    v_cndmask_b32 v129, v129, v209, s[46:47]
    v_cndmask_b32 v130, 0, v218, s[44:45]
    v_cndmask_b32 v130, v130, v210, s[46:47]
    v_cndmask_b32 v131, 0, v219, s[44:45]
    v_cndmask_b32 v131, v131, v211, s[46:47]
    buffer_store_dwordx4 v[128:131], v25, s[20:23], 0 offen
    v_cvt_pk_f16_f32 v220, v104, v105
    v_cvt_pk_f16_f32 v221, v106, v107
    v_cvt_pk_f16_f32 v222, v108, v109
    v_cvt_pk_f16_f32 v223, v110, v111
    v_pk_add_u16 v220, v220, s86
    v_pk_add_u16 v221, v221, s86
    v_pk_add_u16 v222, v222, s86
    v_pk_add_u16 v223, v223, s86
    v_and_b32 v220, s87, v220
    v_and_b32 v221, s87, v221
    v_and_b32 v222, s87, v222
    v_and_b32 v223, s87, v223
    buffer_store_dwordx4 v[220:223], v24, s[20:23], s50 offen offset:0
    v_cndmask_b32 v132, 0, v220, s[44:45]
    v_cndmask_b32 v132, v132, v212, s[46:47]
    v_cndmask_b32 v133, 0, v221, s[44:45]
    v_cndmask_b32 v133, v133, v213, s[46:47]
    v_cndmask_b32 v134, 0, v222, s[44:45]
    v_cndmask_b32 v134, v134, v214, s[46:47]
    v_cndmask_b32 v135, 0, v223, s[44:45]
    v_cndmask_b32 v135, v135, v215, s[46:47]
    buffer_store_dwordx4 v[132:135], v25, s[20:23], s48 offen
    s_waitcnt lgkmcnt(0)
    v_sub_f32 v44, v44, v198
    v_pk_add_f32 v[176:177], v[176:177], v[44:45] op_sel_hi:[1,0]
    v_pk_mul_f32 v[96:97], v[176:177], v[44:45] op_sel:[0,1] op_sel_hi:[1,1]
    v_pk_add_f32 v[178:179], v[178:179], v[44:45] op_sel_hi:[1,0]
    v_pk_mul_f32 v[98:99], v[178:179], v[44:45] op_sel:[0,1] op_sel_hi:[1,1]
    v_pk_add_f32 v[180:181], v[180:181], v[44:45] op_sel_hi:[1,0]
    v_pk_mul_f32 v[100:101], v[180:181], v[44:45] op_sel:[0,1] op_sel_hi:[1,1]
    v_pk_add_f32 v[182:183], v[182:183], v[44:45] op_sel_hi:[1,0]
    v_pk_mul_f32 v[102:103], v[182:183], v[44:45] op_sel:[0,1] op_sel_hi:[1,1]
    v_pk_add_f32 v[184:185], v[184:185], v[44:45] op_sel_hi:[1,0]
    v_pk_mul_f32 v[104:105], v[184:185], v[44:45] op_sel:[0,1] op_sel_hi:[1,1]
    v_pk_add_f32 v[186:187], v[186:187], v[44:45] op_sel_hi:[1,0]
    v_pk_mul_f32 v[106:107], v[186:187], v[44:45] op_sel:[0,1] op_sel_hi:[1,1]
    v_pk_add_f32 v[188:189], v[188:189], v[44:45] op_sel_hi:[1,0]
    v_pk_mul_f32 v[108:109], v[188:189], v[44:45] op_sel:[0,1] op_sel_hi:[1,1]
    v_pk_add_f32 v[190:191], v[190:191], v[44:45] op_sel_hi:[1,0]
    v_pk_mul_f32 v[110:111], v[190:191], v[44:45] op_sel:[0,1] op_sel_hi:[1,1]
    v_exp_f32 v96, v96
    v_exp_f32 v97, v97
    v_exp_f32 v98, v98
    v_exp_f32 v99, v99
    v_exp_f32 v100, v100
    v_exp_f32 v101, v101
    v_exp_f32 v102, v102
    v_exp_f32 v103, v103
    v_exp_f32 v104, v104
    v_exp_f32 v105, v105
    v_exp_f32 v106, v106
    v_exp_f32 v107, v107
    v_exp_f32 v108, v108
    v_exp_f32 v109, v109
    v_exp_f32 v110, v110
    v_exp_f32 v111, v111
    v_pk_fma_f32 v[96:97], v[96:97], v[46:47], v[46:47] op_sel_hi:[1,0,0]
    v_pk_fma_f32 v[98:99], v[98:99], v[46:47], v[46:47] op_sel_hi:[1,0,0]
    v_pk_fma_f32 v[100:101], v[100:101], v[46:47], v[46:47] op_sel_hi:[1,0,0]
    v_pk_fma_f32 v[102:103], v[102:103], v[46:47], v[46:47] op_sel_hi:[1,0,0]
    v_pk_fma_f32 v[104:105], v[104:105], v[46:47], v[46:47] op_sel_hi:[1,0,0]
    v_pk_fma_f32 v[106:107], v[106:107], v[46:47], v[46:47] op_sel_hi:[1,0,0]
    v_pk_fma_f32 v[108:109], v[108:109], v[46:47], v[46:47] op_sel_hi:[1,0,0]
    v_pk_fma_f32 v[110:111], v[110:111], v[46:47], v[46:47] op_sel_hi:[1,0,0]
    v_rcp_f32 v96, v96
    v_rcp_f32 v97, v97
    v_rcp_f32 v98, v98
    v_rcp_f32 v99, v99
    v_rcp_f32 v100, v100
    v_rcp_f32 v101, v101
    v_rcp_f32 v102, v102
    v_rcp_f32 v103, v103
    v_rcp_f32 v104, v104
    v_rcp_f32 v105, v105
    v_rcp_f32 v106, v106
    v_rcp_f32 v107, v107
    v_rcp_f32 v108, v108
    v_rcp_f32 v109, v109
    v_rcp_f32 v110, v110
    v_rcp_f32 v111, v111
    v_pk_mul_f32 v[96:97], v[96:97], v[176:177]
    v_pk_mul_f32 v[98:99], v[98:99], v[178:179]
    v_pk_mul_f32 v[100:101], v[100:101], v[180:181]
    v_pk_mul_f32 v[102:103], v[102:103], v[182:183]
    v_pk_mul_f32 v[104:105], v[104:105], v[184:185]
    v_pk_mul_f32 v[106:107], v[106:107], v[186:187]
    v_pk_mul_f32 v[108:109], v[108:109], v[188:189]
    v_pk_mul_f32 v[110:111], v[110:111], v[190:191]
    v_cvt_pk_f16_f32 v200, v96, v97
    v_cvt_pk_f16_f32 v201, v98, v99
    v_cvt_pk_f16_f32 v202, v100, v101
    v_cvt_pk_f16_f32 v203, v102, v103
    v_pk_add_u16 v200, v200, s86
    v_pk_add_u16 v201, v201, s86
    v_pk_add_u16 v202, v202, s86
    v_pk_add_u16 v203, v203, s86
    v_and_b32 v200, s87, v200
    v_and_b32 v201, s87, v201
    v_and_b32 v202, s87, v202
    v_and_b32 v203, s87, v203
    buffer_store_dwordx4 v[200:203], v24, s[20:23], s49 offen offset:560
    v_cvt_pk_f16_f32 v204, v104, v105
    v_cvt_pk_f16_f32 v205, v106, v107
    v_cvt_pk_f16_f32 v206, v108, v109
    v_cvt_pk_f16_f32 v207, v110, v111
    v_pk_add_u16 v204, v204, s86
    v_pk_add_u16 v205, v205, s86
    v_pk_add_u16 v206, v206, s86
    v_pk_add_u16 v207, v207, s86
    v_and_b32 v204, s87, v204
    v_and_b32 v205, s87, v205
    v_and_b32 v206, s87, v206
    v_and_b32 v207, s87, v207
    buffer_store_dwordx4 v[204:207], v24, s[20:23], s50 offen offset:560
    s_endpgm
.p2align 12
.text
.globl cn_conv_kernel
.p2align 8
.type cn_conv_kernel,@function
cn_conv_kernel:
L2_begin:
    s_cmp_ge_u32 s2, 256
    s_cbranch_scc1 L2_end
    s_load_dwordx2 s[4:5], s[0:1], 64
    s_load_dwordx2 s[6:7], s[0:1], 0
    s_load_dwordx2 s[66:67], s[0:1], 48
    v_lshrrev_b32 v19, 6, v0
    v_and_b32 v20, 63, v0
    v_lshlrev_b32 v1, 4, v20
    v_readfirstlane_b32 s3, v19
    v_add_u32 v2, 4096, v1
    v_add_u32 v3, 8192, v1
    s_and_b32 s52, s2, 7
    s_lshr_b32 s53, s2, 3
    s_and_b32 s54, s52, 1
    s_lshl_b32 s54, s54, 2
    s_and_b32 s58, s53, 3
    s_add_u32 s54, s54, s58
    s_lshr_b32 s55, s52, 1
    s_lshl_b32 s55, s55, 5
    s_lshr_b32 s58, s53, 3
    s_lshl_b32 s58, s58, 3
    s_add_u32 s55, s55, s58
    s_lshr_b32 s56, s53, 2
    s_and_b32 s56, s56, 1
    s_lshl_b32 s56, s56, 4
    s_and_b32 s57, s55, 63
    s_lshl_b32 s58, s54, 2
    s_add_u32 s58, s58, s3
    s_mul_i32 s25, s58, 229376
    s_add_u32 s25, s25, 18874368
    s_mov_b32 s65, 0
    s_mov_b32 s24, 0
    s_add_u32 s96, s25, 0
    s_mov_b32 s51, 557056
    s_add_u32 s97, s25, 12288
    s_mov_b32 s68, 1114112
    s_add_u32 s98, s25, 24576
    s_mov_b32 s69, 1671168
    s_add_u32 s99, s25, 36864
    s_add_u32 s25, s25, 196608
    s_lshl_b32 s30, s3, 10
    s_sub_u32 s59, s55, 1
    s_mul_i32 s59, s59, 1088
    s_mul_i32 s62, s56, 17408
    s_add_u32 s59, s59, s62
    s_cmp_eq_u32 s57, 0
    s_cselect_b32 s63, 68, 0
    s_cmp_eq_u32 s57, 56
    s_movk_i32 s64, 680
    s_cselect_b32 s64, 612, s64
    s_sub_u32 s64, s64, s63
    v_mov_b32 v26, 0x80000000
    v_lshlrev_b32 v21, 4, v0
    v_add_u32 v21, s59, v21
    v_subrev_u32 v22, s63, v0
    v_add_u32 v23, 0, v22
    v_add_u32 v8, 0, v21
    v_cmp_gt_u32 vcc, s64, v23
    s_nop 1
    v_cndmask_b32 v8, v26, v8, vcc
    v_add_u32 v23, 256, v22
    v_add_u32 v9, 4096, v21
    v_cmp_gt_u32 vcc, s64, v23
    s_nop 1
    v_cndmask_b32 v9, v26, v9, vcc
    v_cmp_gt_u32 vcc, 176, v0
    v_mov_b32 v23, -176
    v_mov_b32 v24, 136448
    v_mov_b32 v25, 512
    v_cndmask_b32 v23, v23, v25, vcc
    v_mov_b32 v25, 8192
    v_cndmask_b32 v24, v24, v25, vcc
    v_add_u32 v23, v22, v23
    v_add_u32 v10, v21, v24
    v_cmp_gt_u32 vcc, s64, v23
    s_nop 1
    v_cndmask_b32 v10, v26, v10, vcc
    v_add_u32 v23, 80, v22
    v_add_u32 v11, 140544, v21
    v_cmp_gt_u32 vcc, s64, v23
    s_nop 1
    v_cndmask_b32 v11, v26, v11, vcc
    v_add_u32 v23, 336, v22
    v_add_u32 v12, 144640, v21
    v_cmp_gt_u32 vcc, s64, v23
    s_nop 1
    v_cndmask_b32 v12, v26, v12, vcc
    v_add_u32 v23, 592, v22
    v_add_u32 v13, 148736, v21
    v_cmp_gt_u32 vcc, s64, v23
    s_nop 1
    v_cndmask_b32 v13, v26, v13, vcc
    s_waitcnt lgkmcnt(0)
    s_mov_b32 s12, s4
    s_and_b32 s13, s5, 0xffff
    s_mov_b32 s14, 0x10000000
    s_mov_b32 s15, 0x00020000
    s_mov_b32 s8, s4
    s_and_b32 s9, s5, 0xffff
    s_mov_b32 s10, 0x880000
    s_mov_b32 s11, 0x00020000
    s_add_u32 m0, s30, 0
    s_nop 0
    buffer_load_dwordx4 v8, s[8:11], s24 offen lds
    s_add_u32 m0, s30, 4096
    s_nop 0
    buffer_load_dwordx4 v9, s[8:11], s24 offen lds
    s_add_u32 m0, s30, 8192
    s_nop 0
    buffer_load_dwordx4 v10, s[8:11], s24 offen lds
    s_add_u32 m0, s30, 12288
    s_nop 0
    buffer_load_dwordx4 v11, s[8:11], s24 offen lds
    s_add_u32 m0, s30, 16384
    s_nop 0
    buffer_load_dwordx4 v12, s[8:11], s24 offen lds
    s_add_u32 m0, s30, 20480
    s_nop 0
    buffer_load_dwordx4 v13, s[8:11], s24 offen lds
    s_add_u32 s24, s24, 2228224
    buffer_load_dwordx4 a[0:3], v1, s[12:15], s96 offen offset:0
    buffer_load_dwordx4 a[4:7], v1, s[12:15], s96 offen offset:1024
    buffer_load_dwordx4 a[8:11], v1, s[12:15], s96 offen offset:2048
    buffer_load_dwordx4 a[12:15], v1, s[12:15], s96 offen offset:3072
    buffer_load_dwordx4 a[16:19], v2, s[12:15], s96 offen offset:0
    buffer_load_dwordx4 a[20:23], v2, s[12:15], s96 offen offset:1024
    buffer_load_dwordx4 a[24:27], v2, s[12:15], s96 offen offset:2048
    buffer_load_dwordx4 a[28:31], v2, s[12:15], s96 offen offset:3072
    s_lshl_b32 s58, s54, 7
    s_add_u32 s58, s58, 27262976
    s_add_u32 s60, s4, s58
    s_addc_u32 s61, s5, 0
    s_load_dwordx16 s[32:47], s[60:61], 0
    s_load_dwordx16 s[80:95], s[60:61], 64
    s_mov_b32 s16, s6
    s_and_b32 s17, s7, 0xffff
    s_mov_b32 s18, 0x800000
    s_mov_b32 s19, 0x00020000
    s_mov_b32 s20, s66
    s_and_b32 s21, s67, 0xffff
    s_mov_b32 s22, 0x800000
    s_mov_b32 s23, 0x00020000
    v_lshrrev_b32 v21, 4, v20
    v_and_b32 v22, 15, v20
    v_and_b32 v23, 1, v21
    v_mul_u32_u24 v23, 688, v23
    v_lshrrev_b32 v24, 1, v21
    v_mul_u32_u24 v24, 17, v24
    v_add3_u32 v23, v23, v24, v22
    v_lshlrev_b32 v23, 4, v23
    s_mov_b32 s58, 0
    s_cmp_eq_u32 s3, 0
    s_cselect_b32 s58, 544, s58
    s_cmp_eq_u32 s3, 2
    s_cselect_b32 s58, 560, s58
    s_mov_b32 s59, 560
    s_cmp_eq_u32 s3, 2
    s_cselect_b32 s59, 0, s59
    s_cmp_eq_u32 s3, 3
    s_cselect_b32 s59, 16, s59
    v_add_u32 v4, s58, v23
    v_add_u32 v5, s59, v23
    v_add_u32 v6, 49152, v4
    v_add_u32 v7, 49152, v5
    s_mov_b32 s28, 0xbc00bc00
    s_cmp_eq_u32 s3, 1
    s_cselect_b32 s28, 0x3c003c00, s28
    v_and_b32 v23, 7, v22
    v_xor_b32 v24, v21, v23
    v_lshlrev_b32 v24, 4, v24
    v_lshl_add_u32 v24, v23, 7, v24
    v_lshrrev_b32 v23, 3, v22
    v_lshl_add_u32 v24, v23, 11, v24
    s_lshl_b32 s58, s3, 12
    v_add_u32 v14, s58, v24
    v_xor_b32 v15, 64, v14
    v_add_u32 v124, 0x10000, v14
    v_add_u32 v125, 0x10000, v15
    s_lshr_b32 s58, s3, 1
    s_lshl_b32 s58, s58, 14
    s_and_b32 s59, s3, 1
    s_lshl_b32 s59, s59, 11
    s_add_u32 s58, s58, s59
    v_add_u32 v16, s58, v1
    v_add_u32 v17, 0x10000, v16
    s_lshr_b32 s58, s3, 1
    s_add_u32 s58, s58, s55
    s_lshl_b32 s58, s58, 16
    s_lshl_b32 s59, s56, 11
    s_add_u32 s58, s58, s59
    s_and_b32 s59, s3, 1
    s_lshl_b32 s59, s59, 14
    s_add_u32 s58, s58, s59
    s_lshl_b32 s59, s54, 7
    s_add_u32 s58, s58, s59
    v_lshrrev_b32 v23, 3, v20
    v_and_b32 v24, 7, v20
    v_xor_b32 v24, v24, v23
    v_lshlrev_b32 v24, 4, v24
    v_lshl_add_u32 v24, v23, 11, v24
    v_add_u32 v18, s58, v24
    s_mov_b32 s48, 0x20000
    s_mov_b32 s49, 0x40000
    s_mov_b32 s50, 0x60000
    s_add_u32 s58, s3, 1
    s_cmp_eq_u32 s3, 0
    s_cselect_b32 s58, 0, s58
    s_cmp_eq_u32 s3, 3
    s_cselect_b32 s58, 1, s58
    s_lshl_b32 s58, s58, 14
    s_lshl_b32 s59, s56, 9
    s_add_u32 s58, s58, s59
    s_lshl_b32 s59, s55, 16
    s_add_u32 s58, s58, s59
    s_add_u32 s27, s58, 10485760
    v_mov_b32 v128, 0
    v_mov_b32 v129, 0
    v_mov_b32 v130, 0
    v_mov_b32 v131, 0
    v_mov_b32 v132, 0
    v_mov_b32 v133, 0
    v_mov_b32 v134, 0
    v_mov_b32 v135, 0
    v_mov_b32 v136, 0
    v_mov_b32 v137, 0
    v_mov_b32 v138, 0
    v_mov_b32 v139, 0
    v_mov_b32 v140, 0
    v_mov_b32 v141, 0
    v_mov_b32 v142, 0
    v_mov_b32 v143, 0
    v_mov_b32 v144, 0
    v_mov_b32 v145, 0
    v_mov_b32 v146, 0
    v_mov_b32 v147, 0
    v_mov_b32 v148, 0
    v_mov_b32 v149, 0
    v_mov_b32 v150, 0
    v_mov_b32 v151, 0
    v_mov_b32 v152, 0
    v_mov_b32 v153, 0
    v_mov_b32 v154, 0
    v_mov_b32 v155, 0
    v_mov_b32 v156, 0
    v_mov_b32 v157, 0
    v_mov_b32 v158, 0
    v_mov_b32 v159, 0
    v_mov_b32 v160, 0
    v_mov_b32 v161, 0
    v_mov_b32 v162, 0
    v_mov_b32 v163, 0
    v_mov_b32 v164, 0
    v_mov_b32 v165, 0
    v_mov_b32 v166, 0
    v_mov_b32 v167, 0
    v_mov_b32 v168, 0
    v_mov_b32 v169, 0
    v_mov_b32 v170, 0
    v_mov_b32 v171, 0
    v_mov_b32 v172, 0
    v_mov_b32 v173, 0
    v_mov_b32 v174, 0
    v_mov_b32 v175, 0
    v_mov_b32 v176, 0
    v_mov_b32 v177, 0
    v_mov_b32 v178, 0
    v_mov_b32 v179, 0
    v_mov_b32 v180, 0
    v_mov_b32 v181, 0
    v_mov_b32 v182, 0
    v_mov_b32 v183, 0
    v_mov_b32 v184, 0
    v_mov_b32 v185, 0
    v_mov_b32 v186, 0
    v_mov_b32 v187, 0
    v_mov_b32 v188, 0
    v_mov_b32 v189, 0
    v_mov_b32 v190, 0
    v_mov_b32 v191, 0
    v_mov_b32 v192, 0
    v_mov_b32 v193, 0
    v_mov_b32 v194, 0
    v_mov_b32 v195, 0
    v_mov_b32 v196, 0
    v_mov_b32 v197, 0
    v_mov_b32 v198, 0
    v_mov_b32 v199, 0
    v_mov_b32 v200, 0
    v_mov_b32 v201, 0
    v_mov_b32 v202, 0
    v_mov_b32 v203, 0
    v_mov_b32 v204, 0
    v_mov_b32 v205, 0
    v_mov_b32 v206, 0
    v_mov_b32 v207, 0
    v_mov_b32 v208, 0
    v_mov_b32 v209, 0
    v_mov_b32 v210, 0
    v_mov_b32 v211, 0
    v_mov_b32 v212, 0
    v_mov_b32 v213, 0
    v_mov_b32 v214, 0
    v_mov_b32 v215, 0
    v_mov_b32 v216, 0
    v_mov_b32 v217, 0
    v_mov_b32 v218, 0
    v_mov_b32 v219, 0
    v_mov_b32 v220, 0
    v_mov_b32 v221, 0
    v_mov_b32 v222, 0
    v_mov_b32 v223, 0
    v_mov_b32 v224, 0
    v_mov_b32 v225, 0
    v_mov_b32 v226, 0
    v_mov_b32 v227, 0
    v_mov_b32 v228, 0
    v_mov_b32 v229, 0
    v_mov_b32 v230, 0
    v_mov_b32 v231, 0
    v_mov_b32 v232, 0
    v_mov_b32 v233, 0
    v_mov_b32 v234, 0
    v_mov_b32 v235, 0
    v_mov_b32 v236, 0
    v_mov_b32 v237, 0
    v_mov_b32 v238, 0
    v_mov_b32 v239, 0
    v_mov_b32 v240, 0
    v_mov_b32 v241, 0
    v_mov_b32 v242, 0
    v_mov_b32 v243, 0
    v_mov_b32 v244, 0
    v_mov_b32 v245, 0
    v_mov_b32 v246, 0
    v_mov_b32 v247, 0
    v_mov_b32 v248, 0
    v_mov_b32 v249, 0
    v_mov_b32 v250, 0
    v_mov_b32 v251, 0
    v_mov_b32 v252, 0
    v_mov_b32 v253, 0
    v_mov_b32 v254, 0
    v_mov_b32 v255, 0
    buffer_load_dwordx4 a[32:35], v3, s[12:15], s96 offen offset:0
    buffer_load_dwordx4 a[36:39], v3, s[12:15], s96 offen offset:1024
    buffer_load_dwordx4 a[40:43], v3, s[12:15], s96 offen offset:2048
    buffer_load_dwordx4 a[44:47], v3, s[12:15], s96 offen offset:3072
    s_add_u32 s96, s96, 49152
    s_add_u32 m0, s30, 24576
    s_nop 0
    buffer_load_dwordx4 v8, s[8:11], s51 offen lds
    s_add_u32 m0, s30, 28672
    s_nop 0
    buffer_load_dwordx4 v9, s[8:11], s51 offen lds
    s_add_u32 m0, s30, 32768
    s_nop 0
    buffer_load_dwordx4 v10, s[8:11], s51 offen lds
    s_add_u32 m0, s30, 36864
    s_nop 0
    buffer_load_dwordx4 v11, s[8:11], s51 offen lds
    s_add_u32 m0, s30, 40960
    s_nop 0
    buffer_load_dwordx4 v12, s[8:11], s51 offen lds
    s_add_u32 m0, s30, 45056
    s_nop 0
    buffer_load_dwordx4 v13, s[8:11], s51 offen lds
    s_add_u32 s51, s51, 2228224
    buffer_load_dwordx4 a[48:51], v1, s[12:15], s97 offen offset:0
    buffer_load_dwordx4 a[52:55], v1, s[12:15], s97 offen offset:1024
    buffer_load_dwordx4 a[56:59], v1, s[12:15], s97 offen offset:2048
    buffer_load_dwordx4 a[60:63], v1, s[12:15], s97 offen offset:3072
    buffer_load_dwordx4 a[64:67], v2, s[12:15], s97 offen offset:0
    buffer_load_dwordx4 a[68:71], v2, s[12:15], s97 offen offset:1024
    buffer_load_dwordx4 a[72:75], v2, s[12:15], s97 offen offset:2048
    buffer_load_dwordx4 a[76:79], v2, s[12:15], s97 offen offset:3072
    s_waitcnt lgkmcnt(0)
    s_mov_b32 s58, s32
    s_mov_b32 s59, s32
    s_min_i32 s58, s58, s33
    s_max_i32 s59, s59, s33
    s_min_i32 s58, s58, s34
    s_max_i32 s59, s59, s34
    s_min_i32 s58, s58, s35
    s_max_i32 s59, s59, s35
    s_min_i32 s58, s58, s36
    s_max_i32 s59, s59, s36
    s_min_i32 s58, s58, s37
    s_max_i32 s59, s59, s37
    s_min_i32 s58, s58, s38
    s_max_i32 s59, s59, s38
    s_min_i32 s58, s58, s39
    s_max_i32 s59, s59, s39
    s_min_i32 s58, s58, s40
    s_max_i32 s59, s59, s40
    s_min_i32 s58, s58, s41
    s_max_i32 s59, s59, s41
    s_min_i32 s58, s58, s42
    s_max_i32 s59, s59, s42
    s_min_i32 s58, s58, s43
    s_max_i32 s59, s59, s43
    s_min_i32 s58, s58, s44
    s_max_i32 s59, s59, s44
    s_min_i32 s58, s58, s45
    s_max_i32 s59, s59, s45
    s_min_i32 s58, s58, s46
    s_max_i32 s59, s59, s46
    s_min_i32 s58, s58, s47
    s_max_i32 s59, s59, s47
    s_min_i32 s58, s58, s80
    s_max_i32 s59, s59, s80
    s_min_i32 s58, s58, s81
    s_max_i32 s59, s59, s81
    s_min_i32 s58, s58, s82
    s_max_i32 s59, s59, s82
    s_min_i32 s58, s58, s83
    s_max_i32 s59, s59, s83
    s_min_i32 s58, s58, s84
    s_max_i32 s59, s59, s84
    s_min_i32 s58, s58, s85
    s_max_i32 s59, s59, s85
    s_min_i32 s58, s58, s86
    s_max_i32 s59, s59, s86
    s_min_i32 s58, s58, s87
    s_max_i32 s59, s59, s87
    s_min_i32 s58, s58, s88
    s_max_i32 s59, s59, s88
    s_min_i32 s58, s58, s89
    s_max_i32 s59, s59, s89
    s_min_i32 s58, s58, s90
    s_max_i32 s59, s59, s90
    s_min_i32 s58, s58, s91
    s_max_i32 s59, s59, s91
    s_min_i32 s58, s58, s92
    s_max_i32 s59, s59, s92
    s_min_i32 s58, s58, s93
    s_max_i32 s59, s59, s93
    s_min_i32 s58, s58, s94
    s_max_i32 s59, s59, s94
    s_min_i32 s58, s58, s95
    s_max_i32 s59, s59, s95
    s_add_u32 s60, s3, 1
    s_lshr_b32 s60, s60, 1
    s_and_b32 s60, s60, 1
    s_sub_i32 s60, s60, s58
    s_add_i32 s60, s60, 117
    s_max_i32 s60, s60, 1
    s_min_i32 s60, s60, 254
    s_lshl_b32 s29, s60, 23
    s_cmp_lg_u32 s58, s59
    s_cbranch_scc1 L2_slow
    s_waitcnt vmcnt(26)
    s_barrier
    ds_read_b128 v[20:23], v4 offset:0
    ds_read_b128 v[24:27], v5 offset:0
    ds_read_b128 v[28:31], v4 offset:1088
    ds_read_b128 v[32:35], v5 offset:1088
    ds_read_b128 v[36:39], v4 offset:2176
    ds_read_b128 v[40:43], v5 offset:2176
    s_waitcnt lgkmcnt(4)
    v_pk_fma_f16 v60, v24, s28, v20
    v_pk_fma_f16 v61, v25, s28, v21
    v_pk_fma_f16 v62, v26, s28, v22
    v_pk_fma_f16 v63, v27, s28, v23
    s_waitcnt lgkmcnt(2)
    v_pk_fma_f16 v64, v32, s28, v28
    ds_read_b128 v[44:47], v4 offset:3264
    v_pk_fma_f16 v65, v33, s28, v29
    ds_read_b128 v[48:51], v5 offset:3264
    v_pk_fma_f16 v66, v34, s28, v30
    v_pk_fma_f16 v67, v35, s28, v31
    s_waitcnt vmcnt(22)
    s_nop 1
    s_mov_b32 s26, 3
.p2align 3
L2_loopf:
    v_mfma_f32_16x16x32_f16 v[128:131], a[0:3], v[60:63], v[128:131]
    v_mfma_f32_16x16x32_f16 v[132:135], a[4:7], v[60:63], v[132:135]
    buffer_load_dwordx4 a[80:83], v3, s[12:15], s97 offen offset:0
    v_mfma_f32_16x16x32_f16 v[136:139], a[8:11], v[60:63], v[136:139]
    v_mfma_f32_16x16x32_f16 v[140:143], a[12:15], v[60:63], v[140:143]
    v_mfma_f32_16x16x32_f16 v[144:147], a[0:3], v[64:67], v[144:147]
    s_waitcnt lgkmcnt(2)
    v_pk_fma_f16 v68, v40, s28, v36
    v_mfma_f32_16x16x32_f16 v[148:151], a[4:7], v[64:67], v[148:151]
    v_pk_fma_f16 v69, v41, s28, v37
    v_mfma_f32_16x16x32_f16 v[152:155], a[8:11], v[64:67], v[152:155]
    v_pk_fma_f16 v70, v42, s28, v38
    v_mfma_f32_16x16x32_f16 v[156:159], a[12:15], v[64:67], v[156:159]
    v_pk_fma_f16 v71, v43, s28, v39
    s_waitcnt vmcnt(19)
    v_mfma_f32_16x16x32_f16 v[128:131], a[16:19], v[64:67], v[128:131]
    ds_read_b128 v[52:55], v4 offset:4352
    v_mfma_f32_16x16x32_f16 v[132:135], a[20:23], v[64:67], v[132:135]
    ds_read_b128 v[56:59], v5 offset:4352
    v_mfma_f32_16x16x32_f16 v[136:139], a[24:27], v[64:67], v[136:139]
    buffer_load_dwordx4 a[84:87], v3, s[12:15], s97 offen offset:1024
    v_mfma_f32_16x16x32_f16 v[140:143], a[28:31], v[64:67], v[140:143]
    v_mfma_f32_16x16x32_f16 v[160:163], a[0:3], v[68:71], v[160:163]
    v_mfma_f32_16x16x32_f16 v[164:167], a[4:7], v[68:71], v[164:167]
    v_mfma_f32_16x16x32_f16 v[168:171], a[8:11], v[68:71], v[168:171]
    buffer_load_dwordx4 a[88:91], v3, s[12:15], s97 offen offset:2048
    v_mfma_f32_16x16x32_f16 v[172:175], a[12:15], v[68:71], v[172:175]
    v_mfma_f32_16x16x32_f16 v[144:147], a[16:19], v[68:71], v[144:147]
    s_waitcnt lgkmcnt(2)
    v_pk_fma_f16 v72, v48, s28, v44
    v_mfma_f32_16x16x32_f16 v[148:151], a[20:23], v[68:71], v[148:151]
    v_pk_fma_f16 v73, v49, s28, v45
    v_mfma_f32_16x16x32_f16 v[152:155], a[24:27], v[68:71], v[152:155]
    v_pk_fma_f16 v74, v50, s28, v46
    v_mfma_f32_16x16x32_f16 v[156:159], a[28:31], v[68:71], v[156:159]
    v_pk_fma_f16 v75, v51, s28, v47
    s_waitcnt vmcnt(17)
    v_mfma_f32_16x16x32_f16 v[128:131], a[32:35], v[68:71], v[128:131]
    ds_read_b128 v[20:23], v4 offset:5440
    buffer_load_dwordx4 a[92:95], v3, s[12:15], s97 offen offset:3072
    v_mfma_f32_16x16x32_f16 v[132:135], a[36:39], v[68:71], v[132:135]
    ds_read_b128 v[24:27], v5 offset:5440
    s_add_u32 s97, s97, 49152
    v_mfma_f32_16x16x32_f16 v[136:139], a[40:43], v[68:71], v[136:139]
    v_mfma_f32_16x16x32_f16 v[140:143], a[44:47], v[68:71], v[140:143]
    s_add_u32 m0, s30, 49152
    v_mfma_f32_16x16x32_f16 v[176:179], a[0:3], v[72:75], v[176:179]
    buffer_load_dwordx4 v8, s[8:11], s68 offen lds
    v_mfma_f32_16x16x32_f16 v[180:183], a[4:7], v[72:75], v[180:183]
    v_mfma_f32_16x16x32_f16 v[184:187], a[8:11], v[72:75], v[184:187]
    v_mfma_f32_16x16x32_f16 v[188:191], a[12:15], v[72:75], v[188:191]
    v_mfma_f32_16x16x32_f16 v[160:163], a[16:19], v[72:75], v[160:163]
    s_waitcnt lgkmcnt(2)
    v_pk_fma_f16 v60, v56, s28, v52
    v_mfma_f32_16x16x32_f16 v[164:167], a[20:23], v[72:75], v[164:167]
    v_pk_fma_f16 v61, v57, s28, v53
    s_add_u32 m0, s30, 53248
    v_mfma_f32_16x16x32_f16 v[168:171], a[24:27], v[72:75], v[168:171]
    v_pk_fma_f16 v62, v58, s28, v54
    buffer_load_dwordx4 v9, s[8:11], s68 offen lds
    v_mfma_f32_16x16x32_f16 v[172:175], a[28:31], v[72:75], v[172:175]
    v_pk_fma_f16 v63, v59, s28, v55
    v_mfma_f32_16x16x32_f16 v[144:147], a[32:35], v[72:75], v[144:147]
    ds_read_b128 v[28:31], v4 offset:6528
    v_mfma_f32_16x16x32_f16 v[148:151], a[36:39], v[72:75], v[148:151]
    ds_read_b128 v[32:35], v5 offset:6528
    s_add_u32 m0, s30, 57344
    v_mfma_f32_16x16x32_f16 v[152:155], a[40:43], v[72:75], v[152:155]
    buffer_load_dwordx4 v10, s[8:11], s68 offen lds
    v_mfma_f32_16x16x32_f16 v[156:159], a[44:47], v[72:75], v[156:159]
    v_mfma_f32_16x16x32_f16 v[192:195], a[0:3], v[60:63], v[192:195]
    v_mfma_f32_16x16x32_f16 v[196:199], a[4:7], v[60:63], v[196:199]
    s_add_u32 m0, s30, 61440
    v_mfma_f32_16x16x32_f16 v[200:203], a[8:11], v[60:63], v[200:203]
    buffer_load_dwordx4 v11, s[8:11], s68 offen lds
    v_mfma_f32_16x16x32_f16 v[204:207], a[12:15], v[60:63], v[204:207]
    v_mfma_f32_16x16x32_f16 v[176:179], a[16:19], v[60:63], v[176:179]
    s_waitcnt lgkmcnt(2)
    v_pk_fma_f16 v64, v24, s28, v20
    v_mfma_f32_16x16x32_f16 v[180:183], a[20:23], v[60:63], v[180:183]
    v_pk_fma_f16 v65, v25, s28, v21
    v_mfma_f32_16x16x32_f16 v[184:187], a[24:27], v[60:63], v[184:187]
    v_pk_fma_f16 v66, v26, s28, v22
    v_mfma_f32_16x16x32_f16 v[188:191], a[28:31], v[60:63], v[188:191]
    v_pk_fma_f16 v67, v27, s28, v23
    v_mfma_f32_16x16x32_f16 v[160:163], a[32:35], v[60:63], v[160:163]
    ds_read_b128 v[36:39], v4 offset:7616
    v_mfma_f32_16x16x32_f16 v[164:167], a[36:39], v[60:63], v[164:167]
    ds_read_b128 v[40:43], v5 offset:7616
    s_add_u32 m0, s30, 65536
    v_mfma_f32_16x16x32_f16 v[168:171], a[40:43], v[60:63], v[168:171]
    buffer_load_dwordx4 v12, s[8:11], s68 offen lds
    v_mfma_f32_16x16x32_f16 v[172:175], a[44:47], v[60:63], v[172:175]
    v_mfma_f32_16x16x32_f16 v[208:211], a[0:3], v[64:67], v[208:211]
    v_mfma_f32_16x16x32_f16 v[212:215], a[4:7], v[64:67], v[212:215]
    s_add_u32 m0, s30, 69632
    v_mfma_f32_16x16x32_f16 v[216:219], a[8:11], v[64:67], v[216:219]
    buffer_load_dwordx4 v13, s[8:11], s68 offen lds
    v_mfma_f32_16x16x32_f16 v[220:223], a[12:15], v[64:67], v[220:223]
    s_add_u32 s68, s68, 2228224
    v_mfma_f32_16x16x32_f16 v[192:195], a[16:19], v[64:67], v[192:195]
    s_waitcnt lgkmcnt(2)
    v_pk_fma_f16 v68, v32, s28, v28
    v_mfma_f32_16x16x32_f16 v[196:199], a[20:23], v[64:67], v[196:199]
    v_pk_fma_f16 v69, v33, s28, v29
    v_mfma_f32_16x16x32_f16 v[200:203], a[24:27], v[64:67], v[200:203]
    v_pk_fma_f16 v70, v34, s28, v30
    v_mfma_f32_16x16x32_f16 v[204:207], a[28:31], v[64:67], v[204:207]
    v_pk_fma_f16 v71, v35, s28, v31
    v_mfma_f32_16x16x32_f16 v[176:179], a[32:35], v[64:67], v[176:179]
    ds_read_b128 v[44:47], v4 offset:8704
    buffer_load_dwordx4 a[96:99], v1, s[12:15], s98 offen offset:0
    v_mfma_f32_16x16x32_f16 v[180:183], a[36:39], v[64:67], v[180:183]
    ds_read_b128 v[48:51], v5 offset:8704
    v_mfma_f32_16x16x32_f16 v[184:187], a[40:43], v[64:67], v[184:187]
    v_mfma_f32_16x16x32_f16 v[188:191], a[44:47], v[64:67], v[188:191]
    s_waitcnt vmcnt(19)
    s_barrier
    v_mfma_f32_16x16x32_f16 v[224:227], a[0:3], v[68:71], v[224:227]
    v_mfma_f32_16x16x32_f16 v[228:231], a[4:7], v[68:71], v[228:231]
    v_mfma_f32_16x16x32_f16 v[232:235], a[8:11], v[68:71], v[232:235]
    buffer_load_dwordx4 a[100:103], v1, s[12:15], s98 offen offset:1024
    v_mfma_f32_16x16x32_f16 v[236:239], a[12:15], v[68:71], v[236:239]
    v_mfma_f32_16x16x32_f16 v[208:211], a[16:19], v[68:71], v[208:211]
    s_waitcnt lgkmcnt(2)
    v_pk_fma_f16 v72, v40, s28, v36
    ds_read_b128 v[52:55], v4 offset:9792
    v_mfma_f32_16x16x32_f16 v[212:215], a[20:23], v[68:71], v[212:215]
    v_pk_fma_f16 v73, v41, s28, v37
    ds_read_b128 v[56:59], v5 offset:9792
    v_mfma_f32_16x16x32_f16 v[216:219], a[24:27], v[68:71], v[216:219]
    v_pk_fma_f16 v74, v42, s28, v38
    buffer_load_dwordx4 a[104:107], v1, s[12:15], s98 offen offset:2048
    v_mfma_f32_16x16x32_f16 v[220:223], a[28:31], v[68:71], v[220:223]
    v_pk_fma_f16 v75, v43, s28, v39
    v_mfma_f32_16x16x32_f16 v[192:195], a[32:35], v[68:71], v[192:195]
    ds_read_b128 v[20:23], v4 offset:24576
    v_mfma_f32_16x16x32_f16 v[196:199], a[36:39], v[68:71], v[196:199]
    ds_read_b128 v[24:27], v5 offset:24576
    v_mfma_f32_16x16x32_f16 v[200:203], a[40:43], v[68:71], v[200:203]
    buffer_load_dwordx4 a[108:111], v1, s[12:15], s98 offen offset:3072
    v_mfma_f32_16x16x32_f16 v[204:207], a[44:47], v[68:71], v[204:207]
    v_mfma_f32_16x16x32_f16 v[240:243], a[0:3], v[72:75], v[240:243]
    ds_read_b128 v[28:31], v4 offset:25664
    v_mfma_f32_16x16x32_f16 v[244:247], a[4:7], v[72:75], v[244:247]
    ds_read_b128 v[32:35], v5 offset:25664
    v_mfma_f32_16x16x32_f16 v[248:251], a[8:11], v[72:75], v[248:251]
    v_mfma_f32_16x16x32_f16 v[252:255], a[12:15], v[72:75], v[252:255]
    buffer_load_dwordx4 a[112:115], v2, s[12:15], s98 offen offset:0
    v_mfma_f32_16x16x32_f16 v[224:227], a[16:19], v[72:75], v[224:227]
    s_waitcnt lgkmcnt(6)
    v_pk_fma_f16 v60, v48, s28, v44
    v_mfma_f32_16x16x32_f16 v[228:231], a[20:23], v[72:75], v[228:231]
    v_pk_fma_f16 v61, v49, s28, v45
    v_mfma_f32_16x16x32_f16 v[232:235], a[24:27], v[72:75], v[232:235]
    v_pk_fma_f16 v62, v50, s28, v46
    v_mfma_f32_16x16x32_f16 v[236:239], a[28:31], v[72:75], v[236:239]
    v_pk_fma_f16 v63, v51, s28, v47
    buffer_load_dwordx4 a[116:119], v2, s[12:15], s98 offen offset:1024
    v_mfma_f32_16x16x32_f16 v[208:211], a[32:35], v[72:75], v[208:211]
    ds_read_b128 v[36:39], v4 offset:26752
    v_mfma_f32_16x16x32_f16 v[212:215], a[36:39], v[72:75], v[212:215]
    ds_read_b128 v[40:43], v5 offset:26752
    v_mfma_f32_16x16x32_f16 v[216:219], a[40:43], v[72:75], v[216:219]
    v_mfma_f32_16x16x32_f16 v[220:223], a[44:47], v[72:75], v[220:223]
    buffer_load_dwordx4 a[120:123], v2, s[12:15], s98 offen offset:2048
    v_mfma_f32_16x16x32_f16 v[240:243], a[16:19], v[60:63], v[240:243]
    s_waitcnt lgkmcnt(6)
    v_pk_fma_f16 v64, v56, s28, v52
    v_mfma_f32_16x16x32_f16 v[244:247], a[20:23], v[60:63], v[244:247]
    v_pk_fma_f16 v65, v57, s28, v53
    v_mfma_f32_16x16x32_f16 v[248:251], a[24:27], v[60:63], v[248:251]
    v_pk_fma_f16 v66, v58, s28, v54
    v_mfma_f32_16x16x32_f16 v[252:255], a[28:31], v[60:63], v[252:255]
    v_pk_fma_f16 v67, v59, s28, v55
    v_mfma_f32_16x16x32_f16 v[224:227], a[32:35], v[60:63], v[224:227]
    s_waitcnt lgkmcnt(4)
    v_pk_fma_f16 v68, v24, s28, v20
    v_mfma_f32_16x16x32_f16 v[228:231], a[36:39], v[60:63], v[228:231]
    v_pk_fma_f16 v69, v25, s28, v21
    v_mfma_f32_16x16x32_f16 v[232:235], a[40:43], v[60:63], v[232:235]
    buffer_load_dwordx4 a[124:127], v2, s[12:15], s98 offen offset:3072
    v_pk_fma_f16 v70, v26, s28, v22
    v_mfma_f32_16x16x32_f16 v[236:239], a[44:47], v[60:63], v[236:239]
    v_pk_fma_f16 v71, v27, s28, v23
    v_mfma_f32_16x16x32_f16 v[240:243], a[32:35], v[64:67], v[240:243]
    s_waitcnt lgkmcnt(2)
    v_pk_fma_f16 v72, v32, s28, v28
    ds_read_b128 v[44:47], v4 offset:27840
    v_mfma_f32_16x16x32_f16 v[244:247], a[36:39], v[64:67], v[244:247]
    v_pk_fma_f16 v73, v33, s28, v29
    ds_read_b128 v[48:51], v5 offset:27840
    v_mfma_f32_16x16x32_f16 v[248:251], a[40:43], v[64:67], v[248:251]
    v_pk_fma_f16 v74, v34, s28, v30
    v_mfma_f32_16x16x32_f16 v[252:255], a[44:47], v[64:67], v[252:255]
    s_waitcnt vmcnt(22)
    v_pk_fma_f16 v75, v35, s28, v31
    v_mfma_f32_16x16x32_f16 v[128:131], a[48:51], v[68:71], v[128:131]
    v_mfma_f32_16x16x32_f16 v[132:135], a[52:55], v[68:71], v[132:135]
    buffer_load_dwordx4 a[128:131], v3, s[12:15], s98 offen offset:0
    v_mfma_f32_16x16x32_f16 v[136:139], a[56:59], v[68:71], v[136:139]
    v_mfma_f32_16x16x32_f16 v[140:143], a[60:63], v[68:71], v[140:143]
    v_mfma_f32_16x16x32_f16 v[144:147], a[48:51], v[72:75], v[144:147]
    s_waitcnt lgkmcnt(2)
    v_pk_fma_f16 v60, v40, s28, v36
    v_mfma_f32_16x16x32_f16 v[148:151], a[52:55], v[72:75], v[148:151]
    v_pk_fma_f16 v61, v41, s28, v37
    v_mfma_f32_16x16x32_f16 v[152:155], a[56:59], v[72:75], v[152:155]
    v_pk_fma_f16 v62, v42, s28, v38
    v_mfma_f32_16x16x32_f16 v[156:159], a[60:63], v[72:75], v[156:159]
    v_pk_fma_f16 v63, v43, s28, v39
    s_waitcnt vmcnt(19)
    v_mfma_f32_16x16x32_f16 v[128:131], a[64:67], v[72:75], v[128:131]
    ds_read_b128 v[52:55], v4 offset:28928
    v_mfma_f32_16x16x32_f16 v[132:135], a[68:71], v[72:75], v[132:135]
    ds_read_b128 v[56:59], v5 offset:28928
    v_mfma_f32_16x16x32_f16 v[136:139], a[72:75], v[72:75], v[136:139]
    buffer_load_dwordx4 a[132:135], v3, s[12:15], s98 offen offset:1024
    v_mfma_f32_16x16x32_f16 v[140:143], a[76:79], v[72:75], v[140:143]
    v_mfma_f32_16x16x32_f16 v[160:163], a[48:51], v[60:63], v[160:163]
    v_mfma_f32_16x16x32_f16 v[164:167], a[52:55], v[60:63], v[164:167]
    v_mfma_f32_16x16x32_f16 v[168:171], a[56:59], v[60:63], v[168:171]
    buffer_load_dwordx4 a[136:139], v3, s[12:15], s98 offen offset:2048
    v_mfma_f32_16x16x32_f16 v[172:175], a[60:63], v[60:63], v[172:175]
    v_mfma_f32_16x16x32_f16 v[144:147], a[64:67], v[60:63], v[144:147]
    s_waitcnt lgkmcnt(2)
    v_pk_fma_f16 v64, v48, s28, v44
    v_mfma_f32_16x16x32_f16 v[148:151], a[68:71], v[60:63], v[148:151]
    v_pk_fma_f16 v65, v49, s28, v45
    v_mfma_f32_16x16x32_f16 v[152:155], a[72:75], v[60:63], v[152:155]
    v_pk_fma_f16 v66, v50, s28, v46
    v_mfma_f32_16x16x32_f16 v[156:159], a[76:79], v[60:63], v[156:159]
    v_pk_fma_f16 v67, v51, s28, v47
    s_waitcnt vmcnt(17)
    v_mfma_f32_16x16x32_f16 v[128:131], a[80:83], v[60:63], v[128:131]
    ds_read_b128 v[20:23], v4 offset:30016
    buffer_load_dwordx4 a[140:143], v3, s[12:15], s98 offen offset:3072
    v_mfma_f32_16x16x32_f16 v[132:135], a[84:87], v[60:63], v[132:135]
    ds_read_b128 v[24:27], v5 offset:30016
    s_add_u32 s98, s98, 49152
    v_mfma_f32_16x16x32_f16 v[136:139], a[88:91], v[60:63], v[136:139]
    v_mfma_f32_16x16x32_f16 v[140:143], a[92:95], v[60:63], v[140:143]
    s_add_u32 m0, s30, 73728
    v_mfma_f32_16x16x32_f16 v[176:179], a[48:51], v[64:67], v[176:179]
    buffer_load_dwordx4 v8, s[8:11], s69 offen lds
    v_mfma_f32_16x16x32_f16 v[180:183], a[52:55], v[64:67], v[180:183]
    v_mfma_f32_16x16x32_f16 v[184:187], a[56:59], v[64:67], v[184:187]
    v_mfma_f32_16x16x32_f16 v[188:191], a[60:63], v[64:67], v[188:191]
    v_mfma_f32_16x16x32_f16 v[160:163], a[64:67], v[64:67], v[160:163]
    s_waitcnt lgkmcnt(2)
    v_pk_fma_f16 v68, v56, s28, v52
    v_mfma_f32_16x16x32_f16 v[164:167], a[68:71], v[64:67], v[164:167]
    v_pk_fma_f16 v69, v57, s28, v53
    s_add_u32 m0, s30, 77824
    v_mfma_f32_16x16x32_f16 v[168:171], a[72:75], v[64:67], v[168:171]
    v_pk_fma_f16 v70, v58, s28, v54
    buffer_load_dwordx4 v9, s[8:11], s69 offen lds
    v_mfma_f32_16x16x32_f16 v[172:175], a[76:79], v[64:67], v[172:175]
    v_pk_fma_f16 v71, v59, s28, v55
    v_mfma_f32_16x16x32_f16 v[144:147], a[80:83], v[64:67], v[144:147]
    ds_read_b128 v[28:31], v4 offset:31104
    v_mfma_f32_16x16x32_f16 v[148:151], a[84:87], v[64:67], v[148:151]
    ds_read_b128 v[32:35], v5 offset:31104
    s_add_u32 m0, s30, 81920
    v_mfma_f32_16x16x32_f16 v[152:155], a[88:91], v[64:67], v[152:155]
    buffer_load_dwordx4 v10, s[8:11], s69 offen lds
    v_mfma_f32_16x16x32_f16 v[156:159], a[92:95], v[64:67], v[156:159]
    v_mfma_f32_16x16x32_f16 v[192:195], a[48:51], v[68:71], v[192:195]
    v_mfma_f32_16x16x32_f16 v[196:199], a[52:55], v[68:71], v[196:199]
    s_add_u32 m0, s30, 86016
    v_mfma_f32_16x16x32_f16 v[200:203], a[56:59], v[68:71], v[200:203]
    buffer_load_dwordx4 v11, s[8:11], s69 offen lds
    v_mfma_f32_16x16x32_f16 v[204:207], a[60:63], v[68:71], v[204:207]
    v_mfma_f32_16x16x32_f16 v[176:179], a[64:67], v[68:71], v[176:179]
    s_waitcnt lgkmcnt(2)
    v_pk_fma_f16 v72, v24, s28, v20
    v_mfma_f32_16x16x32_f16 v[180:183], a[68:71], v[68:71], v[180:183]
    v_pk_fma_f16 v73, v25, s28, v21
    v_mfma_f32_16x16x32_f16 v[184:187], a[72:75], v[68:71], v[184:187]
    v_pk_fma_f16 v74, v26, s28, v22
    v_mfma_f32_16x16x32_f16 v[188:191], a[76:79], v[68:71], v[188:191]
    v_pk_fma_f16 v75, v27, s28, v23
    v_mfma_f32_16x16x32_f16 v[160:163], a[80:83], v[68:71], v[160:163]
    ds_read_b128 v[36:39], v4 offset:32192
    v_mfma_f32_16x16x32_f16 v[164:167], a[84:87], v[68:71], v[164:167]
    ds_read_b128 v[40:43], v5 offset:32192
    s_add_u32 m0, s30, 90112
    v_mfma_f32_16x16x32_f16 v[168:171], a[88:91], v[68:71], v[168:171]
    buffer_load_dwordx4 v12, s[8:11], s69 offen lds
    v_mfma_f32_16x16x32_f16 v[172:175], a[92:95], v[68:71], v[172:175]
    v_mfma_f32_16x16x32_f16 v[208:211], a[48:51], v[72:75], v[208:211]
    v_mfma_f32_16x16x32_f16 v[212:215], a[52:55], v[72:75], v[212:215]
    s_add_u32 m0, s30, 94208
    v_mfma_f32_16x16x32_f16 v[216:219], a[56:59], v[72:75], v[216:219]
    buffer_load_dwordx4 v13, s[8:11], s69 offen lds
    v_mfma_f32_16x16x32_f16 v[220:223], a[60:63], v[72:75], v[220:223]
    s_add_u32 s69, s69, 2228224
    v_mfma_f32_16x16x32_f16 v[192:195], a[64:67], v[72:75], v[192:195]
    s_waitcnt lgkmcnt(2)
    v_pk_fma_f16 v60, v32, s28, v28
    v_mfma_f32_16x16x32_f16 v[196:199], a[68:71], v[72:75], v[196:199]
    v_pk_fma_f16 v61, v33, s28, v29
    v_mfma_f32_16x16x32_f16 v[200:203], a[72:75], v[72:75], v[200:203]
    v_pk_fma_f16 v62, v34, s28, v30
    v_mfma_f32_16x16x32_f16 v[204:207], a[76:79], v[72:75], v[204:207]
    v_pk_fma_f16 v63, v35, s28, v31
    v_mfma_f32_16x16x32_f16 v[176:179], a[80:83], v[72:75], v[176:179]
    ds_read_b128 v[44:47], v4 offset:33280
    buffer_load_dwordx4 a[144:147], v1, s[12:15], s99 offen offset:0
    v_mfma_f32_16x16x32_f16 v[180:183], a[84:87], v[72:75], v[180:183]
    ds_read_b128 v[48:51], v5 offset:33280
    v_mfma_f32_16x16x32_f16 v[184:187], a[88:91], v[72:75], v[184:187]
    v_mfma_f32_16x16x32_f16 v[188:191], a[92:95], v[72:75], v[188:191]
    s_waitcnt vmcnt(19)
    s_barrier
    v_mfma_f32_16x16x32_f16 v[224:227], a[48:51], v[60:63], v[224:227]
    v_mfma_f32_16x16x32_f16 v[228:231], a[52:55], v[60:63], v[228:231]
    v_mfma_f32_16x16x32_f16 v[232:235], a[56:59], v[60:63], v[232:235]
    buffer_load_dwordx4 a[148:151], v1, s[12:15], s99 offen offset:1024
    v_mfma_f32_16x16x32_f16 v[236:239], a[60:63], v[60:63], v[236:239]
    v_mfma_f32_16x16x32_f16 v[208:211], a[64:67], v[60:63], v[208:211]
    s_waitcnt lgkmcnt(2)
    v_pk_fma_f16 v64, v40, s28, v36
    ds_read_b128 v[52:55], v4 offset:34368
    v_mfma_f32_16x16x32_f16 v[212:215], a[68:71], v[60:63], v[212:215]
    v_pk_fma_f16 v65, v41, s28, v37
    ds_read_b128 v[56:59], v5 offset:34368
    v_mfma_f32_16x16x32_f16 v[216:219], a[72:75], v[60:63], v[216:219]
    v_pk_fma_f16 v66, v42, s28, v38
    buffer_load_dwordx4 a[152:155], v1, s[12:15], s99 offen offset:2048
    v_mfma_f32_16x16x32_f16 v[220:223], a[76:79], v[60:63], v[220:223]
    v_pk_fma_f16 v67, v43, s28, v39
    v_mfma_f32_16x16x32_f16 v[192:195], a[80:83], v[60:63], v[192:195]
    ds_read_b128 v[20:23], v6 offset:0
    v_mfma_f32_16x16x32_f16 v[196:199], a[84:87], v[60:63], v[196:199]
    ds_read_b128 v[24:27], v7 offset:0
    v_mfma_f32_16x16x32_f16 v[200:203], a[88:91], v[60:63], v[200:203]
    buffer_load_dwordx4 a[156:159], v1, s[12:15], s99 offen offset:3072
    v_mfma_f32_16x16x32_f16 v[204:207], a[92:95], v[60:63], v[204:207]
    v_mfma_f32_16x16x32_f16 v[240:243], a[48:51], v[64:67], v[240:243]
    ds_read_b128 v[28:31], v6 offset:1088
    v_mfma_f32_16x16x32_f16 v[244:247], a[52:55], v[64:67], v[244:247]
    ds_read_b128 v[32:35], v7 offset:1088
    v_mfma_f32_16x16x32_f16 v[248:251], a[56:59], v[64:67], v[248:251]
    v_mfma_f32_16x16x32_f16 v[252:255], a[60:63], v[64:67], v[252:255]
    buffer_load_dwordx4 a[160:163], v2, s[12:15], s99 offen offset:0
    v_mfma_f32_16x16x32_f16 v[224:227], a[64:67], v[64:67], v[224:227]
    s_waitcnt lgkmcnt(6)
    v_pk_fma_f16 v68, v48, s28, v44
    v_mfma_f32_16x16x32_f16 v[228:231], a[68:71], v[64:67], v[228:231]
    v_pk_fma_f16 v69, v49, s28, v45
    v_mfma_f32_16x16x32_f16 v[232:235], a[72:75], v[64:67], v[232:235]
    v_pk_fma_f16 v70, v50, s28, v46
    v_mfma_f32_16x16x32_f16 v[236:239], a[76:79], v[64:67], v[236:239]
    v_pk_fma_f16 v71, v51, s28, v47
    buffer_load_dwordx4 a[164:167], v2, s[12:15], s99 offen offset:1024
    v_mfma_f32_16x16x32_f16 v[208:211], a[80:83], v[64:67], v[208:211]
    ds_read_b128 v[36:39], v6 offset:2176
    v_mfma_f32_16x16x32_f16 v[212:215], a[84:87], v[64:67], v[212:215]
    ds_read_b128 v[40:43], v7 offset:2176
    v_mfma_f32_16x16x32_f16 v[216:219], a[88:91], v[64:67], v[216:219]
    v_mfma_f32_16x16x32_f16 v[220:223], a[92:95], v[64:67], v[220:223]
    buffer_load_dwordx4 a[168:171], v2, s[12:15], s99 offen offset:2048
    v_mfma_f32_16x16x32_f16 v[240:243], a[64:67], v[68:71], v[240:243]
    s_waitcnt lgkmcnt(6)
    v_pk_fma_f16 v72, v56, s28, v52
    v_mfma_f32_16x16x32_f16 v[244:247], a[68:71], v[68:71], v[244:247]
    v_pk_fma_f16 v73, v57, s28, v53
    v_mfma_f32_16x16x32_f16 v[248:251], a[72:75], v[68:71], v[248:251]
    v_pk_fma_f16 v74, v58, s28, v54
    v_mfma_f32_16x16x32_f16 v[252:255], a[76:79], v[68:71], v[252:255]
    v_pk_fma_f16 v75, v59, s28, v55
    v_mfma_f32_16x16x32_f16 v[224:227], a[80:83], v[68:71], v[224:227]
    s_waitcnt lgkmcnt(4)
    v_pk_fma_f16 v60, v24, s28, v20
    v_mfma_f32_16x16x32_f16 v[228:231], a[84:87], v[68:71], v[228:231]
    v_pk_fma_f16 v61, v25, s28, v21
    v_mfma_f32_16x16x32_f16 v[232:235], a[88:91], v[68:71], v[232:235]
    buffer_load_dwordx4 a[172:175], v2, s[12:15], s99 offen offset:3072
    v_pk_fma_f16 v62, v26, s28, v22
    v_mfma_f32_16x16x32_f16 v[236:239], a[92:95], v[68:71], v[236:239]
    v_pk_fma_f16 v63, v27, s28, v23
    v_mfma_f32_16x16x32_f16 v[240:243], a[80:83], v[72:75], v[240:243]
    s_waitcnt lgkmcnt(2)
    v_pk_fma_f16 v64, v32, s28, v28
    ds_read_b128 v[44:47], v6 offset:3264
    v_mfma_f32_16x16x32_f16 v[244:247], a[84:87], v[72:75], v[244:247]
    v_pk_fma_f16 v65, v33, s28, v29
    ds_read_b128 v[48:51], v7 offset:3264
    v_mfma_f32_16x16x32_f16 v[248:251], a[88:91], v[72:75], v[248:251]
    v_pk_fma_f16 v66, v34, s28, v30
    v_mfma_f32_16x16x32_f16 v[252:255], a[92:95], v[72:75], v[252:255]
    s_waitcnt vmcnt(22)
    v_pk_fma_f16 v67, v35, s28, v31
    v_mfma_f32_16x16x32_f16 v[128:131], a[96:99], v[60:63], v[128:131]
    v_mfma_f32_16x16x32_f16 v[132:135], a[100:103], v[60:63], v[132:135]
    buffer_load_dwordx4 a[176:179], v3, s[12:15], s99 offen offset:0
    v_mfma_f32_16x16x32_f16 v[136:139], a[104:107], v[60:63], v[136:139]
    v_mfma_f32_16x16x32_f16 v[140:143], a[108:111], v[60:63], v[140:143]
    v_mfma_f32_16x16x32_f16 v[144:147], a[96:99], v[64:67], v[144:147]
    s_waitcnt lgkmcnt(2)
    v_pk_fma_f16 v68, v40, s28, v36
    v_mfma_f32_16x16x32_f16 v[148:151], a[100:103], v[64:67], v[148:151]
    v_pk_fma_f16 v69, v41, s28, v37
    v_mfma_f32_16x16x32_f16 v[152:155], a[104:107], v[64:67], v[152:155]
    v_pk_fma_f16 v70, v42, s28, v38
    v_mfma_f32_16x16x32_f16 v[156:159], a[108:111], v[64:67], v[156:159]
    v_pk_fma_f16 v71, v43, s28, v39
    s_waitcnt vmcnt(19)
    v_mfma_f32_16x16x32_f16 v[128:131], a[112:115], v[64:67], v[128:131]
    ds_read_b128 v[52:55], v6 offset:4352
    v_mfma_f32_16x16x32_f16 v[132:135], a[116:119], v[64:67], v[132:135]
    ds_read_b128 v[56:59], v7 offset:4352
    v_mfma_f32_16x16x32_f16 v[136:139], a[120:123], v[64:67], v[136:139]
    buffer_load_dwordx4 a[180:183], v3, s[12:15], s99 offen offset:1024
    v_mfma_f32_16x16x32_f16 v[140:143], a[124:127], v[64:67], v[140:143]
    v_mfma_f32_16x16x32_f16 v[160:163], a[96:99], v[68:71], v[160:163]
    v_mfma_f32_16x16x32_f16 v[164:167], a[100:103], v[68:71], v[164:167]
    v_mfma_f32_16x16x32_f16 v[168:171], a[104:107], v[68:71], v[168:171]
    buffer_load_dwordx4 a[184:187], v3, s[12:15], s99 offen offset:2048
    v_mfma_f32_16x16x32_f16 v[172:175], a[108:111], v[68:71], v[172:175]
    v_mfma_f32_16x16x32_f16 v[144:147], a[112:115], v[68:71], v[144:147]
    s_waitcnt lgkmcnt(2)
    v_pk_fma_f16 v72, v48, s28, v44
    v_mfma_f32_16x16x32_f16 v[148:151], a[116:119], v[68:71], v[148:151]
    v_pk_fma_f16 v73, v49, s28, v45
    v_mfma_f32_16x16x32_f16 v[152:155], a[120:123], v[68:71], v[152:155]
    v_pk_fma_f16 v74, v50, s28, v46
    v_mfma_f32_16x16x32_f16 v[156:159], a[124:127], v[68:71], v[156:159]
    v_pk_fma_f16 v75, v51, s28, v47
    s_waitcnt vmcnt(17)
    v_mfma_f32_16x16x32_f16 v[128:131], a[128:131], v[68:71], v[128:131]
    ds_read_b128 v[20:23], v6 offset:5440
    buffer_load_dwordx4 a[188:191], v3, s[12:15], s99 offen offset:3072
    v_mfma_f32_16x16x32_f16 v[132:135], a[132:135], v[68:71], v[132:135]
    ds_read_b128 v[24:27], v7 offset:5440
    s_add_u32 s99, s99, 49152
    v_mfma_f32_16x16x32_f16 v[136:139], a[136:139], v[68:71], v[136:139]
    v_mfma_f32_16x16x32_f16 v[140:143], a[140:143], v[68:71], v[140:143]
    s_add_u32 m0, s30, 0
    v_mfma_f32_16x16x32_f16 v[176:179], a[96:99], v[72:75], v[176:179]
    buffer_load_dwordx4 v8, s[8:11], s24 offen lds
    v_mfma_f32_16x16x32_f16 v[180:183], a[100:103], v[72:75], v[180:183]
    v_mfma_f32_16x16x32_f16 v[184:187], a[104:107], v[72:75], v[184:187]
    v_mfma_f32_16x16x32_f16 v[188:191], a[108:111], v[72:75], v[188:191]
    v_mfma_f32_16x16x32_f16 v[160:163], a[112:115], v[72:75], v[160:163]
    s_waitcnt lgkmcnt(2)
    v_pk_fma_f16 v60, v56, s28, v52
    v_mfma_f32_16x16x32_f16 v[164:167], a[116:119], v[72:75], v[164:167]
    v_pk_fma_f16 v61, v57, s28, v53
    s_add_u32 m0, s30, 4096
    v_mfma_f32_16x16x32_f16 v[168:171], a[120:123], v[72:75], v[168:171]
    v_pk_fma_f16 v62, v58, s28, v54
    buffer_load_dwordx4 v9, s[8:11], s24 offen lds
    v_mfma_f32_16x16x32_f16 v[172:175], a[124:127], v[72:75], v[172:175]
    v_pk_fma_f16 v63, v59, s28, v55
    v_mfma_f32_16x16x32_f16 v[144:147], a[128:131], v[72:75], v[144:147]
    ds_read_b128 v[28:31], v6 offset:6528
    v_mfma_f32_16x16x32_f16 v[148:151], a[132:135], v[72:75], v[148:151]
    ds_read_b128 v[32:35], v7 offset:6528
    s_add_u32 m0, s30, 8192
    v_mfma_f32_16x16x32_f16 v[152:155], a[136:139], v[72:75], v[152:155]
    buffer_load_dwordx4 v10, s[8:11], s24 offen lds
    v_mfma_f32_16x16x32_f16 v[156:159], a[140:143], v[72:75], v[156:159]
    v_mfma_f32_16x16x32_f16 v[192:195], a[96:99], v[60:63], v[192:195]
    v_mfma_f32_16x16x32_f16 v[196:199], a[100:103], v[60:63], v[196:199]
    s_add_u32 m0, s30, 12288
    v_mfma_f32_16x16x32_f16 v[200:203], a[104:107], v[60:63], v[200:203]
    buffer_load_dwordx4 v11, s[8:11], s24 offen lds
    v_mfma_f32_16x16x32_f16 v[204:207], a[108:111], v[60:63], v[204:207]
    v_mfma_f32_16x16x32_f16 v[176:179], a[112:115], v[60:63], v[176:179]
    s_waitcnt lgkmcnt(2)
    v_pk_fma_f16 v64, v24, s28, v20
    v_mfma_f32_16x16x32_f16 v[180:183], a[116:119], v[60:63], v[180:183]
    v_pk_fma_f16 v65, v25, s28, v21
    v_mfma_f32_16x16x32_f16 v[184:187], a[120:123], v[60:63], v[184:187]
    v_pk_fma_f16 v66, v26, s28, v22
    v_mfma_f32_16x16x32_f16 v[188:191], a[124:127], v[60:63], v[188:191]
    v_pk_fma_f16 v67, v27, s28, v23
    v_mfma_f32_16x16x32_f16 v[160:163], a[128:131], v[60:63], v[160:163]
    ds_read_b128 v[36:39], v6 offset:7616
    v_mfma_f32_16x16x32_f16 v[164:167], a[132:135], v[60:63], v[164:167]
    ds_read_b128 v[40:43], v7 offset:7616
    s_add_u32 m0, s30, 16384
    v_mfma_f32_16x16x32_f16 v[168:171], a[136:139], v[60:63], v[168:171]
    buffer_load_dwordx4 v12, s[8:11], s24 offen lds
    v_mfma_f32_16x16x32_f16 v[172:175], a[140:143], v[60:63], v[172:175]
    v_mfma_f32_16x16x32_f16 v[208:211], a[96:99], v[64:67], v[208:211]
    v_mfma_f32_16x16x32_f16 v[212:215], a[100:103], v[64:67], v[212:215]
    s_add_u32 m0, s30, 20480
    v_mfma_f32_16x16x32_f16 v[216:219], a[104:107], v[64:67], v[216:219]
    buffer_load_dwordx4 v13, s[8:11], s24 offen lds
    v_mfma_f32_16x16x32_f16 v[220:223], a[108:111], v[64:67], v[220:223]
    s_add_u32 s24, s24, 2228224
    v_mfma_f32_16x16x32_f16 v[192:195], a[112:115], v[64:67], v[192:195]
    s_waitcnt lgkmcnt(2)
    v_pk_fma_f16 v68, v32, s28, v28
    v_mfma_f32_16x16x32_f16 v[196:199], a[116:119], v[64:67], v[196:199]
    v_pk_fma_f16 v69, v33, s28, v29
    v_mfma_f32_16x16x32_f16 v[200:203], a[120:123], v[64:67], v[200:203]
    v_pk_fma_f16 v70, v34, s28, v30
    v_mfma_f32_16x16x32_f16 v[204:207], a[124:127], v[64:67], v[204:207]
    v_pk_fma_f16 v71, v35, s28, v31
    v_mfma_f32_16x16x32_f16 v[176:179], a[128:131], v[64:67], v[176:179]
    ds_read_b128 v[44:47], v6 offset:8704
    buffer_load_dwordx4 a[0:3], v1, s[12:15], s96 offen offset:0
    v_mfma_f32_16x16x32_f16 v[180:183], a[132:135], v[64:67], v[180:183]
    ds_read_b128 v[48:51], v7 offset:8704
    v_mfma_f32_16x16x32_f16 v[184:187], a[136:139], v[64:67], v[184:187]
    v_mfma_f32_16x16x32_f16 v[188:191], a[140:143], v[64:67], v[188:191]
    s_waitcnt vmcnt(19)
    s_barrier
    v_mfma_f32_16x16x32_f16 v[224:227], a[96:99], v[68:71], v[224:227]
    v_mfma_f32_16x16x32_f16 v[228:231], a[100:103], v[68:71], v[228:231]
    v_mfma_f32_16x16x32_f16 v[232:235], a[104:107], v[68:71], v[232:235]
    buffer_load_dwordx4 a[4:7], v1, s[12:15], s96 offen offset:1024
    v_mfma_f32_16x16x32_f16 v[236:239], a[108:111], v[68:71], v[236:239]
    v_mfma_f32_16x16x32_f16 v[208:211], a[112:115], v[68:71], v[208:211]
    s_waitcnt lgkmcnt(2)
    v_pk_fma_f16 v72, v40, s28, v36
    ds_read_b128 v[52:55], v6 offset:9792
    v_mfma_f32_16x16x32_f16 v[212:215], a[116:119], v[68:71], v[212:215]
    v_pk_fma_f16 v73, v41, s28, v37
    ds_read_b128 v[56:59], v7 offset:9792
    v_mfma_f32_16x16x32_f16 v[216:219], a[120:123], v[68:71], v[216:219]
    v_pk_fma_f16 v74, v42, s28, v38
    buffer_load_dwordx4 a[8:11], v1, s[12:15], s96 offen offset:2048
    v_mfma_f32_16x16x32_f16 v[220:223], a[124:127], v[68:71], v[220:223]
    v_pk_fma_f16 v75, v43, s28, v39
    v_mfma_f32_16x16x32_f16 v[192:195], a[128:131], v[68:71], v[192:195]
    ds_read_b128 v[20:23], v6 offset:24576
    v_mfma_f32_16x16x32_f16 v[196:199], a[132:135], v[68:71], v[196:199]
    ds_read_b128 v[24:27], v7 offset:24576
    v_mfma_f32_16x16x32_f16 v[200:203], a[136:139], v[68:71], v[200:203]
    buffer_load_dwordx4 a[12:15], v1, s[12:15], s96 offen offset:3072
    v_mfma_f32_16x16x32_f16 v[204:207], a[140:143], v[68:71], v[204:207]
    v_mfma_f32_16x16x32_f16 v[240:243], a[96:99], v[72:75], v[240:243]
    ds_read_b128 v[28:31], v6 offset:25664
    v_mfma_f32_16x16x32_f16 v[244:247], a[100:103], v[72:75], v[244:247]
    ds_read_b128 v[32:35], v7 offset:25664
    v_mfma_f32_16x16x32_f16 v[248:251], a[104:107], v[72:75], v[248:251]
    v_mfma_f32_16x16x32_f16 v[252:255], a[108:111], v[72:75], v[252:255]
    buffer_load_dwordx4 a[16:19], v2, s[12:15], s96 offen offset:0
    v_mfma_f32_16x16x32_f16 v[224:227], a[112:115], v[72:75], v[224:227]
    s_waitcnt lgkmcnt(6)
    v_pk_fma_f16 v60, v48, s28, v44
    v_mfma_f32_16x16x32_f16 v[228:231], a[116:119], v[72:75], v[228:231]
    v_pk_fma_f16 v61, v49, s28, v45
    v_mfma_f32_16x16x32_f16 v[232:235], a[120:123], v[72:75], v[232:235]
    v_pk_fma_f16 v62, v50, s28, v46
    v_mfma_f32_16x16x32_f16 v[236:239], a[124:127], v[72:75], v[236:239]
    v_pk_fma_f16 v63, v51, s28, v47
    buffer_load_dwordx4 a[20:23], v2, s[12:15], s96 offen offset:1024
    v_mfma_f32_16x16x32_f16 v[208:211], a[128:131], v[72:75], v[208:211]
    ds_read_b128 v[36:39], v6 offset:26752
    v_mfma_f32_16x16x32_f16 v[212:215], a[132:135], v[72:75], v[212:215]
    ds_read_b128 v[40:43], v7 offset:26752
    v_mfma_f32_16x16x32_f16 v[216:219], a[136:139], v[72:75], v[216:219]
    v_mfma_f32_16x16x32_f16 v[220:223], a[140:143], v[72:75], v[220:223]
    buffer_load_dwordx4 a[24:27], v2, s[12:15], s96 offen offset:2048
    v_mfma_f32_16x16x32_f16 v[240:243], a[112:115], v[60:63], v[240:243]
    s_waitcnt lgkmcnt(6)
    v_pk_fma_f16 v64, v56, s28, v52
    v_mfma_f32_16x16x32_f16 v[244:247], a[116:119], v[60:63], v[244:247]
    v_pk_fma_f16 v65, v57, s28, v53
    v_mfma_f32_16x16x32_f16 v[248:251], a[120:123], v[60:63], v[248:251]
    v_pk_fma_f16 v66, v58, s28, v54
    v_mfma_f32_16x16x32_f16 v[252:255], a[124:127], v[60:63], v[252:255]
    v_pk_fma_f16 v67, v59, s28, v55
    v_mfma_f32_16x16x32_f16 v[224:227], a[128:131], v[60:63], v[224:227]
    s_waitcnt lgkmcnt(4)
    v_pk_fma_f16 v68, v24, s28, v20
    v_mfma_f32_16x16x32_f16 v[228:231], a[132:135], v[60:63], v[228:231]
    v_pk_fma_f16 v69, v25, s28, v21
    v_mfma_f32_16x16x32_f16 v[232:235], a[136:139], v[60:63], v[232:235]
    buffer_load_dwordx4 a[28:31], v2, s[12:15], s96 offen offset:3072
    v_pk_fma_f16 v70, v26, s28, v22
    v_mfma_f32_16x16x32_f16 v[236:239], a[140:143], v[60:63], v[236:239]
    v_pk_fma_f16 v71, v27, s28, v23
    v_mfma_f32_16x16x32_f16 v[240:243], a[128:131], v[64:67], v[240:243]
    s_waitcnt lgkmcnt(2)
    v_pk_fma_f16 v72, v32, s28, v28
    ds_read_b128 v[44:47], v6 offset:27840
    v_mfma_f32_16x16x32_f16 v[244:247], a[132:135], v[64:67], v[244:247]
    v_pk_fma_f16 v73, v33, s28, v29
    ds_read_b128 v[48:51], v7 offset:27840
    v_mfma_f32_16x16x32_f16 v[248:251], a[136:139], v[64:67], v[248:251]
    v_pk_fma_f16 v74, v34, s28, v30
    v_mfma_f32_16x16x32_f16 v[252:255], a[140:143], v[64:67], v[252:255]
    s_waitcnt vmcnt(22)
    v_pk_fma_f16 v75, v35, s28, v31
    v_mfma_f32_16x16x32_f16 v[128:131], a[144:147], v[68:71], v[128:131]
    v_mfma_f32_16x16x32_f16 v[132:135], a[148:151], v[68:71], v[132:135]
    buffer_load_dwordx4 a[32:35], v3, s[12:15], s96 offen offset:0
    v_mfma_f32_16x16x32_f16 v[136:139], a[152:155], v[68:71], v[136:139]
    v_mfma_f32_16x16x32_f16 v[140:143], a[156:159], v[68:71], v[140:143]
    v_mfma_f32_16x16x32_f16 v[144:147], a[144:147], v[72:75], v[144:147]
    s_waitcnt lgkmcnt(2)
    v_pk_fma_f16 v60, v40, s28, v36
    v_mfma_f32_16x16x32_f16 v[148:151], a[148:151], v[72:75], v[148:151]
    v_pk_fma_f16 v61, v41, s28, v37
    v_mfma_f32_16x16x32_f16 v[152:155], a[152:155], v[72:75], v[152:155]
    v_pk_fma_f16 v62, v42, s28, v38
    v_mfma_f32_16x16x32_f16 v[156:159], a[156:159], v[72:75], v[156:159]
    v_pk_fma_f16 v63, v43, s28, v39
    s_waitcnt vmcnt(19)
    v_mfma_f32_16x16x32_f16 v[128:131], a[160:163], v[72:75], v[128:131]
    ds_read_b128 v[52:55], v6 offset:28928
    v_mfma_f32_16x16x32_f16 v[132:135], a[164:167], v[72:75], v[132:135]
    ds_read_b128 v[56:59], v7 offset:28928
    v_mfma_f32_16x16x32_f16 v[136:139], a[168:171], v[72:75], v[136:139]
    buffer_load_dwordx4 a[36:39], v3, s[12:15], s96 offen offset:1024
    v_mfma_f32_16x16x32_f16 v[140:143], a[172:175], v[72:75], v[140:143]
    v_mfma_f32_16x16x32_f16 v[160:163], a[144:147], v[60:63], v[160:163]
    v_mfma_f32_16x16x32_f16 v[164:167], a[148:151], v[60:63], v[164:167]
    v_mfma_f32_16x16x32_f16 v[168:171], a[152:155], v[60:63], v[168:171]
    buffer_load_dwordx4 a[40:43], v3, s[12:15], s96 offen offset:2048
    v_mfma_f32_16x16x32_f16 v[172:175], a[156:159], v[60:63], v[172:175]
    v_mfma_f32_16x16x32_f16 v[144:147], a[160:163], v[60:63], v[144:147]
    s_waitcnt lgkmcnt(2)
    v_pk_fma_f16 v64, v48, s28, v44
    v_mfma_f32_16x16x32_f16 v[148:151], a[164:167], v[60:63], v[148:151]
    v_pk_fma_f16 v65, v49, s28, v45
    v_mfma_f32_16x16x32_f16 v[152:155], a[168:171], v[60:63], v[152:155]
    v_pk_fma_f16 v66, v50, s28, v46
    v_mfma_f32_16x16x32_f16 v[156:159], a[172:175], v[60:63], v[156:159]
    v_pk_fma_f16 v67, v51, s28, v47
    s_waitcnt vmcnt(17)
    v_mfma_f32_16x16x32_f16 v[128:131], a[176:179], v[60:63], v[128:131]
    ds_read_b128 v[20:23], v6 offset:30016
    buffer_load_dwordx4 a[44:47], v3, s[12:15], s96 offen offset:3072
    v_mfma_f32_16x16x32_f16 v[132:135], a[180:183], v[60:63], v[132:135]
    ds_read_b128 v[24:27], v7 offset:30016
    s_add_u32 s96, s96, 49152
    v_mfma_f32_16x16x32_f16 v[136:139], a[184:187], v[60:63], v[136:139]
    v_mfma_f32_16x16x32_f16 v[140:143], a[188:191], v[60:63], v[140:143]
    s_add_u32 m0, s30, 24576
    v_mfma_f32_16x16x32_f16 v[176:179], a[144:147], v[64:67], v[176:179]
    buffer_load_dwordx4 v8, s[8:11], s51 offen lds
    v_mfma_f32_16x16x32_f16 v[180:183], a[148:151], v[64:67], v[180:183]
    v_mfma_f32_16x16x32_f16 v[184:187], a[152:155], v[64:67], v[184:187]
    v_mfma_f32_16x16x32_f16 v[188:191], a[156:159], v[64:67], v[188:191]
    v_mfma_f32_16x16x32_f16 v[160:163], a[160:163], v[64:67], v[160:163]
    s_waitcnt lgkmcnt(2)
    v_pk_fma_f16 v68, v56, s28, v52
    v_mfma_f32_16x16x32_f16 v[164:167], a[164:167], v[64:67], v[164:167]
    v_pk_fma_f16 v69, v57, s28, v53
    s_add_u32 m0, s30, 28672
    v_mfma_f32_16x16x32_f16 v[168:171], a[168:171], v[64:67], v[168:171]
    v_pk_fma_f16 v70, v58, s28, v54
    buffer_load_dwordx4 v9, s[8:11], s51 offen lds
    v_mfma_f32_16x16x32_f16 v[172:175], a[172:175], v[64:67], v[172:175]
    v_pk_fma_f16 v71, v59, s28, v55
    v_mfma_f32_16x16x32_f16 v[144:147], a[176:179], v[64:67], v[144:147]
    ds_read_b128 v[28:31], v6 offset:31104
    v_mfma_f32_16x16x32_f16 v[148:151], a[180:183], v[64:67], v[148:151]
    ds_read_b128 v[32:35], v7 offset:31104
    s_add_u32 m0, s30, 32768
    v_mfma_f32_16x16x32_f16 v[152:155], a[184:187], v[64:67], v[152:155]
    buffer_load_dwordx4 v10, s[8:11], s51 offen lds
    v_mfma_f32_16x16x32_f16 v[156:159], a[188:191], v[64:67], v[156:159]
    v_mfma_f32_16x16x32_f16 v[192:195], a[144:147], v[68:71], v[192:195]
    v_mfma_f32_16x16x32_f16 v[196:199], a[148:151], v[68:71], v[196:199]
    s_add_u32 m0, s30, 36864
    v_mfma_f32_16x16x32_f16 v[200:203], a[152:155], v[68:71], v[200:203]
    buffer_load_dwordx4 v11, s[8:11], s51 offen lds
    v_mfma_f32_16x16x32_f16 v[204:207], a[156:159], v[68:71], v[204:207]
    v_mfma_f32_16x16x32_f16 v[176:179], a[160:163], v[68:71], v[176:179]
    s_waitcnt lgkmcnt(2)
    v_pk_fma_f16 v72, v24, s28, v20
    v_mfma_f32_16x16x32_f16 v[180:183], a[164:167], v[68:71], v[180:183]
    v_pk_fma_f16 v73, v25, s28, v21
    v_mfma_f32_16x16x32_f16 v[184:187], a[168:171], v[68:71], v[184:187]
    v_pk_fma_f16 v74, v26, s28, v22
    v_mfma_f32_16x16x32_f16 v[188:191], a[172:175], v[68:71], v[188:191]
    v_pk_fma_f16 v75, v27, s28, v23
    v_mfma_f32_16x16x32_f16 v[160:163], a[176:179], v[68:71], v[160:163]
    ds_read_b128 v[36:39], v6 offset:32192
    v_mfma_f32_16x16x32_f16 v[164:167], a[180:183], v[68:71], v[164:167]
    ds_read_b128 v[40:43], v7 offset:32192
    s_add_u32 m0, s30, 40960
    v_mfma_f32_16x16x32_f16 v[168:171], a[184:187], v[68:71], v[168:171]
    buffer_load_dwordx4 v12, s[8:11], s51 offen lds
    v_mfma_f32_16x16x32_f16 v[172:175], a[188:191], v[68:71], v[172:175]
    v_mfma_f32_16x16x32_f16 v[208:211], a[144:147], v[72:75], v[208:211]
    v_mfma_f32_16x16x32_f16 v[212:215], a[148:151], v[72:75], v[212:215]
    s_add_u32 m0, s30, 45056
    v_mfma_f32_16x16x32_f16 v[216:219], a[152:155], v[72:75], v[216:219]
    buffer_load_dwordx4 v13, s[8:11], s51 offen lds
    v_mfma_f32_16x16x32_f16 v[220:223], a[156:159], v[72:75], v[220:223]
    s_add_u32 s51, s51, 2228224
    v_mfma_f32_16x16x32_f16 v[192:195], a[160:163], v[72:75], v[192:195]
    s_waitcnt lgkmcnt(2)
    v_pk_fma_f16 v60, v32, s28, v28
    v_mfma_f32_16x16x32_f16 v[196:199], a[164:167], v[72:75], v[196:199]
    v_pk_fma_f16 v61, v33, s28, v29
    v_mfma_f32_16x16x32_f16 v[200:203], a[168:171], v[72:75], v[200:203]
    v_pk_fma_f16 v62, v34, s28, v30
    v_mfma_f32_16x16x32_f16 v[204:207], a[172:175], v[72:75], v[204:207]
    v_pk_fma_f16 v63, v35, s28, v31
    v_mfma_f32_16x16x32_f16 v[176:179], a[176:179], v[72:75], v[176:179]
    ds_read_b128 v[44:47], v6 offset:33280
    buffer_load_dwordx4 a[48:51], v1, s[12:15], s97 offen offset:0
    v_mfma_f32_16x16x32_f16 v[180:183], a[180:183], v[72:75], v[180:183]
    ds_read_b128 v[48:51], v7 offset:33280
    v_mfma_f32_16x16x32_f16 v[184:187], a[184:187], v[72:75], v[184:187]
    v_mfma_f32_16x16x32_f16 v[188:191], a[188:191], v[72:75], v[188:191]
    s_waitcnt vmcnt(19)
    s_barrier
    v_mfma_f32_16x16x32_f16 v[224:227], a[144:147], v[60:63], v[224:227]
    v_mfma_f32_16x16x32_f16 v[228:231], a[148:151], v[60:63], v[228:231]
    v_mfma_f32_16x16x32_f16 v[232:235], a[152:155], v[60:63], v[232:235]
    buffer_load_dwordx4 a[52:55], v1, s[12:15], s97 offen offset:1024
    v_mfma_f32_16x16x32_f16 v[236:239], a[156:159], v[60:63], v[236:239]
    v_mfma_f32_16x16x32_f16 v[208:211], a[160:163], v[60:63], v[208:211]
    s_waitcnt lgkmcnt(2)
    v_pk_fma_f16 v64, v40, s28, v36
    ds_read_b128 v[52:55], v6 offset:34368
    v_mfma_f32_16x16x32_f16 v[212:215], a[164:167], v[60:63], v[212:215]
    v_pk_fma_f16 v65, v41, s28, v37
    ds_read_b128 v[56:59], v7 offset:34368
    v_mfma_f32_16x16x32_f16 v[216:219], a[168:171], v[60:63], v[216:219]
    v_pk_fma_f16 v66, v42, s28, v38
    buffer_load_dwordx4 a[56:59], v1, s[12:15], s97 offen offset:2048
    v_mfma_f32_16x16x32_f16 v[220:223], a[172:175], v[60:63], v[220:223]
    v_pk_fma_f16 v67, v43, s28, v39
    v_mfma_f32_16x16x32_f16 v[192:195], a[176:179], v[60:63], v[192:195]
    ds_read_b128 v[20:23], v4 offset:0
    v_mfma_f32_16x16x32_f16 v[196:199], a[180:183], v[60:63], v[196:199]
    ds_read_b128 v[24:27], v5 offset:0
    v_mfma_f32_16x16x32_f16 v[200:203], a[184:187], v[60:63], v[200:203]
    buffer_load_dwordx4 a[60:63], v1, s[12:15], s97 offen offset:3072
    v_mfma_f32_16x16x32_f16 v[204:207], a[188:191], v[60:63], v[204:207]
    v_mfma_f32_16x16x32_f16 v[240:243], a[144:147], v[64:67], v[240:243]
    ds_read_b128 v[28:31], v4 offset:1088
    v_mfma_f32_16x16x32_f16 v[244:247], a[148:151], v[64:67], v[244:247]
    ds_read_b128 v[32:35], v5 offset:1088
    v_mfma_f32_16x16x32_f16 v[248:251], a[152:155], v[64:67], v[248:251]
    v_mfma_f32_16x16x32_f16 v[252:255], a[156:159], v[64:67], v[252:255]
    buffer_load_dwordx4 a[64:67], v2, s[12:15], s97 offen offset:0
    v_mfma_f32_16x16x32_f16 v[224:227], a[160:163], v[64:67], v[224:227]
    s_waitcnt lgkmcnt(6)
    v_pk_fma_f16 v68, v48, s28, v44
    v_mfma_f32_16x16x32_f16 v[228:231], a[164:167], v[64:67], v[228:231]
    v_pk_fma_f16 v69, v49, s28, v45
    v_mfma_f32_16x16x32_f16 v[232:235], a[168:171], v[64:67], v[232:235]
    v_pk_fma_f16 v70, v50, s28, v46
    v_mfma_f32_16x16x32_f16 v[236:239], a[172:175], v[64:67], v[236:239]
    v_pk_fma_f16 v71, v51, s28, v47
    buffer_load_dwordx4 a[68:71], v2, s[12:15], s97 offen offset:1024
    v_mfma_f32_16x16x32_f16 v[208:211], a[176:179], v[64:67], v[208:211]
    ds_read_b128 v[36:39], v4 offset:2176
    v_mfma_f32_16x16x32_f16 v[212:215], a[180:183], v[64:67], v[212:215]
    ds_read_b128 v[40:43], v5 offset:2176
    v_mfma_f32_16x16x32_f16 v[216:219], a[184:187], v[64:67], v[216:219]
    v_mfma_f32_16x16x32_f16 v[220:223], a[188:191], v[64:67], v[220:223]
    buffer_load_dwordx4 a[72:75], v2, s[12:15], s97 offen offset:2048
    v_mfma_f32_16x16x32_f16 v[240:243], a[160:163], v[68:71], v[240:243]
    s_waitcnt lgkmcnt(6)
    v_pk_fma_f16 v72, v56, s28, v52
    v_mfma_f32_16x16x32_f16 v[244:247], a[164:167], v[68:71], v[244:247]
    v_pk_fma_f16 v73, v57, s28, v53
    v_mfma_f32_16x16x32_f16 v[248:251], a[168:171], v[68:71], v[248:251]
    v_pk_fma_f16 v74, v58, s28, v54
    v_mfma_f32_16x16x32_f16 v[252:255], a[172:175], v[68:71], v[252:255]
    v_pk_fma_f16 v75, v59, s28, v55
    v_mfma_f32_16x16x32_f16 v[224:227], a[176:179], v[68:71], v[224:227]
    s_waitcnt lgkmcnt(4)
    v_pk_fma_f16 v60, v24, s28, v20
    v_mfma_f32_16x16x32_f16 v[228:231], a[180:183], v[68:71], v[228:231]
    v_pk_fma_f16 v61, v25, s28, v21
    v_mfma_f32_16x16x32_f16 v[232:235], a[184:187], v[68:71], v[232:235]
    buffer_load_dwordx4 a[76:79], v2, s[12:15], s97 offen offset:3072
    v_pk_fma_f16 v62, v26, s28, v22
    v_mfma_f32_16x16x32_f16 v[236:239], a[188:191], v[68:71], v[236:239]
    v_pk_fma_f16 v63, v27, s28, v23
    v_mfma_f32_16x16x32_f16 v[240:243], a[176:179], v[72:75], v[240:243]
    s_waitcnt lgkmcnt(2)
    v_pk_fma_f16 v64, v32, s28, v28
    ds_read_b128 v[44:47], v4 offset:3264
    v_mfma_f32_16x16x32_f16 v[244:247], a[180:183], v[72:75], v[244:247]
    v_pk_fma_f16 v65, v33, s28, v29
    ds_read_b128 v[48:51], v5 offset:3264
    v_mfma_f32_16x16x32_f16 v[248:251], a[184:187], v[72:75], v[248:251]
    v_pk_fma_f16 v66, v34, s28, v30
    v_mfma_f32_16x16x32_f16 v[252:255], a[188:191], v[72:75], v[252:255]
    s_waitcnt vmcnt(22)
    v_pk_fma_f16 v67, v35, s28, v31
    s_sub_u32 s26, s26, 1
    s_cmp_lg_u32 s26, 0
    s_cbranch_scc1 L2_loopf
    v_mfma_f32_16x16x32_f16 v[128:131], a[0:3], v[60:63], v[128:131]
    v_mfma_f32_16x16x32_f16 v[132:135], a[4:7], v[60:63], v[132:135]
    buffer_load_dwordx4 a[80:83], v3, s[12:15], s97 offen offset:0
    v_mfma_f32_16x16x32_f16 v[136:139], a[8:11], v[60:63], v[136:139]
    v_mfma_f32_16x16x32_f16 v[140:143], a[12:15], v[60:63], v[140:143]
    buffer_load_dwordx4 a[192:195], v1, s[12:15], s27 offen offset:0
    v_mfma_f32_16x16x32_f16 v[144:147], a[0:3], v[64:67], v[144:147]
    s_waitcnt lgkmcnt(2)
    v_pk_fma_f16 v68, v40, s28, v36
    v_mfma_f32_16x16x32_f16 v[148:151], a[4:7], v[64:67], v[148:151]
    v_pk_fma_f16 v69, v41, s28, v37
    v_mfma_f32_16x16x32_f16 v[152:155], a[8:11], v[64:67], v[152:155]
    v_pk_fma_f16 v70, v42, s28, v38
    v_mfma_f32_16x16x32_f16 v[156:159], a[12:15], v[64:67], v[156:159]
    v_pk_fma_f16 v71, v43, s28, v39
    s_waitcnt vmcnt(20)
    v_mfma_f32_16x16x32_f16 v[128:131], a[16:19], v[64:67], v[128:131]
    ds_read_b128 v[52:55], v4 offset:4352
    v_mfma_f32_16x16x32_f16 v[132:135], a[20:23], v[64:67], v[132:135]
    ds_read_b128 v[56:59], v5 offset:4352
    v_mfma_f32_16x16x32_f16 v[136:139], a[24:27], v[64:67], v[136:139]
    buffer_load_dwordx4 a[84:87], v3, s[12:15], s97 offen offset:1024
    v_mfma_f32_16x16x32_f16 v[140:143], a[28:31], v[64:67], v[140:143]
    v_mfma_f32_16x16x32_f16 v[160:163], a[0:3], v[68:71], v[160:163]
    v_mfma_f32_16x16x32_f16 v[164:167], a[4:7], v[68:71], v[164:167]
    v_mfma_f32_16x16x32_f16 v[168:171], a[8:11], v[68:71], v[168:171]
    buffer_load_dwordx4 a[88:91], v3, s[12:15], s97 offen offset:2048
    v_mfma_f32_16x16x32_f16 v[172:175], a[12:15], v[68:71], v[172:175]
    v_mfma_f32_16x16x32_f16 v[144:147], a[16:19], v[68:71], v[144:147]
    s_waitcnt lgkmcnt(2)
    v_pk_fma_f16 v72, v48, s28, v44
    v_mfma_f32_16x16x32_f16 v[148:151], a[20:23], v[68:71], v[148:151]
    v_pk_fma_f16 v73, v49, s28, v45
    buffer_load_dwordx4 v[76:79], v18, s[16:19], 0 offen offset:0 nt
    v_mfma_f32_16x16x32_f16 v[152:155], a[24:27], v[68:71], v[152:155]
    v_pk_fma_f16 v74, v50, s28, v46
    v_mfma_f32_16x16x32_f16 v[156:159], a[28:31], v[68:71], v[156:159]
    v_pk_fma_f16 v75, v51, s28, v47
    s_waitcnt vmcnt(19)
    v_mfma_f32_16x16x32_f16 v[128:131], a[32:35], v[68:71], v[128:131]
    ds_read_b128 v[20:23], v4 offset:5440
    buffer_load_dwordx4 a[92:95], v3, s[12:15], s97 offen offset:3072
    v_mfma_f32_16x16x32_f16 v[132:135], a[36:39], v[68:71], v[132:135]
    ds_read_b128 v[24:27], v5 offset:5440
    s_add_u32 s97, s97, 49152
    v_mfma_f32_16x16x32_f16 v[136:139], a[40:43], v[68:71], v[136:139]
    v_mfma_f32_16x16x32_f16 v[140:143], a[44:47], v[68:71], v[140:143]
    s_add_u32 m0, s30, 49152
    v_mfma_f32_16x16x32_f16 v[176:179], a[0:3], v[72:75], v[176:179]
    buffer_load_dwordx4 v8, s[8:11], s68 offen lds
    v_mfma_f32_16x16x32_f16 v[180:183], a[4:7], v[72:75], v[180:183]
    v_mfma_f32_16x16x32_f16 v[184:187], a[8:11], v[72:75], v[184:187]
    buffer_load_dwordx4 a[196:199], v1, s[12:15], s27 offen offset:1024
    v_mfma_f32_16x16x32_f16 v[188:191], a[12:15], v[72:75], v[188:191]
    v_mfma_f32_16x16x32_f16 v[160:163], a[16:19], v[72:75], v[160:163]
    s_waitcnt lgkmcnt(2)
    v_pk_fma_f16 v60, v56, s28, v52
    v_mfma_f32_16x16x32_f16 v[164:167], a[20:23], v[72:75], v[164:167]
    v_pk_fma_f16 v61, v57, s28, v53
    s_add_u32 m0, s30, 53248
    v_mfma_f32_16x16x32_f16 v[168:171], a[24:27], v[72:75], v[168:171]
    v_pk_fma_f16 v62, v58, s28, v54
    buffer_load_dwordx4 v9, s[8:11], s68 offen lds
    v_mfma_f32_16x16x32_f16 v[172:175], a[28:31], v[72:75], v[172:175]
    v_pk_fma_f16 v63, v59, s28, v55
    v_mfma_f32_16x16x32_f16 v[144:147], a[32:35], v[72:75], v[144:147]
    ds_read_b128 v[28:31], v4 offset:6528
    v_mfma_f32_16x16x32_f16 v[148:151], a[36:39], v[72:75], v[148:151]
    ds_read_b128 v[32:35], v5 offset:6528
    s_add_u32 m0, s30, 57344
    v_mfma_f32_16x16x32_f16 v[152:155], a[40:43], v[72:75], v[152:155]
    buffer_load_dwordx4 v10, s[8:11], s68 offen lds
    v_mfma_f32_16x16x32_f16 v[156:159], a[44:47], v[72:75], v[156:159]
    v_mfma_f32_16x16x32_f16 v[192:195], a[0:3], v[60:63], v[192:195]
    v_mfma_f32_16x16x32_f16 v[196:199], a[4:7], v[60:63], v[196:199]
    s_add_u32 m0, s30, 61440
    v_mfma_f32_16x16x32_f16 v[200:203], a[8:11], v[60:63], v[200:203]
    buffer_load_dwordx4 v11, s[8:11], s68 offen lds
    v_mfma_f32_16x16x32_f16 v[204:207], a[12:15], v[60:63], v[204:207]
    v_mfma_f32_16x16x32_f16 v[176:179], a[16:19], v[60:63], v[176:179]
    s_waitcnt lgkmcnt(2)
    v_pk_fma_f16 v64, v24, s28, v20
    v_mfma_f32_16x16x32_f16 v[180:183], a[20:23], v[60:63], v[180:183]
    v_pk_fma_f16 v65, v25, s28, v21
    v_mfma_f32_16x16x32_f16 v[184:187], a[24:27], v[60:63], v[184:187]
    v_pk_fma_f16 v66, v26, s28, v22
    v_mfma_f32_16x16x32_f16 v[188:191], a[28:31], v[60:63], v[188:191]
    v_pk_fma_f16 v67, v27, s28, v23
    v_mfma_f32_16x16x32_f16 v[160:163], a[32:35], v[60:63], v[160:163]
    ds_read_b128 v[36:39], v4 offset:7616
    v_mfma_f32_16x16x32_f16 v[164:167], a[36:39], v[60:63], v[164:167]
    ds_read_b128 v[40:43], v5 offset:7616
    s_add_u32 m0, s30, 65536
    v_mfma_f32_16x16x32_f16 v[168:171], a[40:43], v[60:63], v[168:171]
    buffer_load_dwordx4 v12, s[8:11], s68 offen lds
    v_mfma_f32_16x16x32_f16 v[172:175], a[44:47], v[60:63], v[172:175]
    v_mfma_f32_16x16x32_f16 v[208:211], a[0:3], v[64:67], v[208:211]
    buffer_load_dwordx4 a[200:203], v1, s[12:15], s27 offen offset:2048
    v_mfma_f32_16x16x32_f16 v[212:215], a[4:7], v[64:67], v[212:215]
    s_add_u32 m0, s30, 69632
    v_mfma_f32_16x16x32_f16 v[216:219], a[8:11], v[64:67], v[216:219]
    buffer_load_dwordx4 v13, s[8:11], s68 offen lds
    v_mfma_f32_16x16x32_f16 v[220:223], a[12:15], v[64:67], v[220:223]
    s_add_u32 s68, s68, 2228224
    v_mfma_f32_16x16x32_f16 v[192:195], a[16:19], v[64:67], v[192:195]
    s_waitcnt lgkmcnt(2)
    v_pk_fma_f16 v68, v32, s28, v28
    v_mfma_f32_16x16x32_f16 v[196:199], a[20:23], v[64:67], v[196:199]
    v_pk_fma_f16 v69, v33, s28, v29
    v_mfma_f32_16x16x32_f16 v[200:203], a[24:27], v[64:67], v[200:203]
    v_pk_fma_f16 v70, v34, s28, v30
    v_mfma_f32_16x16x32_f16 v[204:207], a[28:31], v[64:67], v[204:207]
    v_pk_fma_f16 v71, v35, s28, v31
    v_mfma_f32_16x16x32_f16 v[176:179], a[32:35], v[64:67], v[176:179]
    ds_read_b128 v[44:47], v4 offset:8704
    buffer_load_dwordx4 a[96:99], v1, s[12:15], s98 offen offset:0
    v_mfma_f32_16x16x32_f16 v[180:183], a[36:39], v[64:67], v[180:183]
    ds_read_b128 v[48:51], v5 offset:8704
    v_mfma_f32_16x16x32_f16 v[184:187], a[40:43], v[64:67], v[184:187]
    buffer_load_dwordx4 v[80:83], v18, s[16:19], 0 offen offset:1024 nt
    v_mfma_f32_16x16x32_f16 v[188:191], a[44:47], v[64:67], v[188:191]
    s_waitcnt vmcnt(24)
    s_barrier
    v_mfma_f32_16x16x32_f16 v[224:227], a[0:3], v[68:71], v[224:227]
    v_mfma_f32_16x16x32_f16 v[228:231], a[4:7], v[68:71], v[228:231]
    v_mfma_f32_16x16x32_f16 v[232:235], a[8:11], v[68:71], v[232:235]
    buffer_load_dwordx4 a[100:103], v1, s[12:15], s98 offen offset:1024
    v_mfma_f32_16x16x32_f16 v[236:239], a[12:15], v[68:71], v[236:239]
    v_mfma_f32_16x16x32_f16 v[208:211], a[16:19], v[68:71], v[208:211]
    s_waitcnt lgkmcnt(2)
    v_pk_fma_f16 v72, v40, s28, v36
    ds_read_b128 v[52:55], v4 offset:9792
    v_mfma_f32_16x16x32_f16 v[212:215], a[20:23], v[68:71], v[212:215]
    v_pk_fma_f16 v73, v41, s28, v37
    ds_read_b128 v[56:59], v5 offset:9792
    v_mfma_f32_16x16x32_f16 v[216:219], a[24:27], v[68:71], v[216:219]
    v_pk_fma_f16 v74, v42, s28, v38
    buffer_load_dwordx4 a[104:107], v1, s[12:15], s98 offen offset:2048
    v_mfma_f32_16x16x32_f16 v[220:223], a[28:31], v[68:71], v[220:223]
    v_pk_fma_f16 v75, v43, s28, v39
    v_mfma_f32_16x16x32_f16 v[192:195], a[32:35], v[68:71], v[192:195]
    ds_read_b128 v[20:23], v4 offset:24576
    v_mfma_f32_16x16x32_f16 v[196:199], a[36:39], v[68:71], v[196:199]
    ds_read_b128 v[24:27], v5 offset:24576
    v_mfma_f32_16x16x32_f16 v[200:203], a[40:43], v[68:71], v[200:203]
    buffer_load_dwordx4 a[108:111], v1, s[12:15], s98 offen offset:3072
    v_mfma_f32_16x16x32_f16 v[204:207], a[44:47], v[68:71], v[204:207]
    buffer_load_dwordx4 a[204:207], v1, s[12:15], s27 offen offset:3072
    v_mfma_f32_16x16x32_f16 v[240:243], a[0:3], v[72:75], v[240:243]
    ds_read_b128 v[28:31], v4 offset:25664
    v_mfma_f32_16x16x32_f16 v[244:247], a[4:7], v[72:75], v[244:247]
    ds_read_b128 v[32:35], v5 offset:25664
    v_mfma_f32_16x16x32_f16 v[248:251], a[8:11], v[72:75], v[248:251]
    v_mfma_f32_16x16x32_f16 v[252:255], a[12:15], v[72:75], v[252:255]
    buffer_load_dwordx4 a[112:115], v2, s[12:15], s98 offen offset:0
    v_mfma_f32_16x16x32_f16 v[224:227], a[16:19], v[72:75], v[224:227]
    s_waitcnt lgkmcnt(6)
    v_pk_fma_f16 v60, v48, s28, v44
    v_mfma_f32_16x16x32_f16 v[228:231], a[20:23], v[72:75], v[228:231]
    v_pk_fma_f16 v61, v49, s28, v45
    v_mfma_f32_16x16x32_f16 v[232:235], a[24:27], v[72:75], v[232:235]
    v_pk_fma_f16 v62, v50, s28, v46
    v_mfma_f32_16x16x32_f16 v[236:239], a[28:31], v[72:75], v[236:239]
    v_pk_fma_f16 v63, v51, s28, v47
    buffer_load_dwordx4 a[116:119], v2, s[12:15], s98 offen offset:1024
    v_mfma_f32_16x16x32_f16 v[208:211], a[32:35], v[72:75], v[208:211]
    ds_read_b128 v[36:39], v4 offset:26752
    v_mfma_f32_16x16x32_f16 v[212:215], a[36:39], v[72:75], v[212:215]
    ds_read_b128 v[40:43], v5 offset:26752
    v_mfma_f32_16x16x32_f16 v[216:219], a[40:43], v[72:75], v[216:219]
    v_mfma_f32_16x16x32_f16 v[220:223], a[44:47], v[72:75], v[220:223]
    buffer_load_dwordx4 a[120:123], v2, s[12:15], s98 offen offset:2048
    v_mfma_f32_16x16x32_f16 v[240:243], a[16:19], v[60:63], v[240:243]
    s_waitcnt lgkmcnt(6)
    v_pk_fma_f16 v64, v56, s28, v52
    v_mfma_f32_16x16x32_f16 v[244:247], a[20:23], v[60:63], v[244:247]
    v_pk_fma_f16 v65, v57, s28, v53
    v_mfma_f32_16x16x32_f16 v[248:251], a[24:27], v[60:63], v[248:251]
    v_pk_fma_f16 v66, v58, s28, v54
    v_mfma_f32_16x16x32_f16 v[252:255], a[28:31], v[60:63], v[252:255]
    v_pk_fma_f16 v67, v59, s28, v55
    v_mfma_f32_16x16x32_f16 v[224:227], a[32:35], v[60:63], v[224:227]
    s_waitcnt lgkmcnt(4)
    v_pk_fma_f16 v68, v24, s28, v20
    v_mfma_f32_16x16x32_f16 v[228:231], a[36:39], v[60:63], v[228:231]
    v_pk_fma_f16 v69, v25, s28, v21
    v_mfma_f32_16x16x32_f16 v[232:235], a[40:43], v[60:63], v[232:235]
    buffer_load_dwordx4 a[124:127], v2, s[12:15], s98 offen offset:3072
    v_pk_fma_f16 v70, v26, s28, v22
    v_mfma_f32_16x16x32_f16 v[236:239], a[44:47], v[60:63], v[236:239]
    v_pk_fma_f16 v71, v27, s28, v23
    v_mfma_f32_16x16x32_f16 v[240:243], a[32:35], v[64:67], v[240:243]
    s_waitcnt lgkmcnt(2)
    v_pk_fma_f16 v72, v32, s28, v28
    ds_read_b128 v[44:47], v4 offset:27840
    v_mfma_f32_16x16x32_f16 v[244:247], a[36:39], v[64:67], v[244:247]
    v_pk_fma_f16 v73, v33, s28, v29
    ds_read_b128 v[48:51], v5 offset:27840
    v_mfma_f32_16x16x32_f16 v[248:251], a[40:43], v[64:67], v[248:251]
    v_pk_fma_f16 v74, v34, s28, v30
    v_mfma_f32_16x16x32_f16 v[252:255], a[44:47], v[64:67], v[252:255]
    s_waitcnt vmcnt(28)
    v_pk_fma_f16 v75, v35, s28, v31
    v_mfma_f32_16x16x32_f16 v[128:131], a[48:51], v[68:71], v[128:131]
    v_mfma_f32_16x16x32_f16 v[132:135], a[52:55], v[68:71], v[132:135]
    buffer_load_dwordx4 a[128:131], v3, s[12:15], s98 offen offset:0
    v_mfma_f32_16x16x32_f16 v[136:139], a[56:59], v[68:71], v[136:139]
    v_mfma_f32_16x16x32_f16 v[140:143], a[60:63], v[68:71], v[140:143]
    buffer_load_dwordx4 a[208:211], v2, s[12:15], s27 offen offset:0
    v_mfma_f32_16x16x32_f16 v[144:147], a[48:51], v[72:75], v[144:147]
    s_waitcnt lgkmcnt(2)
    v_pk_fma_f16 v60, v40, s28, v36
    v_mfma_f32_16x16x32_f16 v[148:151], a[52:55], v[72:75], v[148:151]
    v_pk_fma_f16 v61, v41, s28, v37
    v_mfma_f32_16x16x32_f16 v[152:155], a[56:59], v[72:75], v[152:155]
    v_pk_fma_f16 v62, v42, s28, v38
    v_mfma_f32_16x16x32_f16 v[156:159], a[60:63], v[72:75], v[156:159]
    v_pk_fma_f16 v63, v43, s28, v39
    s_waitcnt vmcnt(26)
    v_mfma_f32_16x16x32_f16 v[128:131], a[64:67], v[72:75], v[128:131]
    ds_read_b128 v[52:55], v4 offset:28928
    v_mfma_f32_16x16x32_f16 v[132:135], a[68:71], v[72:75], v[132:135]
    ds_read_b128 v[56:59], v5 offset:28928
    v_mfma_f32_16x16x32_f16 v[136:139], a[72:75], v[72:75], v[136:139]
    buffer_load_dwordx4 a[132:135], v3, s[12:15], s98 offen offset:1024
    v_mfma_f32_16x16x32_f16 v[140:143], a[76:79], v[72:75], v[140:143]
    v_mfma_f32_16x16x32_f16 v[160:163], a[48:51], v[60:63], v[160:163]
    v_mfma_f32_16x16x32_f16 v[164:167], a[52:55], v[60:63], v[164:167]
    v_mfma_f32_16x16x32_f16 v[168:171], a[56:59], v[60:63], v[168:171]
    buffer_load_dwordx4 a[136:139], v3, s[12:15], s98 offen offset:2048
    v_mfma_f32_16x16x32_f16 v[172:175], a[60:63], v[60:63], v[172:175]
    v_mfma_f32_16x16x32_f16 v[144:147], a[64:67], v[60:63], v[144:147]
    s_waitcnt lgkmcnt(2)
    v_pk_fma_f16 v64, v48, s28, v44
    v_mfma_f32_16x16x32_f16 v[148:151], a[68:71], v[60:63], v[148:151]
    v_pk_fma_f16 v65, v49, s28, v45
    buffer_load_dwordx4 v[84:87], v18, s[16:19], s48 offen offset:0 nt
    v_mfma_f32_16x16x32_f16 v[152:155], a[72:75], v[60:63], v[152:155]
    v_pk_fma_f16 v66, v50, s28, v46
    v_mfma_f32_16x16x32_f16 v[156:159], a[76:79], v[60:63], v[156:159]
    v_pk_fma_f16 v67, v51, s28, v47
    s_waitcnt vmcnt(23)
    v_mfma_f32_16x16x32_f16 v[128:131], a[80:83], v[60:63], v[128:131]
    ds_read_b128 v[20:23], v4 offset:30016
    buffer_load_dwordx4 a[140:143], v3, s[12:15], s98 offen offset:3072
    v_mfma_f32_16x16x32_f16 v[132:135], a[84:87], v[60:63], v[132:135]
    ds_read_b128 v[24:27], v5 offset:30016
    s_add_u32 s98, s98, 49152
    v_mfma_f32_16x16x32_f16 v[136:139], a[88:91], v[60:63], v[136:139]
    v_mfma_f32_16x16x32_f16 v[140:143], a[92:95], v[60:63], v[140:143]
    s_add_u32 m0, s30, 73728
    v_mfma_f32_16x16x32_f16 v[176:179], a[48:51], v[64:67], v[176:179]
    buffer_load_dwordx4 v8, s[8:11], s69 offen lds
    v_mfma_f32_16x16x32_f16 v[180:183], a[52:55], v[64:67], v[180:183]
    v_mfma_f32_16x16x32_f16 v[184:187], a[56:59], v[64:67], v[184:187]
    buffer_load_dwordx4 a[212:215], v2, s[12:15], s27 offen offset:1024
    v_mfma_f32_16x16x32_f16 v[188:191], a[60:63], v[64:67], v[188:191]
    v_mfma_f32_16x16x32_f16 v[160:163], a[64:67], v[64:67], v[160:163]
    s_waitcnt lgkmcnt(2)
    v_pk_fma_f16 v68, v56, s28, v52
    v_mfma_f32_16x16x32_f16 v[164:167], a[68:71], v[64:67], v[164:167]
    v_pk_fma_f16 v69, v57, s28, v53
    s_add_u32 m0, s30, 77824
    v_mfma_f32_16x16x32_f16 v[168:171], a[72:75], v[64:67], v[168:171]
    v_pk_fma_f16 v70, v58, s28, v54
    buffer_load_dwordx4 v9, s[8:11], s69 offen lds
    v_mfma_f32_16x16x32_f16 v[172:175], a[76:79], v[64:67], v[172:175]
    v_pk_fma_f16 v71, v59, s28, v55
    v_mfma_f32_16x16x32_f16 v[144:147], a[80:83], v[64:67], v[144:147]
    ds_read_b128 v[28:31], v4 offset:31104
    v_mfma_f32_16x16x32_f16 v[148:151], a[84:87], v[64:67], v[148:151]
    ds_read_b128 v[32:35], v5 offset:31104
    s_add_u32 m0, s30, 81920
    v_mfma_f32_16x16x32_f16 v[152:155], a[88:91], v[64:67], v[152:155]
    buffer_load_dwordx4 v10, s[8:11], s69 offen lds
    v_mfma_f32_16x16x32_f16 v[156:159], a[92:95], v[64:67], v[156:159]
    v_mfma_f32_16x16x32_f16 v[192:195], a[48:51], v[68:71], v[192:195]
    v_mfma_f32_16x16x32_f16 v[196:199], a[52:55], v[68:71], v[196:199]
    s_add_u32 m0, s30, 86016
    v_mfma_f32_16x16x32_f16 v[200:203], a[56:59], v[68:71], v[200:203]
    buffer_load_dwordx4 v11, s[8:11], s69 offen lds
    v_mfma_f32_16x16x32_f16 v[204:207], a[60:63], v[68:71], v[204:207]
    v_mfma_f32_16x16x32_f16 v[176:179], a[64:67], v[68:71], v[176:179]
    s_waitcnt lgkmcnt(2)
    v_pk_fma_f16 v72, v24, s28, v20
    v_mfma_f32_16x16x32_f16 v[180:183], a[68:71], v[68:71], v[180:183]
    v_pk_fma_f16 v73, v25, s28, v21
    v_mfma_f32_16x16x32_f16 v[184:187], a[72:75], v[68:71], v[184:187]
    v_pk_fma_f16 v74, v26, s28, v22
    v_mfma_f32_16x16x32_f16 v[188:191], a[76:79], v[68:71], v[188:191]
    v_pk_fma_f16 v75, v27, s28, v23
    v_mfma_f32_16x16x32_f16 v[160:163], a[80:83], v[68:71], v[160:163]
    ds_read_b128 v[36:39], v4 offset:32192
    v_mfma_f32_16x16x32_f16 v[164:167], a[84:87], v[68:71], v[164:167]
    ds_read_b128 v[40:43], v5 offset:32192
    s_add_u32 m0, s30, 90112
    v_mfma_f32_16x16x32_f16 v[168:171], a[88:91], v[68:71], v[168:171]
    buffer_load_dwordx4 v12, s[8:11], s69 offen lds
    v_mfma_f32_16x16x32_f16 v[172:175], a[92:95], v[68:71], v[172:175]
    v_mfma_f32_16x16x32_f16 v[208:211], a[48:51], v[72:75], v[208:211]
    buffer_load_dwordx4 a[216:219], v2, s[12:15], s27 offen offset:2048
    v_mfma_f32_16x16x32_f16 v[212:215], a[52:55], v[72:75], v[212:215]
    s_add_u32 m0, s30, 94208
    v_mfma_f32_16x16x32_f16 v[216:219], a[56:59], v[72:75], v[216:219]
    buffer_load_dwordx4 v13, s[8:11], s69 offen lds
    v_mfma_f32_16x16x32_f16 v[220:223], a[60:63], v[72:75], v[220:223]
    s_add_u32 s69, s69, 2228224
    v_mfma_f32_16x16x32_f16 v[192:195], a[64:67], v[72:75], v[192:195]
    s_waitcnt lgkmcnt(2)
    v_pk_fma_f16 v60, v32, s28, v28
    v_mfma_f32_16x16x32_f16 v[196:199], a[68:71], v[72:75], v[196:199]
    v_pk_fma_f16 v61, v33, s28, v29
    v_mfma_f32_16x16x32_f16 v[200:203], a[72:75], v[72:75], v[200:203]
    v_pk_fma_f16 v62, v34, s28, v30
    v_mfma_f32_16x16x32_f16 v[204:207], a[76:79], v[72:75], v[204:207]
    v_pk_fma_f16 v63, v35, s28, v31
    v_mfma_f32_16x16x32_f16 v[176:179], a[80:83], v[72:75], v[176:179]
    ds_read_b128 v[44:47], v4 offset:33280
    buffer_load_dwordx4 a[144:147], v1, s[12:15], s99 offen offset:0
    v_mfma_f32_16x16x32_f16 v[180:183], a[84:87], v[72:75], v[180:183]
    ds_read_b128 v[48:51], v5 offset:33280
    v_mfma_f32_16x16x32_f16 v[184:187], a[88:91], v[72:75], v[184:187]
    buffer_load_dwordx4 v[88:91], v18, s[16:19], s48 offen offset:1024 nt
    v_mfma_f32_16x16x32_f16 v[188:191], a[92:95], v[72:75], v[188:191]
    s_waitcnt vmcnt(26)
    s_barrier
    v_mfma_f32_16x16x32_f16 v[224:227], a[48:51], v[60:63], v[224:227]
    v_mfma_f32_16x16x32_f16 v[228:231], a[52:55], v[60:63], v[228:231]
    v_mfma_f32_16x16x32_f16 v[232:235], a[56:59], v[60:63], v[232:235]
    buffer_load_dwordx4 a[148:151], v1, s[12:15], s99 offen offset:1024
    v_mfma_f32_16x16x32_f16 v[236:239], a[60:63], v[60:63], v[236:239]
    v_mfma_f32_16x16x32_f16 v[208:211], a[64:67], v[60:63], v[208:211]
    s_waitcnt lgkmcnt(2)
    v_pk_fma_f16 v64, v40, s28, v36
    ds_read_b128 v[52:55], v4 offset:34368
    v_mfma_f32_16x16x32_f16 v[212:215], a[68:71], v[60:63], v[212:215]
    v_pk_fma_f16 v65, v41, s28, v37
    ds_read_b128 v[56:59], v5 offset:34368
    v_mfma_f32_16x16x32_f16 v[216:219], a[72:75], v[60:63], v[216:219]
    v_pk_fma_f16 v66, v42, s28, v38
    buffer_load_dwordx4 a[152:155], v1, s[12:15], s99 offen offset:2048
    v_mfma_f32_16x16x32_f16 v[220:223], a[76:79], v[60:63], v[220:223]
    v_pk_fma_f16 v67, v43, s28, v39
    v_mfma_f32_16x16x32_f16 v[192:195], a[80:83], v[60:63], v[192:195]
    ds_read_b128 v[20:23], v6 offset:0
    v_mfma_f32_16x16x32_f16 v[196:199], a[84:87], v[60:63], v[196:199]
    ds_read_b128 v[24:27], v7 offset:0
    v_mfma_f32_16x16x32_f16 v[200:203], a[88:91], v[60:63], v[200:203]
    buffer_load_dwordx4 a[156:159], v1, s[12:15], s99 offen offset:3072
    v_mfma_f32_16x16x32_f16 v[204:207], a[92:95], v[60:63], v[204:207]
    buffer_load_dwordx4 a[220:223], v2, s[12:15], s27 offen offset:3072
    s_add_u32 s27, s27, 0x10000
    v_mfma_f32_16x16x32_f16 v[240:243], a[48:51], v[64:67], v[240:243]
    ds_read_b128 v[28:31], v6 offset:1088
    v_mfma_f32_16x16x32_f16 v[244:247], a[52:55], v[64:67], v[244:247]
    ds_read_b128 v[32:35], v7 offset:1088
    v_mfma_f32_16x16x32_f16 v[248:251], a[56:59], v[64:67], v[248:251]
    v_mfma_f32_16x16x32_f16 v[252:255], a[60:63], v[64:67], v[252:255]
    buffer_load_dwordx4 a[160:163], v2, s[12:15], s99 offen offset:0
    v_mfma_f32_16x16x32_f16 v[224:227], a[64:67], v[64:67], v[224:227]
    s_waitcnt lgkmcnt(6)
    v_pk_fma_f16 v68, v48, s28, v44
    v_mfma_f32_16x16x32_f16 v[228:231], a[68:71], v[64:67], v[228:231]
    v_pk_fma_f16 v69, v49, s28, v45
    v_mfma_f32_16x16x32_f16 v[232:235], a[72:75], v[64:67], v[232:235]
    v_pk_fma_f16 v70, v50, s28, v46
    v_mfma_f32_16x16x32_f16 v[236:239], a[76:79], v[64:67], v[236:239]
    v_pk_fma_f16 v71, v51, s28, v47
    buffer_load_dwordx4 a[164:167], v2, s[12:15], s99 offen offset:1024
    v_mfma_f32_16x16x32_f16 v[208:211], a[80:83], v[64:67], v[208:211]
    ds_read_b128 v[36:39], v6 offset:2176
    v_mfma_f32_16x16x32_f16 v[212:215], a[84:87], v[64:67], v[212:215]
    ds_read_b128 v[40:43], v7 offset:2176
    v_mfma_f32_16x16x32_f16 v[216:219], a[88:91], v[64:67], v[216:219]
    v_mfma_f32_16x16x32_f16 v[220:223], a[92:95], v[64:67], v[220:223]
    buffer_load_dwordx4 a[168:171], v2, s[12:15], s99 offen offset:2048
    v_mfma_f32_16x16x32_f16 v[240:243], a[64:67], v[68:71], v[240:243]
    s_waitcnt lgkmcnt(6)
    v_pk_fma_f16 v72, v56, s28, v52
    v_mfma_f32_16x16x32_f16 v[244:247], a[68:71], v[68:71], v[244:247]
    v_pk_fma_f16 v73, v57, s28, v53
    v_mfma_f32_16x16x32_f16 v[248:251], a[72:75], v[68:71], v[248:251]
    v_pk_fma_f16 v74, v58, s28, v54
    v_mfma_f32_16x16x32_f16 v[252:255], a[76:79], v[68:71], v[252:255]
    v_pk_fma_f16 v75, v59, s28, v55
    v_mfma_f32_16x16x32_f16 v[224:227], a[80:83], v[68:71], v[224:227]
    s_waitcnt lgkmcnt(4)
    v_pk_fma_f16 v60, v24, s28, v20
    v_mfma_f32_16x16x32_f16 v[228:231], a[84:87], v[68:71], v[228:231]
    v_pk_fma_f16 v61, v25, s28, v21
    v_mfma_f32_16x16x32_f16 v[232:235], a[88:91], v[68:71], v[232:235]
    buffer_load_dwordx4 a[172:175], v2, s[12:15], s99 offen offset:3072
    v_pk_fma_f16 v62, v26, s28, v22
    v_mfma_f32_16x16x32_f16 v[236:239], a[92:95], v[68:71], v[236:239]
    v_pk_fma_f16 v63, v27, s28, v23
    v_mfma_f32_16x16x32_f16 v[240:243], a[80:83], v[72:75], v[240:243]
    s_waitcnt lgkmcnt(2)
    v_pk_fma_f16 v64, v32, s28, v28
    ds_read_b128 v[44:47], v6 offset:3264
    v_mfma_f32_16x16x32_f16 v[244:247], a[84:87], v[72:75], v[244:247]
    v_pk_fma_f16 v65, v33, s28, v29
    ds_read_b128 v[48:51], v7 offset:3264
    v_mfma_f32_16x16x32_f16 v[248:251], a[88:91], v[72:75], v[248:251]
    v_pk_fma_f16 v66, v34, s28, v30
    v_mfma_f32_16x16x32_f16 v[252:255], a[92:95], v[72:75], v[252:255]
    s_waitcnt vmcnt(29)
    v_pk_fma_f16 v67, v35, s28, v31
    v_mfma_f32_16x16x32_f16 v[128:131], a[96:99], v[60:63], v[128:131]
    v_mfma_f32_16x16x32_f16 v[132:135], a[100:103], v[60:63], v[132:135]
    buffer_load_dwordx4 a[176:179], v3, s[12:15], s99 offen offset:0
    v_mfma_f32_16x16x32_f16 v[136:139], a[104:107], v[60:63], v[136:139]
    v_mfma_f32_16x16x32_f16 v[140:143], a[108:111], v[60:63], v[140:143]
    buffer_load_dwordx4 a[224:227], v1, s[12:15], s27 offen offset:0
    v_mfma_f32_16x16x32_f16 v[144:147], a[96:99], v[64:67], v[144:147]
    s_waitcnt lgkmcnt(2)
    v_pk_fma_f16 v68, v40, s28, v36
    v_mfma_f32_16x16x32_f16 v[148:151], a[100:103], v[64:67], v[148:151]
    v_pk_fma_f16 v69, v41, s28, v37
    v_mfma_f32_16x16x32_f16 v[152:155], a[104:107], v[64:67], v[152:155]
    v_pk_fma_f16 v70, v42, s28, v38
    v_mfma_f32_16x16x32_f16 v[156:159], a[108:111], v[64:67], v[156:159]
    v_pk_fma_f16 v71, v43, s28, v39
    s_waitcnt vmcnt(26)
    v_mfma_f32_16x16x32_f16 v[128:131], a[112:115], v[64:67], v[128:131]
    ds_read_b128 v[52:55], v6 offset:4352
    v_mfma_f32_16x16x32_f16 v[132:135], a[116:119], v[64:67], v[132:135]
    ds_read_b128 v[56:59], v7 offset:4352
    v_mfma_f32_16x16x32_f16 v[136:139], a[120:123], v[64:67], v[136:139]
    buffer_load_dwordx4 a[180:183], v3, s[12:15], s99 offen offset:1024
    v_mfma_f32_16x16x32_f16 v[140:143], a[124:127], v[64:67], v[140:143]
    v_mfma_f32_16x16x32_f16 v[160:163], a[96:99], v[68:71], v[160:163]
    v_mfma_f32_16x16x32_f16 v[164:167], a[100:103], v[68:71], v[164:167]
    v_mfma_f32_16x16x32_f16 v[168:171], a[104:107], v[68:71], v[168:171]
    buffer_load_dwordx4 a[184:187], v3, s[12:15], s99 offen offset:2048
    v_mfma_f32_16x16x32_f16 v[172:175], a[108:111], v[68:71], v[172:175]
    v_mfma_f32_16x16x32_f16 v[144:147], a[112:115], v[68:71], v[144:147]
    s_waitcnt lgkmcnt(2)
    v_pk_fma_f16 v72, v48, s28, v44
    v_mfma_f32_16x16x32_f16 v[148:151], a[116:119], v[68:71], v[148:151]
    v_pk_fma_f16 v73, v49, s28, v45
    buffer_load_dwordx4 v[92:95], v18, s[16:19], s49 offen offset:0 nt
    v_mfma_f32_16x16x32_f16 v[152:155], a[120:123], v[68:71], v[152:155]
    v_pk_fma_f16 v74, v50, s28, v46
    v_mfma_f32_16x16x32_f16 v[156:159], a[124:127], v[68:71], v[156:159]
    v_pk_fma_f16 v75, v51, s28, v47
    s_waitcnt vmcnt(23)
    v_mfma_f32_16x16x32_f16 v[128:131], a[128:131], v[68:71], v[128:131]
    ds_read_b128 v[20:23], v6 offset:5440
    buffer_load_dwordx4 a[188:191], v3, s[12:15], s99 offen offset:3072
    v_mfma_f32_16x16x32_f16 v[132:135], a[132:135], v[68:71], v[132:135]
    ds_read_b128 v[24:27], v7 offset:5440
    s_add_u32 s99, s99, 49152
    v_mfma_f32_16x16x32_f16 v[136:139], a[136:139], v[68:71], v[136:139]
    v_mfma_f32_16x16x32_f16 v[140:143], a[140:143], v[68:71], v[140:143]
    v_mfma_f32_16x16x32_f16 v[176:179], a[96:99], v[72:75], v[176:179]
    buffer_load_dwordx4 a[0:3], v1, s[12:15], s25 offen offset:0
    v_mfma_f32_16x16x32_f16 v[180:183], a[100:103], v[72:75], v[180:183]
    v_mfma_f32_16x16x32_f16 v[184:187], a[104:107], v[72:75], v[184:187]
    buffer_load_dwordx4 a[228:231], v1, s[12:15], s27 offen offset:1024
    v_mfma_f32_16x16x32_f16 v[188:191], a[108:111], v[72:75], v[188:191]
    v_mfma_f32_16x16x32_f16 v[160:163], a[112:115], v[72:75], v[160:163]
    s_waitcnt lgkmcnt(2)
    v_pk_fma_f16 v60, v56, s28, v52
    v_mfma_f32_16x16x32_f16 v[164:167], a[116:119], v[72:75], v[164:167]
    v_pk_fma_f16 v61, v57, s28, v53
    v_mfma_f32_16x16x32_f16 v[168:171], a[120:123], v[72:75], v[168:171]
    v_pk_fma_f16 v62, v58, s28, v54
    buffer_load_dwordx4 a[4:7], v1, s[12:15], s25 offen offset:1024
    v_mfma_f32_16x16x32_f16 v[172:175], a[124:127], v[72:75], v[172:175]
    v_pk_fma_f16 v63, v59, s28, v55
    v_mfma_f32_16x16x32_f16 v[144:147], a[128:131], v[72:75], v[144:147]
    ds_read_b128 v[28:31], v6 offset:6528
    v_mfma_f32_16x16x32_f16 v[148:151], a[132:135], v[72:75], v[148:151]
    ds_read_b128 v[32:35], v7 offset:6528
    v_mfma_f32_16x16x32_f16 v[152:155], a[136:139], v[72:75], v[152:155]
    buffer_load_dwordx4 a[8:11], v1, s[12:15], s25 offen offset:2048
    v_mfma_f32_16x16x32_f16 v[156:159], a[140:143], v[72:75], v[156:159]
    v_mfma_f32_16x16x32_f16 v[192:195], a[96:99], v[60:63], v[192:195]
    v_mfma_f32_16x16x32_f16 v[196:199], a[100:103], v[60:63], v[196:199]
    v_mfma_f32_16x16x32_f16 v[200:203], a[104:107], v[60:63], v[200:203]
    buffer_load_dwordx4 a[12:15], v1, s[12:15], s25 offen offset:3072
    v_mfma_f32_16x16x32_f16 v[204:207], a[108:111], v[60:63], v[204:207]
    v_mfma_f32_16x16x32_f16 v[176:179], a[112:115], v[60:63], v[176:179]
    s_waitcnt lgkmcnt(2)
    v_pk_fma_f16 v64, v24, s28, v20
    v_mfma_f32_16x16x32_f16 v[180:183], a[116:119], v[60:63], v[180:183]
    v_pk_fma_f16 v65, v25, s28, v21
    v_mfma_f32_16x16x32_f16 v[184:187], a[120:123], v[60:63], v[184:187]
    v_pk_fma_f16 v66, v26, s28, v22
    v_mfma_f32_16x16x32_f16 v[188:191], a[124:127], v[60:63], v[188:191]
    v_pk_fma_f16 v67, v27, s28, v23
    v_mfma_f32_16x16x32_f16 v[160:163], a[128:131], v[60:63], v[160:163]
    ds_read_b128 v[36:39], v6 offset:7616
    v_mfma_f32_16x16x32_f16 v[164:167], a[132:135], v[60:63], v[164:167]
    ds_read_b128 v[40:43], v7 offset:7616
    v_mfma_f32_16x16x32_f16 v[168:171], a[136:139], v[60:63], v[168:171]
    buffer_load_dwordx4 a[16:19], v2, s[12:15], s25 offen offset:0
    v_mfma_f32_16x16x32_f16 v[172:175], a[140:143], v[60:63], v[172:175]
    v_mfma_f32_16x16x32_f16 v[208:211], a[96:99], v[64:67], v[208:211]
    v_mfma_f32_16x16x32_f16 v[212:215], a[100:103], v[64:67], v[212:215]
    v_mfma_f32_16x16x32_f16 v[216:219], a[104:107], v[64:67], v[216:219]
    buffer_load_dwordx4 a[20:23], v2, s[12:15], s25 offen offset:1024
    v_mfma_f32_16x16x32_f16 v[220:223], a[108:111], v[64:67], v[220:223]
    v_mfma_f32_16x16x32_f16 v[192:195], a[112:115], v[64:67], v[192:195]
    s_waitcnt lgkmcnt(2)
    v_pk_fma_f16 v68, v32, s28, v28
    v_mfma_f32_16x16x32_f16 v[196:199], a[116:119], v[64:67], v[196:199]
    v_pk_fma_f16 v69, v33, s28, v29
    v_mfma_f32_16x16x32_f16 v[200:203], a[120:123], v[64:67], v[200:203]
    v_pk_fma_f16 v70, v34, s28, v30
    v_mfma_f32_16x16x32_f16 v[204:207], a[124:127], v[64:67], v[204:207]
    v_pk_fma_f16 v71, v35, s28, v31
    v_mfma_f32_16x16x32_f16 v[176:179], a[128:131], v[64:67], v[176:179]
    ds_read_b128 v[44:47], v6 offset:8704
    buffer_load_dwordx4 a[24:27], v2, s[12:15], s25 offen offset:2048
    v_mfma_f32_16x16x32_f16 v[180:183], a[132:135], v[64:67], v[180:183]
    ds_read_b128 v[48:51], v7 offset:8704
    v_mfma_f32_16x16x32_f16 v[184:187], a[136:139], v[64:67], v[184:187]
    buffer_load_dwordx4 v[96:99], v18, s[16:19], s49 offen offset:1024 nt
    v_mfma_f32_16x16x32_f16 v[188:191], a[140:143], v[64:67], v[188:191]
    s_waitcnt vmcnt(25)
    s_barrier
    v_mfma_f32_16x16x32_f16 v[224:227], a[96:99], v[68:71], v[224:227]
    v_mfma_f32_16x16x32_f16 v[228:231], a[100:103], v[68:71], v[228:231]
    v_mfma_f32_16x16x32_f16 v[232:235], a[104:107], v[68:71], v[232:235]
    buffer_load_dwordx4 a[28:31], v2, s[12:15], s25 offen offset:3072
    v_mfma_f32_16x16x32_f16 v[236:239], a[108:111], v[68:71], v[236:239]
    v_mfma_f32_16x16x32_f16 v[208:211], a[112:115], v[68:71], v[208:211]
    s_waitcnt lgkmcnt(2)
    v_pk_fma_f16 v72, v40, s28, v36
    ds_read_b128 v[52:55], v6 offset:9792
    v_mfma_f32_16x16x32_f16 v[212:215], a[116:119], v[68:71], v[212:215]
    v_pk_fma_f16 v73, v41, s28, v37
    ds_read_b128 v[56:59], v7 offset:9792
    v_mfma_f32_16x16x32_f16 v[216:219], a[120:123], v[68:71], v[216:219]
    v_pk_fma_f16 v74, v42, s28, v38
    buffer_load_dwordx4 a[32:35], v3, s[12:15], s25 offen offset:0
    v_mfma_f32_16x16x32_f16 v[220:223], a[124:127], v[68:71], v[220:223]
    v_pk_fma_f16 v75, v43, s28, v39
    v_mfma_f32_16x16x32_f16 v[192:195], a[128:131], v[68:71], v[192:195]
    ds_read_b128 v[20:23], v6 offset:24576
    v_mfma_f32_16x16x32_f16 v[196:199], a[132:135], v[68:71], v[196:199]
    ds_read_b128 v[24:27], v7 offset:24576
    v_mfma_f32_16x16x32_f16 v[200:203], a[136:139], v[68:71], v[200:203]
    buffer_load_dwordx4 a[36:39], v3, s[12:15], s25 offen offset:1024
    v_mfma_f32_16x16x32_f16 v[204:207], a[140:143], v[68:71], v[204:207]
    v_mfma_f32_16x16x32_f16 v[240:243], a[96:99], v[72:75], v[240:243]
    ds_read_b128 v[28:31], v6 offset:25664
    v_mfma_f32_16x16x32_f16 v[244:247], a[100:103], v[72:75], v[244:247]
    ds_read_b128 v[32:35], v7 offset:25664
    v_mfma_f32_16x16x32_f16 v[248:251], a[104:107], v[72:75], v[248:251]
    v_mfma_f32_16x16x32_f16 v[252:255], a[108:111], v[72:75], v[252:255]
    buffer_load_dwordx4 a[40:43], v3, s[12:15], s25 offen offset:2048
    v_mfma_f32_16x16x32_f16 v[224:227], a[112:115], v[72:75], v[224:227]
    s_waitcnt lgkmcnt(6)
    v_pk_fma_f16 v60, v48, s28, v44
    v_mfma_f32_16x16x32_f16 v[228:231], a[116:119], v[72:75], v[228:231]
    v_pk_fma_f16 v61, v49, s28, v45
    v_mfma_f32_16x16x32_f16 v[232:235], a[120:123], v[72:75], v[232:235]
    v_pk_fma_f16 v62, v50, s28, v46
    v_mfma_f32_16x16x32_f16 v[236:239], a[124:127], v[72:75], v[236:239]
    v_pk_fma_f16 v63, v51, s28, v47
    buffer_load_dwordx4 a[44:47], v3, s[12:15], s25 offen offset:3072
    s_add_u32 s25, s25, 12288
    v_mfma_f32_16x16x32_f16 v[208:211], a[128:131], v[72:75], v[208:211]
    ds_read_b128 v[36:39], v6 offset:26752
    v_mfma_f32_16x16x32_f16 v[212:215], a[132:135], v[72:75], v[212:215]
    ds_read_b128 v[40:43], v7 offset:26752
    v_mfma_f32_16x16x32_f16 v[216:219], a[136:139], v[72:75], v[216:219]
    v_mfma_f32_16x16x32_f16 v[220:223], a[140:143], v[72:75], v[220:223]
    buffer_load_dwordx4 a[48:51], v1, s[12:15], s25 offen offset:0
    v_mfma_f32_16x16x32_f16 v[240:243], a[112:115], v[60:63], v[240:243]
    s_waitcnt lgkmcnt(6)
    v_pk_fma_f16 v64, v56, s28, v52
    v_mfma_f32_16x16x32_f16 v[244:247], a[116:119], v[60:63], v[244:247]
    v_pk_fma_f16 v65, v57, s28, v53
    v_mfma_f32_16x16x32_f16 v[248:251], a[120:123], v[60:63], v[248:251]
    v_pk_fma_f16 v66, v58, s28, v54
    v_mfma_f32_16x16x32_f16 v[252:255], a[124:127], v[60:63], v[252:255]
    v_pk_fma_f16 v67, v59, s28, v55
    v_mfma_f32_16x16x32_f16 v[224:227], a[128:131], v[60:63], v[224:227]
    s_waitcnt lgkmcnt(4)
    v_pk_fma_f16 v68, v24, s28, v20
    v_mfma_f32_16x16x32_f16 v[228:231], a[132:135], v[60:63], v[228:231]
    v_pk_fma_f16 v69, v25, s28, v21
    v_mfma_f32_16x16x32_f16 v[232:235], a[136:139], v[60:63], v[232:235]
    buffer_load_dwordx4 a[52:55], v1, s[12:15], s25 offen offset:1024
    v_pk_fma_f16 v70, v26, s28, v22
    v_mfma_f32_16x16x32_f16 v[236:239], a[140:143], v[60:63], v[236:239]
    v_pk_fma_f16 v71, v27, s28, v23
    v_mfma_f32_16x16x32_f16 v[240:243], a[128:131], v[64:67], v[240:243]
    s_waitcnt lgkmcnt(2)
    v_pk_fma_f16 v72, v32, s28, v28
    ds_read_b128 v[44:47], v6 offset:27840
    v_mfma_f32_16x16x32_f16 v[244:247], a[132:135], v[64:67], v[244:247]
    v_pk_fma_f16 v73, v33, s28, v29
    ds_read_b128 v[48:51], v7 offset:27840
    v_mfma_f32_16x16x32_f16 v[248:251], a[136:139], v[64:67], v[248:251]
    v_pk_fma_f16 v74, v34, s28, v30
    v_mfma_f32_16x16x32_f16 v[252:255], a[140:143], v[64:67], v[252:255]
    s_waitcnt vmcnt(27)
    v_pk_fma_f16 v75, v35, s28, v31
    v_mfma_f32_16x16x32_f16 v[128:131], a[144:147], v[68:71], v[128:131]
    v_mfma_f32_16x16x32_f16 v[132:135], a[148:151], v[68:71], v[132:135]
    buffer_load_dwordx4 a[56:59], v1, s[12:15], s25 offen offset:2048
    v_mfma_f32_16x16x32_f16 v[136:139], a[152:155], v[68:71], v[136:139]
    v_mfma_f32_16x16x32_f16 v[140:143], a[156:159], v[68:71], v[140:143]
    v_mfma_f32_16x16x32_f16 v[144:147], a[144:147], v[72:75], v[144:147]
    s_waitcnt lgkmcnt(2)
    v_pk_fma_f16 v60, v40, s28, v36
    buffer_load_dwordx4 a[60:63], v1, s[12:15], s25 offen offset:3072
    v_mfma_f32_16x16x32_f16 v[148:151], a[148:151], v[72:75], v[148:151]
    v_pk_fma_f16 v61, v41, s28, v37
    v_mfma_f32_16x16x32_f16 v[152:155], a[152:155], v[72:75], v[152:155]
    v_pk_fma_f16 v62, v42, s28, v38
    v_mfma_f32_16x16x32_f16 v[156:159], a[156:159], v[72:75], v[156:159]
    v_pk_fma_f16 v63, v43, s28, v39
    s_waitcnt vmcnt(24)
    v_mfma_f32_16x16x32_f16 v[128:131], a[160:163], v[72:75], v[128:131]
    ds_read_b128 v[52:55], v6 offset:28928
    buffer_load_dwordx4 a[64:67], v2, s[12:15], s25 offen offset:0
    v_mfma_f32_16x16x32_f16 v[132:135], a[164:167], v[72:75], v[132:135]
    ds_read_b128 v[56:59], v7 offset:28928
    v_mfma_f32_16x16x32_f16 v[136:139], a[168:171], v[72:75], v[136:139]
    v_mfma_f32_16x16x32_f16 v[140:143], a[172:175], v[72:75], v[140:143]
    v_mfma_f32_16x16x32_f16 v[160:163], a[144:147], v[60:63], v[160:163]
    buffer_load_dwordx4 a[68:71], v2, s[12:15], s25 offen offset:1024
    v_mfma_f32_16x16x32_f16 v[164:167], a[148:151], v[60:63], v[164:167]
    v_mfma_f32_16x16x32_f16 v[168:171], a[152:155], v[60:63], v[168:171]
    v_mfma_f32_16x16x32_f16 v[172:175], a[156:159], v[60:63], v[172:175]
    v_mfma_f32_16x16x32_f16 v[144:147], a[160:163], v[60:63], v[144:147]
    s_waitcnt lgkmcnt(2)
    v_pk_fma_f16 v64, v48, s28, v44
    buffer_load_dwordx4 a[72:75], v2, s[12:15], s25 offen offset:2048
    v_mfma_f32_16x16x32_f16 v[148:151], a[164:167], v[60:63], v[148:151]
    v_pk_fma_f16 v65, v49, s28, v45
    buffer_load_dwordx4 v[100:103], v18, s[16:19], s50 offen offset:0 nt
    v_mfma_f32_16x16x32_f16 v[152:155], a[168:171], v[60:63], v[152:155]
    v_pk_fma_f16 v66, v50, s28, v46
    v_mfma_f32_16x16x32_f16 v[156:159], a[172:175], v[60:63], v[156:159]
    v_pk_fma_f16 v67, v51, s28, v47
    s_waitcnt vmcnt(22)
    v_mfma_f32_16x16x32_f16 v[128:131], a[176:179], v[60:63], v[128:131]
    ds_read_b128 v[20:23], v6 offset:30016
    buffer_load_dwordx4 a[76:79], v2, s[12:15], s25 offen offset:3072
    v_mfma_f32_16x16x32_f16 v[132:135], a[180:183], v[60:63], v[132:135]
    ds_read_b128 v[24:27], v7 offset:30016
    v_mfma_f32_16x16x32_f16 v[136:139], a[184:187], v[60:63], v[136:139]
    v_mfma_f32_16x16x32_f16 v[140:143], a[188:191], v[60:63], v[140:143]
    v_mfma_f32_16x16x32_f16 v[176:179], a[144:147], v[64:67], v[176:179]
    buffer_load_dwordx4 a[80:83], v3, s[12:15], s25 offen offset:0
    v_mfma_f32_16x16x32_f16 v[180:183], a[148:151], v[64:67], v[180:183]
    v_mfma_f32_16x16x32_f16 v[184:187], a[152:155], v[64:67], v[184:187]
    v_mfma_f32_16x16x32_f16 v[188:191], a[156:159], v[64:67], v[188:191]
    v_mfma_f32_16x16x32_f16 v[160:163], a[160:163], v[64:67], v[160:163]
    s_waitcnt lgkmcnt(2)
    v_pk_fma_f16 v68, v56, s28, v52
    buffer_load_dwordx4 a[84:87], v3, s[12:15], s25 offen offset:1024
    v_mfma_f32_16x16x32_f16 v[164:167], a[164:167], v[64:67], v[164:167]
    v_pk_fma_f16 v69, v57, s28, v53
    v_mfma_f32_16x16x32_f16 v[168:171], a[168:171], v[64:67], v[168:171]
    v_pk_fma_f16 v70, v58, s28, v54
    v_mfma_f32_16x16x32_f16 v[172:175], a[172:175], v[64:67], v[172:175]
    v_pk_fma_f16 v71, v59, s28, v55
    v_mfma_f32_16x16x32_f16 v[144:147], a[176:179], v[64:67], v[144:147]
    ds_read_b128 v[28:31], v6 offset:31104
    buffer_load_dwordx4 a[88:91], v3, s[12:15], s25 offen offset:2048
    v_mfma_f32_16x16x32_f16 v[148:151], a[180:183], v[64:67], v[148:151]
    ds_read_b128 v[32:35], v7 offset:31104
    v_mfma_f32_16x16x32_f16 v[152:155], a[184:187], v[64:67], v[152:155]
    v_mfma_f32_16x16x32_f16 v[156:159], a[188:191], v[64:67], v[156:159]
    v_mfma_f32_16x16x32_f16 v[192:195], a[144:147], v[68:71], v[192:195]
    buffer_load_dwordx4 a[92:95], v3, s[12:15], s25 offen offset:3072
    s_add_u32 s25, s25, 12288
    v_mfma_f32_16x16x32_f16 v[196:199], a[148:151], v[68:71], v[196:199]
    v_mfma_f32_16x16x32_f16 v[200:203], a[152:155], v[68:71], v[200:203]
    v_mfma_f32_16x16x32_f16 v[204:207], a[156:159], v[68:71], v[204:207]
    v_mfma_f32_16x16x32_f16 v[176:179], a[160:163], v[68:71], v[176:179]
    s_waitcnt lgkmcnt(2)
    v_pk_fma_f16 v72, v24, s28, v20
    buffer_load_dwordx4 a[96:99], v1, s[12:15], s25 offen offset:0
    v_mul_f32 v128, s29, v128
    v_mfma_f32_16x16x32_f16 v[180:183], a[164:167], v[68:71], v[180:183]
    v_pk_fma_f16 v73, v25, s28, v21
    v_mul_f32 v129, s29, v129
    v_mfma_f32_16x16x32_f16 v[184:187], a[168:171], v[68:71], v[184:187]
    v_pk_fma_f16 v74, v26, s28, v22
    v_mul_f32 v130, s29, v130
    v_mfma_f32_16x16x32_f16 v[188:191], a[172:175], v[68:71], v[188:191]
    v_pk_fma_f16 v75, v27, s28, v23
    v_mul_f32 v131, s29, v131
    v_mfma_f32_16x16x32_f16 v[160:163], a[176:179], v[68:71], v[160:163]
    ds_read_b128 v[36:39], v6 offset:32192
    buffer_load_dwordx4 a[100:103], v1, s[12:15], s25 offen offset:1024
    v_mul_f32 v132, s29, v132
    v_mfma_f32_16x16x32_f16 v[164:167], a[180:183], v[68:71], v[164:167]
    ds_read_b128 v[40:43], v7 offset:32192
    v_mul_f32 v133, s29, v133
    v_mfma_f32_16x16x32_f16 v[168:171], a[184:187], v[68:71], v[168:171]
    v_mul_f32 v134, s29, v134
    v_mfma_f32_16x16x32_f16 v[172:175], a[188:191], v[68:71], v[172:175]
    v_mul_f32 v135, s29, v135
    v_mfma_f32_16x16x32_f16 v[208:211], a[144:147], v[72:75], v[208:211]
    buffer_load_dwordx4 a[104:107], v1, s[12:15], s25 offen offset:2048
    v_mul_f32 v136, s29, v136
    v_mfma_f32_16x16x32_f16 v[212:215], a[148:151], v[72:75], v[212:215]
    v_mul_f32 v137, s29, v137
    v_mfma_f32_16x16x32_f16 v[216:219], a[152:155], v[72:75], v[216:219]
    v_mul_f32 v138, s29, v138
    v_mfma_f32_16x16x32_f16 v[220:223], a[156:159], v[72:75], v[220:223]
    buffer_load_dwordx4 a[108:111], v1, s[12:15], s25 offen offset:3072
    v_mul_f32 v139, s29, v139
    v_mfma_f32_16x16x32_f16 v[192:195], a[160:163], v[72:75], v[192:195]
    s_waitcnt lgkmcnt(2)
    v_pk_fma_f16 v60, v32, s28, v28
    v_mul_f32 v140, s29, v140
    v_mfma_f32_16x16x32_f16 v[196:199], a[164:167], v[72:75], v[196:199]
    v_pk_fma_f16 v61, v33, s28, v29
    v_mul_f32 v141, s29, v141
    v_mfma_f32_16x16x32_f16 v[200:203], a[168:171], v[72:75], v[200:203]
    v_pk_fma_f16 v62, v34, s28, v30
    v_mul_f32 v142, s29, v142
    v_mfma_f32_16x16x32_f16 v[204:207], a[172:175], v[72:75], v[204:207]
    v_pk_fma_f16 v63, v35, s28, v31
    buffer_load_dwordx4 a[112:115], v2, s[12:15], s25 offen offset:0
    v_mul_f32 v143, s29, v143
    v_mfma_f32_16x16x32_f16 v[176:179], a[176:179], v[72:75], v[176:179]
    ds_read_b128 v[44:47], v6 offset:33280
    v_mfma_f32_16x16x32_f16 v[180:183], a[180:183], v[72:75], v[180:183]
    ds_read_b128 v[48:51], v7 offset:33280
    v_mfma_f32_16x16x32_f16 v[184:187], a[184:187], v[72:75], v[184:187]
    buffer_load_dwordx4 v[104:107], v18, s[16:19], s50 offen offset:1024 nt
    v_mfma_f32_16x16x32_f16 v[188:191], a[188:191], v[72:75], v[188:191]
    buffer_load_dwordx4 a[116:119], v2, s[12:15], s25 offen offset:1024
    v_mfma_f32_16x16x32_f16 v[224:227], a[144:147], v[60:63], v[224:227]
    v_mfma_f32_16x16x32_f16 v[228:231], a[148:151], v[60:63], v[228:231]
    v_mfma_f32_16x16x32_f16 v[232:235], a[152:155], v[60:63], v[232:235]
    v_mfma_f32_16x16x32_f16 v[236:239], a[156:159], v[60:63], v[236:239]
    buffer_load_dwordx4 a[120:123], v2, s[12:15], s25 offen offset:2048
    v_mfma_f32_16x16x32_f16 v[208:211], a[160:163], v[60:63], v[208:211]
    s_waitcnt lgkmcnt(2)
    v_pk_fma_f16 v64, v40, s28, v36
    ds_read_b128 v[52:55], v6 offset:34368
    v_mfma_f32_16x16x32_f16 v[212:215], a[164:167], v[60:63], v[212:215]
    v_pk_fma_f16 v65, v41, s28, v37
    ds_read_b128 v[56:59], v7 offset:34368
    v_mfma_f32_16x16x32_f16 v[216:219], a[168:171], v[60:63], v[216:219]
    v_pk_fma_f16 v66, v42, s28, v38
    v_mfma_f32_16x16x32_f16 v[220:223], a[172:175], v[60:63], v[220:223]
    v_pk_fma_f16 v67, v43, s28, v39
    buffer_load_dwordx4 a[124:127], v2, s[12:15], s25 offen offset:3072
    v_mfma_f32_16x16x32_f16 v[192:195], a[176:179], v[60:63], v[192:195]
    v_mfma_f32_16x16x32_f16 v[196:199], a[180:183], v[60:63], v[196:199]
    v_mfma_f32_16x16x32_f16 v[200:203], a[184:187], v[60:63], v[200:203]
    v_mfma_f32_16x16x32_f16 v[204:207], a[188:191], v[60:63], v[204:207]
    buffer_load_dwordx4 a[232:235], v1, s[12:15], s27 offen offset:2048
    v_mfma_f32_16x16x32_f16 v[240:243], a[144:147], v[64:67], v[240:243]
    v_mfma_f32_16x16x32_f16 v[244:247], a[148:151], v[64:67], v[244:247]
    v_mfma_f32_16x16x32_f16 v[248:251], a[152:155], v[64:67], v[248:251]
    v_mfma_f32_16x16x32_f16 v[252:255], a[156:159], v[64:67], v[252:255]
    buffer_load_dwordx4 a[236:239], v1, s[12:15], s27 offen offset:3072
    v_mfma_f32_16x16x32_f16 v[224:227], a[160:163], v[64:67], v[224:227]
    s_waitcnt lgkmcnt(2)
    v_pk_fma_f16 v68, v48, s28, v44
    v_mfma_f32_16x16x32_f16 v[228:231], a[164:167], v[64:67], v[228:231]
    v_pk_fma_f16 v69, v49, s28, v45
    v_mfma_f32_16x16x32_f16 v[232:235], a[168:171], v[64:67], v[232:235]
    v_pk_fma_f16 v70, v50, s28, v46
    v_mfma_f32_16x16x32_f16 v[236:239], a[172:175], v[64:67], v[236:239]
    v_pk_fma_f16 v71, v51, s28, v47
    buffer_load_dwordx4 a[240:243], v2, s[12:15], s27 offen offset:0
    v_mfma_f32_16x16x32_f16 v[208:211], a[176:179], v[64:67], v[208:211]
    v_mfma_f32_16x16x32_f16 v[212:215], a[180:183], v[64:67], v[212:215]
    v_mfma_f32_16x16x32_f16 v[216:219], a[184:187], v[64:67], v[216:219]
    v_mfma_f32_16x16x32_f16 v[220:223], a[188:191], v[64:67], v[220:223]
    buffer_load_dwordx4 a[244:247], v2, s[12:15], s27 offen offset:1024
    v_mfma_f32_16x16x32_f16 v[240:243], a[160:163], v[68:71], v[240:243]
    s_waitcnt lgkmcnt(0)
    v_pk_fma_f16 v72, v56, s28, v52
    v_mfma_f32_16x16x32_f16 v[244:247], a[164:167], v[68:71], v[244:247]
    v_pk_fma_f16 v73, v57, s28, v53
    v_mfma_f32_16x16x32_f16 v[248:251], a[168:171], v[68:71], v[248:251]
    v_pk_fma_f16 v74, v58, s28, v54
    v_mfma_f32_16x16x32_f16 v[252:255], a[172:175], v[68:71], v[252:255]
    v_pk_fma_f16 v75, v59, s28, v55
    buffer_load_dwordx4 a[248:251], v2, s[12:15], s27 offen offset:2048
    v_mfma_f32_16x16x32_f16 v[224:227], a[176:179], v[68:71], v[224:227]
    v_mfma_f32_16x16x32_f16 v[228:231], a[180:183], v[68:71], v[228:231]
    v_mfma_f32_16x16x32_f16 v[232:235], a[184:187], v[68:71], v[232:235]
    v_mfma_f32_16x16x32_f16 v[236:239], a[188:191], v[68:71], v[236:239]
    buffer_load_dwordx4 a[252:255], v2, s[12:15], s27 offen offset:3072
    s_add_u32 s27, s27, 0x10000
    v_mfma_f32_16x16x32_f16 v[240:243], a[176:179], v[72:75], v[240:243]
    v_mfma_f32_16x16x32_f16 v[244:247], a[180:183], v[72:75], v[244:247]
    v_mfma_f32_16x16x32_f16 v[248:251], a[184:187], v[72:75], v[248:251]
    v_mfma_f32_16x16x32_f16 v[252:255], a[188:191], v[72:75], v[252:255]
    s_waitcnt vmcnt(6)
    v_mfma_f32_16x16x32_bf16 v[128:131], a[0:3], a[192:195], v[128:131]
    v_mfma_f32_16x16x32_bf16 v[132:135], a[4:7], a[192:195], v[132:135]
    buffer_load_dwordx4 v[20:23], v1, s[12:15], s27 offen offset:0
    v_mfma_f32_16x16x32_bf16 v[136:139], a[8:11], a[192:195], v[136:139]
    v_mul_f32 v144, s29, v144
    v_mul_f32 v145, s29, v145
    v_mfma_f32_16x16x32_bf16 v[140:143], a[12:15], a[192:195], v[140:143]
    v_mul_f32 v146, s29, v146
    v_mfma_f32_16x16x32_bf16 v[128:131], a[16:19], a[196:199], v[128:131]
    v_mul_f32 v147, s29, v147
    v_mfma_f32_16x16x32_bf16 v[132:135], a[20:23], a[196:199], v[132:135]
    v_mul_f32 v148, s29, v148
    v_mul_f32 v149, s29, v149
    v_mfma_f32_16x16x32_bf16 v[136:139], a[24:27], a[196:199], v[136:139]
    v_mul_f32 v150, s29, v150
    buffer_load_dwordx4 v[24:27], v1, s[12:15], s27 offen offset:1024
    v_mfma_f32_16x16x32_bf16 v[140:143], a[28:31], a[196:199], v[140:143]
    v_mul_f32 v151, s29, v151
    v_mfma_f32_16x16x32_bf16 v[128:131], a[32:35], a[200:203], v[128:131]
    v_mfma_f32_16x16x32_bf16 v[132:135], a[36:39], a[200:203], v[132:135]
    v_mul_f32 v152, s29, v152
    v_mul_f32 v153, s29, v153
    v_mfma_f32_16x16x32_bf16 v[136:139], a[40:43], a[200:203], v[136:139]
    v_mul_f32 v154, s29, v154
    v_mfma_f32_16x16x32_bf16 v[140:143], a[44:47], a[200:203], v[140:143]
    v_mul_f32 v155, s29, v155
    buffer_load_dwordx4 v[28:31], v1, s[12:15], s27 offen offset:2048
    v_mfma_f32_16x16x32_bf16 v[128:131], a[48:51], a[204:207], v[128:131]
    v_mul_f32 v156, s29, v156
    v_mul_f32 v157, s29, v157
    v_mfma_f32_16x16x32_bf16 v[132:135], a[52:55], a[204:207], v[132:135]
    v_mul_f32 v158, s29, v158
    v_mfma_f32_16x16x32_bf16 v[136:139], a[56:59], a[204:207], v[136:139]
    v_mfma_f32_16x16x32_bf16 v[140:143], a[60:63], a[204:207], v[140:143]
    v_mul_f32 v159, s29, v159
    v_mfma_f32_16x16x32_bf16 v[128:131], a[64:67], a[208:211], v[128:131]
    v_mul_f32 v160, s29, v160
    v_mul_f32 v161, s29, v161
    buffer_load_dwordx4 v[32:35], v1, s[12:15], s27 offen offset:3072
    v_mfma_f32_16x16x32_bf16 v[132:135], a[68:71], a[208:211], v[132:135]
    v_mul_f32 v162, s29, v162
    v_mfma_f32_16x16x32_bf16 v[136:139], a[72:75], a[208:211], v[136:139]
    v_mul_f32 v163, s29, v163
    v_mfma_f32_16x16x32_bf16 v[140:143], a[76:79], a[208:211], v[140:143]
    v_mul_f32 v164, s29, v164
    v_mul_f32 v165, s29, v165
    v_mfma_f32_16x16x32_bf16 v[128:131], a[80:83], a[212:215], v[128:131]
    s_barrier
    v_mfma_f32_16x16x32_bf16 v[132:135], a[84:87], a[212:215], v[132:135]
    v_mul_f32 v166, s29, v166
    buffer_load_dwordx4 v[36:39], v2, s[12:15], s27 offen offset:0
    v_mfma_f32_16x16x32_bf16 v[136:139], a[88:91], a[212:215], v[136:139]
    v_mul_f32 v167, s29, v167
    v_mfma_f32_16x16x32_bf16 v[140:143], a[92:95], a[212:215], v[140:143]
    v_mul_f32 v168, s29, v168
    v_mul_f32 v169, s29, v169
    v_mfma_f32_16x16x32_bf16 v[128:131], a[96:99], a[216:219], v[128:131]
    v_mul_f32 v170, s29, v170
    v_mfma_f32_16x16x32_bf16 v[132:135], a[100:103], a[216:219], v[132:135]
    v_mul_f32 v171, s29, v171
    v_mfma_f32_16x16x32_bf16 v[136:139], a[104:107], a[216:219], v[136:139]
    buffer_load_dwordx4 v[40:43], v2, s[12:15], s27 offen offset:1024
    v_mfma_f32_16x16x32_bf16 v[140:143], a[108:111], a[216:219], v[140:143]
    v_mul_f32 v172, s29, v172
    v_mul_f32 v173, s29, v173
    v_mfma_f32_16x16x32_bf16 v[128:131], a[112:115], a[220:223], v[128:131]
    v_mul_f32 v174, s29, v174
    v_mfma_f32_16x16x32_bf16 v[132:135], a[116:119], a[220:223], v[132:135]
    v_mul_f32 v175, s29, v175
    v_mfma_f32_16x16x32_bf16 v[136:139], a[120:123], a[220:223], v[136:139]
    v_mfma_f32_16x16x32_bf16 v[140:143], a[124:127], a[220:223], v[140:143]
    buffer_load_dwordx4 v[44:47], v2, s[12:15], s27 offen offset:2048
    s_waitcnt vmcnt(11)
    v_mfma_f32_16x16x32_bf16 v[144:147], a[0:3], a[224:227], v[144:147]
    v_mfma_f32_16x16x32_bf16 v[148:151], a[4:7], a[224:227], v[148:151]
    v_mfma_f32_16x16x32_bf16 v[152:155], a[8:11], a[224:227], v[152:155]
    v_mul_f32 v176, s29, v176
    v_mul_f32 v177, s29, v177
    v_mfma_f32_16x16x32_bf16 v[156:159], a[12:15], a[224:227], v[156:159]
    v_mul_f32 v178, s29, v178
    v_mfma_f32_16x16x32_bf16 v[144:147], a[16:19], a[228:231], v[144:147]
    v_mul_f32 v179, s29, v179
    buffer_load_dwordx4 v[48:51], v2, s[12:15], s27 offen offset:3072
    s_add_u32 s27, s27, 0x10000
    v_mfma_f32_16x16x32_bf16 v[148:151], a[20:23], a[228:231], v[148:151]
    v_mul_f32 v180, s29, v180
    v_mul_f32 v181, s29, v181
    v_mfma_f32_16x16x32_bf16 v[152:155], a[24:27], a[228:231], v[152:155]
    v_mul_f32 v182, s29, v182
    v_mfma_f32_16x16x32_bf16 v[156:159], a[28:31], a[228:231], v[156:159]
    v_mul_f32 v183, s29, v183
    v_mfma_f32_16x16x32_bf16 v[144:147], a[32:35], a[232:235], v[144:147]
    ds_write_b128 v14, v[128:131] offset:0
    v_mfma_f32_16x16x32_bf16 v[148:151], a[36:39], a[232:235], v[148:151]
    v_mul_f32 v184, s29, v184
    v_mul_f32 v185, s29, v185
    buffer_load_dwordx4 v[52:55], v1, s[12:15], s27 offen offset:0
    v_mfma_f32_16x16x32_bf16 v[152:155], a[40:43], a[232:235], v[152:155]
    v_mul_f32 v186, s29, v186
    v_mfma_f32_16x16x32_bf16 v[156:159], a[44:47], a[232:235], v[156:159]
    v_mul_f32 v187, s29, v187
    v_mfma_f32_16x16x32_bf16 v[144:147], a[48:51], a[236:239], v[144:147]
    v_mul_f32 v188, s29, v188
    v_mul_f32 v189, s29, v189
    v_mfma_f32_16x16x32_bf16 v[148:151], a[52:55], a[236:239], v[148:151]
    v_mul_f32 v190, s29, v190
    v_mfma_f32_16x16x32_bf16 v[152:155], a[56:59], a[236:239], v[152:155]
    ds_write_b128 v14, v[132:135] offset:1024
    buffer_load_dwordx4 v[56:59], v1, s[12:15], s27 offen offset:1024
    v_mfma_f32_16x16x32_bf16 v[156:159], a[60:63], a[236:239], v[156:159]
    v_mul_f32 v191, s29, v191
    s_waitcnt vmcnt(10)
    v_mfma_f32_16x16x32_bf16 v[144:147], a[64:67], a[240:243], v[144:147]
    v_mul_f32 v192, s29, v192
    v_mul_f32 v193, s29, v193
    v_mfma_f32_16x16x32_bf16 v[148:151], a[68:71], a[240:243], v[148:151]
    v_mul_f32 v194, s29, v194
    v_mfma_f32_16x16x32_bf16 v[152:155], a[72:75], a[240:243], v[152:155]
    v_mul_f32 v195, s29, v195
    v_mfma_f32_16x16x32_bf16 v[156:159], a[76:79], a[240:243], v[156:159]
    v_mul_f32 v196, s29, v196
    v_mul_f32 v197, s29, v197
    buffer_load_dwordx4 v[108:111], v1, s[12:15], s27 offen offset:2048
    v_mfma_f32_16x16x32_bf16 v[144:147], a[80:83], a[244:247], v[144:147]
    ds_write_b128 v15, v[136:139] offset:0
    v_mfma_f32_16x16x32_bf16 v[148:151], a[84:87], a[244:247], v[148:151]
    v_mul_f32 v198, s29, v198
    v_mfma_f32_16x16x32_bf16 v[152:155], a[88:91], a[244:247], v[152:155]
    v_mul_f32 v199, s29, v199
    v_mfma_f32_16x16x32_bf16 v[156:159], a[92:95], a[244:247], v[156:159]
    v_mul_f32 v200, s29, v200
    v_mul_f32 v201, s29, v201
    v_mfma_f32_16x16x32_bf16 v[144:147], a[96:99], a[248:251], v[144:147]
    v_mul_f32 v202, s29, v202
    buffer_load_dwordx4 v[112:115], v1, s[12:15], s27 offen offset:3072
    v_mfma_f32_16x16x32_bf16 v[148:151], a[100:103], a[248:251], v[148:151]
    v_mul_f32 v203, s29, v203
    v_mfma_f32_16x16x32_bf16 v[152:155], a[104:107], a[248:251], v[152:155]
    ds_write_b128 v15, v[140:143] offset:1024
    v_mfma_f32_16x16x32_bf16 v[156:159], a[108:111], a[248:251], v[156:159]
    v_mul_f32 v204, s29, v204
    v_mul_f32 v205, s29, v205
    v_mfma_f32_16x16x32_bf16 v[144:147], a[112:115], a[252:255], v[144:147]
    v_mul_f32 v206, s29, v206
    v_mfma_f32_16x16x32_bf16 v[148:151], a[116:119], a[252:255], v[148:151]
    v_mul_f32 v207, s29, v207
    buffer_load_dwordx4 v[116:119], v2, s[12:15], s27 offen offset:0
    v_mfma_f32_16x16x32_bf16 v[152:155], a[120:123], a[252:255], v[152:155]
    v_mfma_f32_16x16x32_bf16 v[156:159], a[124:127], a[252:255], v[156:159]
    s_waitcnt vmcnt(9)
    v_mfma_f32_16x16x32_bf16 v[160:163], a[0:3], v[20:23], v[160:163]
    v_mfma_f32_16x16x32_bf16 v[164:167], a[4:7], v[20:23], v[164:167]
    v_mfma_f32_16x16x32_bf16 v[168:171], a[8:11], v[20:23], v[168:171]
    v_mul_f32 v208, s29, v208
    v_mul_f32 v209, s29, v209
    buffer_load_dwordx4 v[120:123], v2, s[12:15], s27 offen offset:1024
    v_mfma_f32_16x16x32_bf16 v[172:175], a[12:15], v[20:23], v[172:175]
    v_mul_f32 v210, s29, v210
    v_mfma_f32_16x16x32_bf16 v[160:163], a[16:19], v[24:27], v[160:163]
    v_mul_f32 v211, s29, v211
    v_mfma_f32_16x16x32_bf16 v[164:167], a[20:23], v[24:27], v[164:167]
    v_mul_f32 v212, s29, v212
    v_mul_f32 v213, s29, v213
    v_mfma_f32_16x16x32_bf16 v[168:171], a[24:27], v[24:27], v[168:171]
    v_mul_f32 v214, s29, v214
    v_mfma_f32_16x16x32_bf16 v[172:175], a[28:31], v[24:27], v[172:175]
    v_mul_f32 v215, s29, v215
    buffer_load_dwordx4 a[128:131], v2, s[12:15], s27 offen offset:2048
    v_mfma_f32_16x16x32_bf16 v[160:163], a[32:35], v[28:31], v[160:163]
    ds_write_b128 v14, v[144:147] offset:16384
    v_mfma_f32_16x16x32_bf16 v[164:167], a[36:39], v[28:31], v[164:167]
    v_mul_f32 v216, s29, v216
    v_mul_f32 v217, s29, v217
    v_mfma_f32_16x16x32_bf16 v[168:171], a[40:43], v[28:31], v[168:171]
    v_mul_f32 v218, s29, v218
    v_mfma_f32_16x16x32_bf16 v[172:175], a[44:47], v[28:31], v[172:175]
    v_mul_f32 v219, s29, v219
    v_mfma_f32_16x16x32_bf16 v[160:163], a[48:51], v[32:35], v[160:163]
    v_mul_f32 v220, s29, v220
    v_mul_f32 v221, s29, v221
    buffer_load_dwordx4 a[132:135], v2, s[12:15], s27 offen offset:3072
    s_add_u32 s27, s27, 0x10000
    v_mfma_f32_16x16x32_bf16 v[164:167], a[52:55], v[32:35], v[164:167]
    v_mul_f32 v222, s29, v222
    v_mfma_f32_16x16x32_bf16 v[168:171], a[56:59], v[32:35], v[168:171]
    ds_write_b128 v14, v[148:151] offset:17408
    v_mfma_f32_16x16x32_bf16 v[172:175], a[60:63], v[32:35], v[172:175]
    v_mul_f32 v223, s29, v223
    s_waitcnt vmcnt(8)
    v_mfma_f32_16x16x32_bf16 v[160:163], a[64:67], v[36:39], v[160:163]
    v_mul_f32 v224, s29, v224
    v_mul_f32 v225, s29, v225
    v_mfma_f32_16x16x32_bf16 v[164:167], a[68:71], v[36:39], v[164:167]
    v_mul_f32 v226, s29, v226
    buffer_load_dwordx4 a[136:139], v1, s[12:15], s27 offen offset:0
    v_mfma_f32_16x16x32_bf16 v[168:171], a[72:75], v[36:39], v[168:171]
    v_mul_f32 v227, s29, v227
    v_mfma_f32_16x16x32_bf16 v[172:175], a[76:79], v[36:39], v[172:175]
    v_mul_f32 v228, s29, v228
    v_mul_f32 v229, s29, v229
    v_mfma_f32_16x16x32_bf16 v[160:163], a[80:83], v[40:43], v[160:163]
    ds_write_b128 v15, v[152:155] offset:16384
    v_mfma_f32_16x16x32_bf16 v[164:167], a[84:87], v[40:43], v[164:167]
    v_mul_f32 v230, s29, v230
    v_mfma_f32_16x16x32_bf16 v[168:171], a[88:91], v[40:43], v[168:171]
    v_mul_f32 v231, s29, v231
    buffer_load_dwordx4 a[140:143], v1, s[12:15], s27 offen offset:1024
    v_mfma_f32_16x16x32_bf16 v[172:175], a[92:95], v[40:43], v[172:175]
    v_mul_f32 v232, s29, v232
    v_mul_f32 v233, s29, v233
    v_mfma_f32_16x16x32_bf16 v[160:163], a[96:99], v[44:47], v[160:163]
    v_mul_f32 v234, s29, v234
    v_mfma_f32_16x16x32_bf16 v[164:167], a[100:103], v[44:47], v[164:167]
    v_mul_f32 v235, s29, v235
    v_mfma_f32_16x16x32_bf16 v[168:171], a[104:107], v[44:47], v[168:171]
    ds_write_b128 v15, v[156:159] offset:17408
    v_mfma_f32_16x16x32_bf16 v[172:175], a[108:111], v[44:47], v[172:175]
    v_mul_f32 v236, s29, v236
    v_mul_f32 v237, s29, v237
    buffer_load_dwordx4 a[144:147], v1, s[12:15], s27 offen offset:2048
    v_mfma_f32_16x16x32_bf16 v[160:163], a[112:115], v[48:51], v[160:163]
    v_mul_f32 v238, s29, v238
    v_mfma_f32_16x16x32_bf16 v[164:167], a[116:119], v[48:51], v[164:167]
    v_mul_f32 v239, s29, v239
    v_mfma_f32_16x16x32_bf16 v[168:171], a[120:123], v[48:51], v[168:171]
    v_mfma_f32_16x16x32_bf16 v[172:175], a[124:127], v[48:51], v[172:175]
    s_waitcnt lgkmcnt(0)
    s_barrier
    s_waitcnt vmcnt(7)
    v_mfma_f32_16x16x32_bf16 v[176:179], a[0:3], v[52:55], v[176:179]
    buffer_load_dwordx4 a[148:151], v1, s[12:15], s27 offen offset:3072
    ds_read_b128 v[128:131], v16 offset:0
    ds_read_b128 v[136:139], v16 offset:4096
    v_mfma_f32_16x16x32_bf16 v[180:183], a[4:7], v[52:55], v[180:183]
    ds_read_b128 v[144:147], v16 offset:8192
    ds_read_b128 v[152:155], v16 offset:12288
    v_mfma_f32_16x16x32_bf16 v[184:187], a[8:11], v[52:55], v[184:187]
    v_mul_f32 v240, s29, v240
    ds_read_b128 v[132:135], v16 offset:1024
    ds_read_b128 v[140:143], v16 offset:5120
    v_mfma_f32_16x16x32_bf16 v[188:191], a[12:15], v[52:55], v[188:191]
    v_mul_f32 v241, s29, v241
    ds_read_b128 v[148:151], v16 offset:9216
    ds_read_b128 v[156:159], v16 offset:13312
    v_mfma_f32_16x16x32_bf16 v[176:179], a[16:19], v[56:59], v[176:179]
    v_mfma_f32_16x16x32_bf16 v[180:183], a[20:23], v[56:59], v[180:183]
    v_mul_f32 v242, s29, v242
    buffer_load_dwordx4 a[152:155], v2, s[12:15], s27 offen offset:0
    v_mfma_f32_16x16x32_bf16 v[184:187], a[24:27], v[56:59], v[184:187]
    v_mul_f32 v243, s29, v243
    v_mfma_f32_16x16x32_bf16 v[188:191], a[28:31], v[56:59], v[188:191]
    v_mfma_f32_16x16x32_bf16 v[176:179], a[32:35], v[108:111], v[176:179]
    ds_write_b128 v14, v[160:163] offset:32768
    v_mfma_f32_16x16x32_bf16 v[180:183], a[36:39], v[108:111], v[180:183]
    v_mul_f32 v244, s29, v244
    v_mfma_f32_16x16x32_bf16 v[184:187], a[40:43], v[108:111], v[184:187]
    v_mul_f32 v245, s29, v245
    buffer_load_dwordx4 a[156:159], v2, s[12:15], s27 offen offset:1024
    s_waitcnt lgkmcnt(5)
    v_fmac_f32 v128, 0.5, v136
    v_mfma_f32_16x16x32_bf16 v[188:191], a[44:47], v[108:111], v[188:191]
    v_fma_f32 v152, v136, 0.5, -v152
    v_fmac_f32 v128, 0.5, v144
    v_mfma_f32_16x16x32_bf16 v[176:179], a[48:51], v[112:115], v[176:179]
    v_mul_f32 v246, s29, v246
    v_fmac_f32 v152, -0.5, v144
    v_fmac_f32 v129, 0.5, v137
    v_mfma_f32_16x16x32_bf16 v[180:183], a[52:55], v[112:115], v[180:183]
    v_mul_f32 v247, s29, v247
    v_fma_f32 v153, v137, 0.5, -v153
    v_fmac_f32 v129, 0.5, v145
    v_mfma_f32_16x16x32_bf16 v[184:187], a[56:59], v[112:115], v[184:187]
    ds_write_b128 v14, v[164:167] offset:33792
    v_mfma_f32_16x16x32_bf16 v[188:191], a[60:63], v[112:115], v[188:191]
    buffer_load_dwordx4 a[160:163], v2, s[12:15], s27 offen offset:2048
    v_fmac_f32 v153, -0.5, v145
    v_fmac_f32 v130, 0.5, v138
    s_waitcnt vmcnt(7)
    v_mfma_f32_16x16x32_bf16 v[176:179], a[64:67], v[116:119], v[176:179]
    v_mul_f32 v248, s29, v248
    v_fma_f32 v154, v138, 0.5, -v154
    v_mfma_f32_16x16x32_bf16 v[180:183], a[68:71], v[116:119], v[180:183]
    v_mul_f32 v249, s29, v249
    v_fmac_f32 v130, 0.5, v146
    v_fmac_f32 v154, -0.5, v146
    v_mfma_f32_16x16x32_bf16 v[184:187], a[72:75], v[116:119], v[184:187]
    v_fmac_f32 v131, 0.5, v139
    v_fma_f32 v155, v139, 0.5, -v155
    v_mfma_f32_16x16x32_bf16 v[188:191], a[76:79], v[116:119], v[188:191]
    v_mul_f32 v250, s29, v250
    v_fmac_f32 v131, 0.5, v147
    v_fmac_f32 v155, -0.5, v147
    v_mfma_f32_16x16x32_bf16 v[176:179], a[80:83], v[120:123], v[176:179]
    ds_write_b128 v15, v[168:171] offset:32768
    buffer_load_dwordx4 a[164:167], v2, s[12:15], s27 offen offset:3072
    s_add_u32 s27, s27, 0x10000
    v_mfma_f32_16x16x32_bf16 v[180:183], a[84:87], v[120:123], v[180:183]
    v_mul_f32 v251, s29, v251
    s_waitcnt lgkmcnt(3)
    v_fmac_f32 v132, 0.5, v140
    v_mfma_f32_16x16x32_bf16 v[184:187], a[88:91], v[120:123], v[184:187]
    v_fma_f32 v156, v140, 0.5, -v156
    v_fmac_f32 v132, 0.5, v148
    v_mfma_f32_16x16x32_bf16 v[188:191], a[92:95], v[120:123], v[188:191]
    v_mul_f32 v252, s29, v252
    v_fmac_f32 v156, -0.5, v148
    v_mfma_f32_16x16x32_bf16 v[176:179], a[96:99], a[128:131], v[176:179]
    v_mul_f32 v253, s29, v253
    v_fmac_f32 v133, 0.5, v141
    v_fma_f32 v157, v141, 0.5, -v157
    v_mfma_f32_16x16x32_bf16 v[180:183], a[100:103], a[128:131], v[180:183]
    buffer_load_dwordx4 a[168:171], v1, s[12:15], s27 offen offset:0
    v_fmac_f32 v133, 0.5, v149
    v_fmac_f32 v157, -0.5, v149
    v_mfma_f32_16x16x32_bf16 v[184:187], a[104:107], a[128:131], v[184:187]
    ds_write_b128 v15, v[172:175] offset:33792
    v_mfma_f32_16x16x32_bf16 v[188:191], a[108:111], a[128:131], v[188:191]
    v_mul_f32 v254, s29, v254
    v_fmac_f32 v134, 0.5, v142
    v_fma_f32 v158, v142, 0.5, -v158
    v_mfma_f32_16x16x32_bf16 v[176:179], a[112:115], a[132:135], v[176:179]
    v_mul_f32 v255, s29, v255
    v_fmac_f32 v134, 0.5, v150
    v_fmac_f32 v158, -0.5, v150
    v_mfma_f32_16x16x32_bf16 v[180:183], a[116:119], a[132:135], v[180:183]
    v_fmac_f32 v135, 0.5, v143
    v_fma_f32 v159, v143, 0.5, -v159
    v_mfma_f32_16x16x32_bf16 v[184:187], a[120:123], a[132:135], v[184:187]
    buffer_load_dwordx4 a[172:175], v1, s[12:15], s27 offen offset:1024
    v_fmac_f32 v135, 0.5, v151
    v_mfma_f32_16x16x32_bf16 v[188:191], a[124:127], a[132:135], v[188:191]
    v_fmac_f32 v159, -0.5, v151
    s_waitcnt vmcnt(6)
    v_mfma_f32_16x16x32_bf16 v[192:195], a[0:3], a[136:139], v[192:195]
    v_lshlrev_b32 v60, 16, v76
    v_and_b32 v61, 0xffff0000, v76
    v_mfma_f32_16x16x32_bf16 v[196:199], a[4:7], a[136:139], v[196:199]
    v_add_f32 v128, v128, v60
    v_add_f32 v129, v129, v61
    v_mfma_f32_16x16x32_bf16 v[200:203], a[8:11], a[136:139], v[200:203]
    v_cvt_pk_bf16_f32 v76, v128, v129
    v_lshlrev_b32 v62, 16, v77
    v_mfma_f32_16x16x32_bf16 v[204:207], a[12:15], a[136:139], v[204:207]
    buffer_load_dwordx4 a[176:179], v1, s[12:15], s27 offen offset:2048
    v_and_b32 v63, 0xffff0000, v77
    v_add_f32 v130, v130, v62
    v_mfma_f32_16x16x32_bf16 v[192:195], a[16:19], a[140:143], v[192:195]
    v_add_f32 v131, v131, v63
    v_mfma_f32_16x16x32_bf16 v[196:199], a[20:23], a[140:143], v[196:199]
    v_cvt_pk_bf16_f32 v77, v130, v131
    v_lshlrev_b32 v64, 16, v78
    v_mfma_f32_16x16x32_bf16 v[200:203], a[24:27], a[140:143], v[200:203]
    v_and_b32 v65, 0xffff0000, v78
    v_add_f32 v132, v132, v64
    v_mfma_f32_16x16x32_bf16 v[204:207], a[28:31], a[140:143], v[204:207]
    v_add_f32 v133, v133, v65
    v_cvt_pk_bf16_f32 v78, v132, v133
    v_mfma_f32_16x16x32_bf16 v[192:195], a[32:35], a[144:147], v[192:195]
    ds_write_b128 v14, v[176:179] offset:49152
    buffer_load_dwordx4 a[180:183], v1, s[12:15], s27 offen offset:3072
    v_mfma_f32_16x16x32_bf16 v[196:199], a[36:39], a[144:147], v[196:199]
    v_lshlrev_b32 v66, 16, v79
    v_and_b32 v67, 0xffff0000, v79
    v_mfma_f32_16x16x32_bf16 v[200:203], a[40:43], a[144:147], v[200:203]
    v_add_f32 v134, v134, v66
    v_add_f32 v135, v135, v67
    v_mfma_f32_16x16x32_bf16 v[204:207], a[44:47], a[144:147], v[204:207]
    v_cvt_pk_bf16_f32 v79, v134, v135
    v_mfma_f32_16x16x32_bf16 v[192:195], a[48:51], a[148:151], v[192:195]
    buffer_store_dwordx4 v[76:79], v18, s[20:23], 0 offen offset:0 sc1
    v_lshlrev_b32 v68, 16, v80
    v_mfma_f32_16x16x32_bf16 v[196:199], a[52:55], a[148:151], v[196:199]
    buffer_load_dwordx4 a[184:187], v2, s[12:15], s27 offen offset:0
    v_and_b32 v69, 0xffff0000, v80
    v_add_f32 v152, v152, v68
    v_mfma_f32_16x16x32_bf16 v[200:203], a[56:59], a[148:151], v[200:203]
    ds_write_b128 v14, v[180:183] offset:50176
    v_mfma_f32_16x16x32_bf16 v[204:207], a[60:63], a[148:151], v[204:207]
    v_add_f32 v153, v153, v69
    v_cvt_pk_bf16_f32 v80, v152, v153
    s_waitcnt vmcnt(6)
    v_mfma_f32_16x16x32_bf16 v[192:195], a[64:67], a[152:155], v[192:195]
    v_lshlrev_b32 v70, 16, v81
    v_and_b32 v71, 0xffff0000, v81
    v_mfma_f32_16x16x32_bf16 v[196:199], a[68:71], a[152:155], v[196:199]
    v_add_f32 v154, v154, v70
    v_add_f32 v155, v155, v71
    v_mfma_f32_16x16x32_bf16 v[200:203], a[72:75], a[152:155], v[200:203]
    buffer_load_dwordx4 a[188:191], v2, s[12:15], s27 offen offset:1024
    v_cvt_pk_bf16_f32 v81, v154, v155
    v_mfma_f32_16x16x32_bf16 v[204:207], a[76:79], a[152:155], v[204:207]
    v_lshlrev_b32 v72, 16, v82
    v_and_b32 v73, 0xffff0000, v82
    v_mfma_f32_16x16x32_bf16 v[192:195], a[80:83], a[156:159], v[192:195]
    ds_write_b128 v15, v[184:187] offset:49152
    v_mfma_f32_16x16x32_bf16 v[196:199], a[84:87], a[156:159], v[196:199]
    v_add_f32 v156, v156, v72
    v_add_f32 v157, v157, v73
    v_mfma_f32_16x16x32_bf16 v[200:203], a[88:91], a[156:159], v[200:203]
    v_cvt_pk_bf16_f32 v82, v156, v157
    v_lshlrev_b32 v74, 16, v83
    v_mfma_f32_16x16x32_bf16 v[204:207], a[92:95], a[156:159], v[204:207]
    buffer_load_dwordx4 a[192:195], v2, s[12:15], s27 offen offset:2048
    v_and_b32 v75, 0xffff0000, v83
    v_add_f32 v158, v158, v74
    v_mfma_f32_16x16x32_bf16 v[192:195], a[96:99], a[160:163], v[192:195]
    v_add_f32 v159, v159, v75
    v_cvt_pk_bf16_f32 v83, v158, v159
    v_mfma_f32_16x16x32_bf16 v[196:199], a[100:103], a[160:163], v[196:199]
    buffer_load_dwordx4 a[196:199], v2, s[12:15], s27 offen offset:3072
    s_add_u32 s27, s27, 0x10000
    buffer_store_dwordx4 v[80:83], v18, s[20:23], 0 offen offset:1024 sc1
    v_mfma_f32_16x16x32_bf16 v[200:203], a[104:107], a[160:163], v[200:203]
    ds_write_b128 v15, v[188:191] offset:50176
    v_mfma_f32_16x16x32_bf16 v[204:207], a[108:111], a[160:163], v[204:207]
    buffer_load_dwordx4 a[200:203], v1, s[12:15], s27 offen offset:0
    v_mfma_f32_16x16x32_bf16 v[192:195], a[112:115], a[164:167], v[192:195]
    v_mfma_f32_16x16x32_bf16 v[196:199], a[116:119], a[164:167], v[196:199]
    buffer_load_dwordx4 a[204:207], v1, s[12:15], s27 offen offset:1024
    v_mfma_f32_16x16x32_bf16 v[200:203], a[120:123], a[164:167], v[200:203]
    v_mfma_f32_16x16x32_bf16 v[204:207], a[124:127], a[164:167], v[204:207]
    buffer_load_dwordx4 a[208:211], v1, s[12:15], s27 offen offset:2048
    s_waitcnt lgkmcnt(0)
    s_barrier
    s_waitcnt vmcnt(9)
    v_mfma_f32_16x16x32_bf16 v[208:211], a[0:3], a[168:171], v[208:211]
    ds_read_b128 v[160:163], v16 offset:32768
    ds_read_b128 v[168:171], v16 offset:36864
    v_mfma_f32_16x16x32_bf16 v[212:215], a[4:7], a[168:171], v[212:215]
    buffer_load_dwordx4 a[212:215], v1, s[12:15], s27 offen offset:3072
    ds_read_b128 v[176:179], v16 offset:40960
    ds_read_b128 v[184:187], v16 offset:45056
    v_mfma_f32_16x16x32_bf16 v[216:219], a[8:11], a[168:171], v[216:219]
    ds_read_b128 v[164:167], v16 offset:33792
    ds_read_b128 v[172:175], v16 offset:37888
    v_mfma_f32_16x16x32_bf16 v[220:223], a[12:15], a[168:171], v[220:223]
    buffer_load_dwordx4 a[216:219], v2, s[12:15], s27 offen offset:0
    ds_read_b128 v[180:183], v16 offset:41984
    ds_read_b128 v[188:191], v16 offset:46080
    v_mfma_f32_16x16x32_bf16 v[208:211], a[16:19], a[172:175], v[208:211]
    v_mfma_f32_16x16x32_bf16 v[212:215], a[20:23], a[172:175], v[212:215]
    buffer_load_dwordx4 a[220:223], v2, s[12:15], s27 offen offset:1024
    v_mfma_f32_16x16x32_bf16 v[216:219], a[24:27], a[172:175], v[216:219]
    v_mfma_f32_16x16x32_bf16 v[220:223], a[28:31], a[172:175], v[220:223]
    buffer_load_dwordx4 a[224:227], v2, s[12:15], s27 offen offset:2048
    v_mfma_f32_16x16x32_bf16 v[208:211], a[32:35], a[176:179], v[208:211]
    ds_write_b128 v124, v[192:195] offset:0
    v_mfma_f32_16x16x32_bf16 v[212:215], a[36:39], a[176:179], v[212:215]
    buffer_load_dwordx4 a[228:231], v2, s[12:15], s27 offen offset:3072
    s_add_u32 s27, s27, 0x10000
    v_mfma_f32_16x16x32_bf16 v[216:219], a[40:43], a[176:179], v[216:219]
    s_waitcnt lgkmcnt(5)
    v_fmac_f32 v160, 0.5, v168
    v_mfma_f32_16x16x32_bf16 v[220:223], a[44:47], a[176:179], v[220:223]
    buffer_load_dwordx4 a[232:235], v1, s[12:15], s27 offen offset:0
    v_fma_f32 v184, v168, 0.5, -v184
    v_fmac_f32 v160, 0.5, v176
    v_mfma_f32_16x16x32_bf16 v[208:211], a[48:51], a[180:183], v[208:211]
    v_fmac_f32 v184, -0.5, v176
    v_fmac_f32 v161, 0.5, v169
    v_mfma_f32_16x16x32_bf16 v[212:215], a[52:55], a[180:183], v[212:215]
    buffer_load_dwordx4 a[236:239], v1, s[12:15], s27 offen offset:1024
    v_fma_f32 v185, v169, 0.5, -v185
    v_fmac_f32 v161, 0.5, v177
    v_mfma_f32_16x16x32_bf16 v[216:219], a[56:59], a[180:183], v[216:219]
    ds_write_b128 v124, v[196:199] offset:1024
    v_mfma_f32_16x16x32_bf16 v[220:223], a[60:63], a[180:183], v[220:223]
    buffer_load_dwordx4 a[240:243], v1, s[12:15], s27 offen offset:2048
    v_fmac_f32 v185, -0.5, v177
    v_fmac_f32 v162, 0.5, v170
    s_waitcnt vmcnt(12)
    v_mfma_f32_16x16x32_bf16 v[208:211], a[64:67], a[184:187], v[208:211]
    v_fma_f32 v186, v170, 0.5, -v186
    v_mfma_f32_16x16x32_bf16 v[212:215], a[68:71], a[184:187], v[212:215]
    buffer_load_dwordx4 a[244:247], v1, s[12:15], s27 offen offset:3072
    v_fmac_f32 v162, 0.5, v178
    v_fmac_f32 v186, -0.5, v178
    v_mfma_f32_16x16x32_bf16 v[216:219], a[72:75], a[184:187], v[216:219]
    v_fmac_f32 v163, 0.5, v171
    v_fma_f32 v187, v171, 0.5, -v187
    v_mfma_f32_16x16x32_bf16 v[220:223], a[76:79], a[184:187], v[220:223]
    buffer_load_dwordx4 a[248:251], v2, s[12:15], s27 offen offset:0
    v_fmac_f32 v163, 0.5, v179
    v_fmac_f32 v187, -0.5, v179
    v_mfma_f32_16x16x32_bf16 v[208:211], a[80:83], a[188:191], v[208:211]
    ds_write_b128 v125, v[200:203] offset:0
    v_mfma_f32_16x16x32_bf16 v[212:215], a[84:87], a[188:191], v[212:215]
    buffer_load_dwordx4 a[252:255], v2, s[12:15], s27 offen offset:1024
    s_waitcnt lgkmcnt(3)
    v_fmac_f32 v164, 0.5, v172
    v_mfma_f32_16x16x32_bf16 v[216:219], a[88:91], a[188:191], v[216:219]
    v_fma_f32 v188, v172, 0.5, -v188
    v_fmac_f32 v164, 0.5, v180
    v_mfma_f32_16x16x32_bf16 v[220:223], a[92:95], a[188:191], v[220:223]
    buffer_load_dwordx4 v[20:23], v2, s[12:15], s27 offen offset:2048
    v_fmac_f32 v188, -0.5, v180
    v_mfma_f32_16x16x32_bf16 v[208:211], a[96:99], a[192:195], v[208:211]
    v_fmac_f32 v165, 0.5, v173
    v_fma_f32 v189, v173, 0.5, -v189
    v_mfma_f32_16x16x32_bf16 v[212:215], a[100:103], a[192:195], v[212:215]
    buffer_load_dwordx4 v[24:27], v2, s[12:15], s27 offen offset:3072
    s_add_u32 s27, s27, 0x10000
    v_fmac_f32 v165, 0.5, v181
    v_fmac_f32 v189, -0.5, v181
    v_mfma_f32_16x16x32_bf16 v[216:219], a[104:107], a[192:195], v[216:219]
    ds_write_b128 v125, v[204:207] offset:1024
    v_mfma_f32_16x16x32_bf16 v[220:223], a[108:111], a[192:195], v[220:223]
    v_fmac_f32 v166, 0.5, v174
    v_fma_f32 v190, v174, 0.5, -v190
    v_mfma_f32_16x16x32_bf16 v[208:211], a[112:115], a[196:199], v[208:211]
    v_fmac_f32 v166, 0.5, v182
    v_fmac_f32 v190, -0.5, v182
    v_mfma_f32_16x16x32_bf16 v[212:215], a[116:119], a[196:199], v[212:215]
    v_fmac_f32 v167, 0.5, v175
    v_fma_f32 v191, v175, 0.5, -v191
    v_mfma_f32_16x16x32_bf16 v[216:219], a[120:123], a[196:199], v[216:219]
    v_fmac_f32 v167, 0.5, v183
    v_mfma_f32_16x16x32_bf16 v[220:223], a[124:127], a[196:199], v[220:223]
    v_fmac_f32 v191, -0.5, v183
    s_waitcnt vmcnt(12)
    v_mfma_f32_16x16x32_bf16 v[224:227], a[0:3], a[200:203], v[224:227]
    v_lshlrev_b32 v60, 16, v84
    v_and_b32 v61, 0xffff0000, v84
    v_mfma_f32_16x16x32_bf16 v[228:231], a[4:7], a[200:203], v[228:231]
    v_add_f32 v160, v160, v60
    v_add_f32 v161, v161, v61
    v_mfma_f32_16x16x32_bf16 v[232:235], a[8:11], a[200:203], v[232:235]
    v_cvt_pk_bf16_f32 v84, v160, v161
    v_lshlrev_b32 v62, 16, v85
    v_mfma_f32_16x16x32_bf16 v[236:239], a[12:15], a[200:203], v[236:239]
    v_and_b32 v63, 0xffff0000, v85
    v_add_f32 v162, v162, v62
    v_mfma_f32_16x16x32_bf16 v[224:227], a[16:19], a[204:207], v[224:227]
    v_add_f32 v163, v163, v63
    v_mfma_f32_16x16x32_bf16 v[228:231], a[20:23], a[204:207], v[228:231]
    v_cvt_pk_bf16_f32 v85, v162, v163
    v_lshlrev_b32 v64, 16, v86
    v_mfma_f32_16x16x32_bf16 v[232:235], a[24:27], a[204:207], v[232:235]
    v_and_b32 v65, 0xffff0000, v86
    v_add_f32 v164, v164, v64
    v_mfma_f32_16x16x32_bf16 v[236:239], a[28:31], a[204:207], v[236:239]
    v_add_f32 v165, v165, v65
    v_cvt_pk_bf16_f32 v86, v164, v165
    v_mfma_f32_16x16x32_bf16 v[224:227], a[32:35], a[208:211], v[224:227]
    ds_write_b128 v124, v[208:211] offset:16384
    v_mfma_f32_16x16x32_bf16 v[228:231], a[36:39], a[208:211], v[228:231]
    v_lshlrev_b32 v66, 16, v87
    v_and_b32 v67, 0xffff0000, v87
    v_mfma_f32_16x16x32_bf16 v[232:235], a[40:43], a[208:211], v[232:235]
    v_add_f32 v166, v166, v66
    v_add_f32 v167, v167, v67
    v_mfma_f32_16x16x32_bf16 v[236:239], a[44:47], a[208:211], v[236:239]
    v_cvt_pk_bf16_f32 v87, v166, v167
    v_mfma_f32_16x16x32_bf16 v[224:227], a[48:51], a[212:215], v[224:227]
    buffer_store_dwordx4 v[84:87], v18, s[20:23], s48 offen offset:0 sc1
    v_lshlrev_b32 v68, 16, v88
    v_mfma_f32_16x16x32_bf16 v[228:231], a[52:55], a[212:215], v[228:231]
    v_and_b32 v69, 0xffff0000, v88
    v_add_f32 v184, v184, v68
    v_mfma_f32_16x16x32_bf16 v[232:235], a[56:59], a[212:215], v[232:235]
    ds_write_b128 v124, v[212:215] offset:17408
    v_mfma_f32_16x16x32_bf16 v[236:239], a[60:63], a[212:215], v[236:239]
    v_add_f32 v185, v185, v69
    v_cvt_pk_bf16_f32 v88, v184, v185
    s_waitcnt vmcnt(9)
    v_mfma_f32_16x16x32_bf16 v[224:227], a[64:67], a[216:219], v[224:227]
    v_lshlrev_b32 v70, 16, v89
    v_and_b32 v71, 0xffff0000, v89
    v_mfma_f32_16x16x32_bf16 v[228:231], a[68:71], a[216:219], v[228:231]
    v_add_f32 v186, v186, v70
    v_add_f32 v187, v187, v71
    v_mfma_f32_16x16x32_bf16 v[232:235], a[72:75], a[216:219], v[232:235]
    v_cvt_pk_bf16_f32 v89, v186, v187
    v_mfma_f32_16x16x32_bf16 v[236:239], a[76:79], a[216:219], v[236:239]
    v_lshlrev_b32 v72, 16, v90
    v_and_b32 v73, 0xffff0000, v90
    v_mfma_f32_16x16x32_bf16 v[224:227], a[80:83], a[220:223], v[224:227]
    ds_write_b128 v125, v[216:219] offset:16384
    v_mfma_f32_16x16x32_bf16 v[228:231], a[84:87], a[220:223], v[228:231]
    v_add_f32 v188, v188, v72
    v_add_f32 v189, v189, v73
    v_mfma_f32_16x16x32_bf16 v[232:235], a[88:91], a[220:223], v[232:235]
    v_cvt_pk_bf16_f32 v90, v188, v189
    v_lshlrev_b32 v74, 16, v91
    v_mfma_f32_16x16x32_bf16 v[236:239], a[92:95], a[220:223], v[236:239]
    v_and_b32 v75, 0xffff0000, v91
    v_add_f32 v190, v190, v74
    v_mfma_f32_16x16x32_bf16 v[224:227], a[96:99], a[224:227], v[224:227]
    v_add_f32 v191, v191, v75
    v_cvt_pk_bf16_f32 v91, v190, v191
    v_mfma_f32_16x16x32_bf16 v[228:231], a[100:103], a[224:227], v[228:231]
    buffer_store_dwordx4 v[88:91], v18, s[20:23], s48 offen offset:1024 sc1
    v_mfma_f32_16x16x32_bf16 v[232:235], a[104:107], a[224:227], v[232:235]
    ds_write_b128 v125, v[220:223] offset:17408
    v_mfma_f32_16x16x32_bf16 v[236:239], a[108:111], a[224:227], v[236:239]
    v_mfma_f32_16x16x32_bf16 v[224:227], a[112:115], a[228:231], v[224:227]
    v_mfma_f32_16x16x32_bf16 v[228:231], a[116:119], a[228:231], v[228:231]
    v_mfma_f32_16x16x32_bf16 v[232:235], a[120:123], a[228:231], v[232:235]
    v_mfma_f32_16x16x32_bf16 v[236:239], a[124:127], a[228:231], v[236:239]
    s_waitcnt lgkmcnt(0)
    s_barrier
    s_waitcnt vmcnt(6)
    v_mfma_f32_16x16x32_bf16 v[240:243], a[0:3], a[232:235], v[240:243]
    ds_read_b128 v[192:195], v17 offset:0
    ds_read_b128 v[200:203], v17 offset:4096
    v_mfma_f32_16x16x32_bf16 v[244:247], a[4:7], a[232:235], v[244:247]
    ds_read_b128 v[208:211], v17 offset:8192
    ds_read_b128 v[216:219], v17 offset:12288
    v_mfma_f32_16x16x32_bf16 v[248:251], a[8:11], a[232:235], v[248:251]
    ds_read_b128 v[196:199], v17 offset:1024
    ds_read_b128 v[204:207], v17 offset:5120
    v_mfma_f32_16x16x32_bf16 v[252:255], a[12:15], a[232:235], v[252:255]
    ds_read_b128 v[212:215], v17 offset:9216
    ds_read_b128 v[220:223], v17 offset:13312
    v_mfma_f32_16x16x32_bf16 v[240:243], a[16:19], a[236:239], v[240:243]
    v_mfma_f32_16x16x32_bf16 v[244:247], a[20:23], a[236:239], v[244:247]
    v_mfma_f32_16x16x32_bf16 v[248:251], a[24:27], a[236:239], v[248:251]
    v_mfma_f32_16x16x32_bf16 v[252:255], a[28:31], a[236:239], v[252:255]
    v_mfma_f32_16x16x32_bf16 v[240:243], a[32:35], a[240:243], v[240:243]
    ds_write_b128 v124, v[224:227] offset:32768
    v_mfma_f32_16x16x32_bf16 v[244:247], a[36:39], a[240:243], v[244:247]
    v_mfma_f32_16x16x32_bf16 v[248:251], a[40:43], a[240:243], v[248:251]
    s_waitcnt lgkmcnt(5)
    v_fmac_f32 v192, 0.5, v200
    v_fma_f32 v216, v200, 0.5, -v216
    v_fmac_f32 v192, 0.5, v208
    v_mfma_f32_16x16x32_bf16 v[252:255], a[44:47], a[240:243], v[252:255]
    v_fmac_f32 v216, -0.5, v208
    v_fmac_f32 v193, 0.5, v201
    v_fma_f32 v217, v201, 0.5, -v217
    v_mfma_f32_16x16x32_bf16 v[240:243], a[48:51], a[244:247], v[240:243]
    v_fmac_f32 v193, 0.5, v209
    v_fmac_f32 v217, -0.5, v209
    v_fmac_f32 v194, 0.5, v202
    v_fma_f32 v218, v202, 0.5, -v218
    v_mfma_f32_16x16x32_bf16 v[244:247], a[52:55], a[244:247], v[244:247]
    v_fmac_f32 v194, 0.5, v210
    v_fmac_f32 v218, -0.5, v210
    v_fmac_f32 v195, 0.5, v203
    v_mfma_f32_16x16x32_bf16 v[248:251], a[56:59], a[244:247], v[248:251]
    ds_write_b128 v124, v[228:231] offset:33792
    v_mfma_f32_16x16x32_bf16 v[252:255], a[60:63], a[244:247], v[252:255]
    v_fma_f32 v219, v203, 0.5, -v219
    v_fmac_f32 v195, 0.5, v211
    v_fmac_f32 v219, -0.5, v211
    s_waitcnt vmcnt(2)
    v_mfma_f32_16x16x32_bf16 v[240:243], a[64:67], a[248:251], v[240:243]
    s_waitcnt lgkmcnt(2)
    v_fmac_f32 v196, 0.5, v204
    v_fma_f32 v220, v204, 0.5, -v220
    v_fmac_f32 v196, 0.5, v212
    v_mfma_f32_16x16x32_bf16 v[244:247], a[68:71], a[248:251], v[244:247]
    v_fmac_f32 v220, -0.5, v212
    v_fmac_f32 v197, 0.5, v205
    v_fma_f32 v221, v205, 0.5, -v221
    v_mfma_f32_16x16x32_bf16 v[248:251], a[72:75], a[248:251], v[248:251]
    v_fmac_f32 v197, 0.5, v213
    v_fmac_f32 v221, -0.5, v213
    v_fmac_f32 v198, 0.5, v206
    v_mfma_f32_16x16x32_bf16 v[252:255], a[76:79], a[248:251], v[252:255]
    v_fma_f32 v222, v206, 0.5, -v222
    v_fmac_f32 v198, 0.5, v214
    v_fmac_f32 v222, -0.5, v214
    v_fmac_f32 v199, 0.5, v207
    v_mfma_f32_16x16x32_bf16 v[240:243], a[80:83], a[252:255], v[240:243]
    ds_write_b128 v125, v[232:235] offset:32768
    v_mfma_f32_16x16x32_bf16 v[244:247], a[84:87], a[252:255], v[244:247]
    v_fma_f32 v223, v207, 0.5, -v223
    v_fmac_f32 v199, 0.5, v215
    v_fmac_f32 v223, -0.5, v215
    v_mfma_f32_16x16x32_bf16 v[248:251], a[88:91], a[252:255], v[248:251]
    v_lshlrev_b32 v60, 16, v92
    v_and_b32 v61, 0xffff0000, v92
    v_add_f32 v192, v192, v60
    v_mfma_f32_16x16x32_bf16 v[252:255], a[92:95], a[252:255], v[252:255]
    v_add_f32 v193, v193, v61
    v_cvt_pk_bf16_f32 v92, v192, v193
    v_lshlrev_b32 v62, 16, v93
    v_mfma_f32_16x16x32_bf16 v[240:243], a[96:99], v[20:23], v[240:243]
    v_and_b32 v63, 0xffff0000, v93
    v_add_f32 v194, v194, v62
    v_add_f32 v195, v195, v63
    v_mfma_f32_16x16x32_bf16 v[244:247], a[100:103], v[20:23], v[244:247]
    v_cvt_pk_bf16_f32 v93, v194, v195
    v_lshlrev_b32 v64, 16, v94
    v_and_b32 v65, 0xffff0000, v94
    v_add_f32 v196, v196, v64
    v_mfma_f32_16x16x32_bf16 v[248:251], a[104:107], v[20:23], v[248:251]
    ds_write_b128 v125, v[236:239] offset:33792
    v_mfma_f32_16x16x32_bf16 v[252:255], a[108:111], v[20:23], v[252:255]
    v_add_f32 v197, v197, v65
    v_cvt_pk_bf16_f32 v94, v196, v197
    v_lshlrev_b32 v66, 16, v95
    v_mfma_f32_16x16x32_bf16 v[240:243], a[112:115], v[24:27], v[240:243]
    v_and_b32 v67, 0xffff0000, v95
    v_add_f32 v198, v198, v66
    v_add_f32 v199, v199, v67
    v_mfma_f32_16x16x32_bf16 v[244:247], a[116:119], v[24:27], v[244:247]
    v_cvt_pk_bf16_f32 v95, v198, v199
    buffer_store_dwordx4 v[92:95], v18, s[20:23], s49 offen offset:0 sc1
    v_lshlrev_b32 v68, 16, v96
    v_and_b32 v69, 0xffff0000, v96
    v_mfma_f32_16x16x32_bf16 v[248:251], a[120:123], v[24:27], v[248:251]
    v_add_f32 v216, v216, v68
    v_add_f32 v217, v217, v69
    v_cvt_pk_bf16_f32 v96, v216, v217
    v_mfma_f32_16x16x32_bf16 v[252:255], a[124:127], v[24:27], v[252:255]
    v_lshlrev_b32 v70, 16, v97
    v_and_b32 v71, 0xffff0000, v97
    v_add_f32 v218, v218, v70
    v_add_f32 v219, v219, v71
    v_cvt_pk_bf16_f32 v97, v218, v219
    v_lshlrev_b32 v72, 16, v98
    v_and_b32 v73, 0xffff0000, v98
    v_add_f32 v220, v220, v72
    v_add_f32 v221, v221, v73
    v_cvt_pk_bf16_f32 v98, v220, v221
    v_lshlrev_b32 v74, 16, v99
    v_and_b32 v75, 0xffff0000, v99
    v_add_f32 v222, v222, v74
    ds_write_b128 v124, v[240:243] offset:49152
    ds_write_b128 v124, v[244:247] offset:50176
    ds_write_b128 v125, v[248:251] offset:49152
    ds_write_b128 v125, v[252:255] offset:50176
    v_add_f32 v223, v223, v75
    v_cvt_pk_bf16_f32 v99, v222, v223
    buffer_store_dwordx4 v[96:99], v18, s[20:23], s49 offen offset:1024 sc1
    s_waitcnt lgkmcnt(0)
    s_barrier
    ds_read_b128 v[224:227], v17 offset:32768
    ds_read_b128 v[232:235], v17 offset:36864
    ds_read_b128 v[240:243], v17 offset:40960
    ds_read_b128 v[248:251], v17 offset:45056
    ds_read_b128 v[228:231], v17 offset:33792
    ds_read_b128 v[236:239], v17 offset:37888
    ds_read_b128 v[244:247], v17 offset:41984
    ds_read_b128 v[252:255], v17 offset:46080
    s_waitcnt lgkmcnt(4)
    v_pk_fma_f32 v[224:225], v[232:233], 0.5, v[224:225] op_sel_hi:[1,0,1]
    v_pk_fma_f32 v[248:249], v[232:233], 0.5, v[248:249] op_sel_hi:[1,0,1] neg_lo:[0,0,1] neg_hi:[0,0,1]
    v_pk_fma_f32 v[224:225], v[240:241], 0.5, v[224:225] op_sel_hi:[1,0,1]
    v_pk_fma_f32 v[248:249], v[240:241], -0.5, v[248:249] op_sel_hi:[1,0,1]
    v_pk_fma_f32 v[226:227], v[234:235], 0.5, v[226:227] op_sel_hi:[1,0,1]
    v_pk_fma_f32 v[250:251], v[234:235], 0.5, v[250:251] op_sel_hi:[1,0,1] neg_lo:[0,0,1] neg_hi:[0,0,1]
    v_pk_fma_f32 v[226:227], v[242:243], 0.5, v[226:227] op_sel_hi:[1,0,1]
    v_pk_fma_f32 v[250:251], v[242:243], -0.5, v[250:251] op_sel_hi:[1,0,1]
    s_waitcnt lgkmcnt(0)
    v_pk_fma_f32 v[228:229], v[236:237], 0.5, v[228:229] op_sel_hi:[1,0,1]
    v_pk_fma_f32 v[252:253], v[236:237], 0.5, v[252:253] op_sel_hi:[1,0,1] neg_lo:[0,0,1] neg_hi:[0,0,1]
    v_pk_fma_f32 v[228:229], v[244:245], 0.5, v[228:229] op_sel_hi:[1,0,1]
    v_pk_fma_f32 v[252:253], v[244:245], -0.5, v[252:253] op_sel_hi:[1,0,1]
    v_pk_fma_f32 v[230:231], v[238:239], 0.5, v[230:231] op_sel_hi:[1,0,1]
    v_pk_fma_f32 v[254:255], v[238:239], 0.5, v[254:255] op_sel_hi:[1,0,1] neg_lo:[0,0,1] neg_hi:[0,0,1]
    v_pk_fma_f32 v[230:231], v[246:247], 0.5, v[230:231] op_sel_hi:[1,0,1]
    v_pk_fma_f32 v[254:255], v[246:247], -0.5, v[254:255] op_sel_hi:[1,0,1]
    v_lshlrev_b32 v60, 16, v100
    v_and_b32 v61, 0xffff0000, v100
    v_pk_add_f32 v[224:225], v[224:225], v[60:61]
    v_cvt_pk_bf16_f32 v100, v224, v225
    v_lshlrev_b32 v62, 16, v101
    v_and_b32 v63, 0xffff0000, v101
    v_pk_add_f32 v[226:227], v[226:227], v[62:63]
    v_cvt_pk_bf16_f32 v101, v226, v227
    v_lshlrev_b32 v64, 16, v102
    v_and_b32 v65, 0xffff0000, v102
    v_pk_add_f32 v[228:229], v[228:229], v[64:65]
    v_cvt_pk_bf16_f32 v102, v228, v229
    v_lshlrev_b32 v66, 16, v103
    v_and_b32 v67, 0xffff0000, v103
    v_pk_add_f32 v[230:231], v[230:231], v[66:67]
    v_cvt_pk_bf16_f32 v103, v230, v231
    buffer_store_dwordx4 v[100:103], v18, s[20:23], s50 offen offset:0 sc1
    v_lshlrev_b32 v68, 16, v104
    v_and_b32 v69, 0xffff0000, v104
    v_pk_add_f32 v[248:249], v[248:249], v[68:69]
    v_cvt_pk_bf16_f32 v104, v248, v249
    v_lshlrev_b32 v70, 16, v105
    v_and_b32 v71, 0xffff0000, v105
    v_pk_add_f32 v[250:251], v[250:251], v[70:71]
    v_cvt_pk_bf16_f32 v105, v250, v251
    v_lshlrev_b32 v72, 16, v106
    v_and_b32 v73, 0xffff0000, v106
    v_pk_add_f32 v[252:253], v[252:253], v[72:73]
    v_cvt_pk_bf16_f32 v106, v252, v253
    v_lshlrev_b32 v74, 16, v107
    v_and_b32 v75, 0xffff0000, v107
    v_pk_add_f32 v[254:255], v[254:255], v[74:75]
    v_cvt_pk_bf16_f32 v107, v254, v255
    buffer_store_dwordx4 v[104:107], v18, s[20:23], s50 offen offset:1024 sc1
    s_endpgm
L2_slow:
    s_sub_i32 s60, s32, s58
    s_sub_i32 s61, 15, s60
    s_lshl_b32 s61, s61, 10
    s_sub_i32 s62, 24, s60
    s_lshl_b32 s62, 1, s62
    s_cmp_lt_i32 s60, 15
    s_cselect_b32 s61, s61, s62
    s_cmp_gt_i32 s60, 24
    s_cselect_b32 s61, 0, s61
    s_mov_b32 s63, s61
    s_sub_i32 s60, s33, s58
    s_sub_i32 s61, 15, s60
    s_lshl_b32 s61, s61, 10
    s_sub_i32 s62, 24, s60
    s_lshl_b32 s62, 1, s62
    s_cmp_lt_i32 s60, 15
    s_cselect_b32 s61, s61, s62
    s_cmp_gt_i32 s60, 24
    s_cselect_b32 s61, 0, s61
    s_pack_ll_b32_b16 s32, s63, s61
    s_sub_i32 s60, s34, s58
    s_sub_i32 s61, 15, s60
    s_lshl_b32 s61, s61, 10
    s_sub_i32 s62, 24, s60
    s_lshl_b32 s62, 1, s62
    s_cmp_lt_i32 s60, 15
    s_cselect_b32 s61, s61, s62
    s_cmp_gt_i32 s60, 24
    s_cselect_b32 s61, 0, s61
    s_mov_b32 s63, s61
    s_sub_i32 s60, s35, s58
    s_sub_i32 s61, 15, s60
    s_lshl_b32 s61, s61, 10
    s_sub_i32 s62, 24, s60
    s_lshl_b32 s62, 1, s62
    s_cmp_lt_i32 s60, 15
    s_cselect_b32 s61, s61, s62
    s_cmp_gt_i32 s60, 24
    s_cselect_b32 s61, 0, s61
    s_pack_ll_b32_b16 s33, s63, s61
    s_sub_i32 s60, s36, s58
    s_sub_i32 s61, 15, s60
    s_lshl_b32 s61, s61, 10
    s_sub_i32 s62, 24, s60
    s_lshl_b32 s62, 1, s62
    s_cmp_lt_i32 s60, 15
    s_cselect_b32 s61, s61, s62
    s_cmp_gt_i32 s60, 24
    s_cselect_b32 s61, 0, s61
    s_mov_b32 s63, s61
    s_sub_i32 s60, s37, s58
    s_sub_i32 s61, 15, s60
    s_lshl_b32 s61, s61, 10
    s_sub_i32 s62, 24, s60
    s_lshl_b32 s62, 1, s62
    s_cmp_lt_i32 s60, 15
    s_cselect_b32 s61, s61, s62
    s_cmp_gt_i32 s60, 24
    s_cselect_b32 s61, 0, s61
    s_pack_ll_b32_b16 s34, s63, s61
    s_sub_i32 s60, s38, s58
    s_sub_i32 s61, 15, s60
    s_lshl_b32 s61, s61, 10
    s_sub_i32 s62, 24, s60
    s_lshl_b32 s62, 1, s62
    s_cmp_lt_i32 s60, 15
    s_cselect_b32 s61, s61, s62
    s_cmp_gt_i32 s60, 24
    s_cselect_b32 s61, 0, s61
    s_mov_b32 s63, s61
    s_sub_i32 s60, s39, s58
    s_sub_i32 s61, 15, s60
    s_lshl_b32 s61, s61, 10
    s_sub_i32 s62, 24, s60
    s_lshl_b32 s62, 1, s62
    s_cmp_lt_i32 s60, 15
    s_cselect_b32 s61, s61, s62
    s_cmp_gt_i32 s60, 24
    s_cselect_b32 s61, 0, s61
    s_pack_ll_b32_b16 s35, s63, s61
    s_sub_i32 s60, s40, s58
    s_sub_i32 s61, 15, s60
    s_lshl_b32 s61, s61, 10
    s_sub_i32 s62, 24, s60
    s_lshl_b32 s62, 1, s62
    s_cmp_lt_i32 s60, 15
    s_cselect_b32 s61, s61, s62
    s_cmp_gt_i32 s60, 24
    s_cselect_b32 s61, 0, s61
    s_mov_b32 s63, s61
    s_sub_i32 s60, s41, s58
    s_sub_i32 s61, 15, s60
    s_lshl_b32 s61, s61, 10
    s_sub_i32 s62, 24, s60
    s_lshl_b32 s62, 1, s62
    s_cmp_lt_i32 s60, 15
    s_cselect_b32 s61, s61, s62
    s_cmp_gt_i32 s60, 24
    s_cselect_b32 s61, 0, s61
    s_pack_ll_b32_b16 s36, s63, s61
    s_sub_i32 s60, s42, s58
    s_sub_i32 s61, 15, s60
    s_lshl_b32 s61, s61, 10
    s_sub_i32 s62, 24, s60
    s_lshl_b32 s62, 1, s62
    s_cmp_lt_i32 s60, 15
    s_cselect_b32 s61, s61, s62
    s_cmp_gt_i32 s60, 24
    s_cselect_b32 s61, 0, s61
    s_mov_b32 s63, s61
    s_sub_i32 s60, s43, s58
    s_sub_i32 s61, 15, s60
    s_lshl_b32 s61, s61, 10
    s_sub_i32 s62, 24, s60
    s_lshl_b32 s62, 1, s62
    s_cmp_lt_i32 s60, 15
    s_cselect_b32 s61, s61, s62
    s_cmp_gt_i32 s60, 24
    s_cselect_b32 s61, 0, s61
    s_pack_ll_b32_b16 s37, s63, s61
    s_sub_i32 s60, s44, s58
    s_sub_i32 s61, 15, s60
    s_lshl_b32 s61, s61, 10
    s_sub_i32 s62, 24, s60
    s_lshl_b32 s62, 1, s62
    s_cmp_lt_i32 s60, 15
    s_cselect_b32 s61, s61, s62
    s_cmp_gt_i32 s60, 24
    s_cselect_b32 s61, 0, s61
    s_mov_b32 s63, s61
    s_sub_i32 s60, s45, s58
    s_sub_i32 s61, 15, s60
    s_lshl_b32 s61, s61, 10
    s_sub_i32 s62, 24, s60
    s_lshl_b32 s62, 1, s62
    s_cmp_lt_i32 s60, 15
    s_cselect_b32 s61, s61, s62
    s_cmp_gt_i32 s60, 24
    s_cselect_b32 s61, 0, s61
    s_pack_ll_b32_b16 s38, s63, s61
    s_sub_i32 s60, s46, s58
    s_sub_i32 s61, 15, s60
    s_lshl_b32 s61, s61, 10
    s_sub_i32 s62, 24, s60
    s_lshl_b32 s62, 1, s62
    s_cmp_lt_i32 s60, 15
    s_cselect_b32 s61, s61, s62
    s_cmp_gt_i32 s60, 24
    s_cselect_b32 s61, 0, s61
    s_mov_b32 s63, s61
    s_sub_i32 s60, s47, s58
    s_sub_i32 s61, 15, s60
    s_lshl_b32 s61, s61, 10
    s_sub_i32 s62, 24, s60
    s_lshl_b32 s62, 1, s62
    s_cmp_lt_i32 s60, 15
    s_cselect_b32 s61, s61, s62
    s_cmp_gt_i32 s60, 24
    s_cselect_b32 s61, 0, s61
    s_pack_ll_b32_b16 s39, s63, s61
    s_sub_i32 s60, s80, s58
    s_sub_i32 s61, 15, s60
    s_lshl_b32 s61, s61, 10
    s_sub_i32 s62, 24, s60
    s_lshl_b32 s62, 1, s62
    s_cmp_lt_i32 s60, 15
    s_cselect_b32 s61, s61, s62
    s_cmp_gt_i32 s60, 24
    s_cselect_b32 s61, 0, s61
    s_mov_b32 s63, s61
    s_sub_i32 s60, s81, s58
    s_sub_i32 s61, 15, s60
    s_lshl_b32 s61, s61, 10
    s_sub_i32 s62, 24, s60
    s_lshl_b32 s62, 1, s62
    s_cmp_lt_i32 s60, 15
    s_cselect_b32 s61, s61, s62
    s_cmp_gt_i32 s60, 24
    s_cselect_b32 s61, 0, s61
    s_pack_ll_b32_b16 s40, s63, s61
    s_sub_i32 s60, s82, s58
    s_sub_i32 s61, 15, s60
    s_lshl_b32 s61, s61, 10
    s_sub_i32 s62, 24, s60
    s_lshl_b32 s62, 1, s62
    s_cmp_lt_i32 s60, 15
    s_cselect_b32 s61, s61, s62
    s_cmp_gt_i32 s60, 24
    s_cselect_b32 s61, 0, s61
    s_mov_b32 s63, s61
    s_sub_i32 s60, s83, s58
    s_sub_i32 s61, 15, s60
    s_lshl_b32 s61, s61, 10
    s_sub_i32 s62, 24, s60
    s_lshl_b32 s62, 1, s62
    s_cmp_lt_i32 s60, 15
    s_cselect_b32 s61, s61, s62
    s_cmp_gt_i32 s60, 24
    s_cselect_b32 s61, 0, s61
    s_pack_ll_b32_b16 s41, s63, s61
    s_sub_i32 s60, s84, s58
    s_sub_i32 s61, 15, s60
    s_lshl_b32 s61, s61, 10
    s_sub_i32 s62, 24, s60
    s_lshl_b32 s62, 1, s62
    s_cmp_lt_i32 s60, 15
    s_cselect_b32 s61, s61, s62
    s_cmp_gt_i32 s60, 24
    s_cselect_b32 s61, 0, s61
    s_mov_b32 s63, s61
    s_sub_i32 s60, s85, s58
    s_sub_i32 s61, 15, s60
    s_lshl_b32 s61, s61, 10
    s_sub_i32 s62, 24, s60
    s_lshl_b32 s62, 1, s62
    s_cmp_lt_i32 s60, 15
    s_cselect_b32 s61, s61, s62
    s_cmp_gt_i32 s60, 24
    s_cselect_b32 s61, 0, s61
    s_pack_ll_b32_b16 s42, s63, s61
    s_sub_i32 s60, s86, s58
    s_sub_i32 s61, 15, s60
    s_lshl_b32 s61, s61, 10
    s_sub_i32 s62, 24, s60
    s_lshl_b32 s62, 1, s62
    s_cmp_lt_i32 s60, 15
    s_cselect_b32 s61, s61, s62
    s_cmp_gt_i32 s60, 24
    s_cselect_b32 s61, 0, s61
    s_mov_b32 s63, s61
    s_sub_i32 s60, s87, s58
    s_sub_i32 s61, 15, s60
    s_lshl_b32 s61, s61, 10
    s_sub_i32 s62, 24, s60
    s_lshl_b32 s62, 1, s62
    s_cmp_lt_i32 s60, 15
    s_cselect_b32 s61, s61, s62
    s_cmp_gt_i32 s60, 24
    s_cselect_b32 s61, 0, s61
    s_pack_ll_b32_b16 s43, s63, s61
    s_sub_i32 s60, s88, s58
    s_sub_i32 s61, 15, s60
    s_lshl_b32 s61, s61, 10
    s_sub_i32 s62, 24, s60
    s_lshl_b32 s62, 1, s62
    s_cmp_lt_i32 s60, 15
    s_cselect_b32 s61, s61, s62
    s_cmp_gt_i32 s60, 24
    s_cselect_b32 s61, 0, s61
    s_mov_b32 s63, s61
    s_sub_i32 s60, s89, s58
    s_sub_i32 s61, 15, s60
    s_lshl_b32 s61, s61, 10
    s_sub_i32 s62, 24, s60
    s_lshl_b32 s62, 1, s62
    s_cmp_lt_i32 s60, 15
    s_cselect_b32 s61, s61, s62
    s_cmp_gt_i32 s60, 24
    s_cselect_b32 s61, 0, s61
    s_pack_ll_b32_b16 s44, s63, s61
    s_sub_i32 s60, s90, s58
    s_sub_i32 s61, 15, s60
    s_lshl_b32 s61, s61, 10
    s_sub_i32 s62, 24, s60
    s_lshl_b32 s62, 1, s62
    s_cmp_lt_i32 s60, 15
    s_cselect_b32 s61, s61, s62
    s_cmp_gt_i32 s60, 24
    s_cselect_b32 s61, 0, s61
    s_mov_b32 s63, s61
    s_sub_i32 s60, s91, s58
    s_sub_i32 s61, 15, s60
    s_lshl_b32 s61, s61, 10
    s_sub_i32 s62, 24, s60
    s_lshl_b32 s62, 1, s62
    s_cmp_lt_i32 s60, 15
    s_cselect_b32 s61, s61, s62
    s_cmp_gt_i32 s60, 24
    s_cselect_b32 s61, 0, s61
    s_pack_ll_b32_b16 s45, s63, s61
    s_sub_i32 s60, s92, s58
    s_sub_i32 s61, 15, s60
    s_lshl_b32 s61, s61, 10
    s_sub_i32 s62, 24, s60
    s_lshl_b32 s62, 1, s62
    s_cmp_lt_i32 s60, 15
    s_cselect_b32 s61, s61, s62
    s_cmp_gt_i32 s60, 24
    s_cselect_b32 s61, 0, s61
    s_mov_b32 s63, s61
    s_sub_i32 s60, s93, s58
    s_sub_i32 s61, 15, s60
    s_lshl_b32 s61, s61, 10
    s_sub_i32 s62, 24, s60
    s_lshl_b32 s62, 1, s62
    s_cmp_lt_i32 s60, 15
    s_cselect_b32 s61, s61, s62
    s_cmp_gt_i32 s60, 24
    s_cselect_b32 s61, 0, s61
    s_pack_ll_b32_b16 s46, s63, s61
    s_sub_i32 s60, s94, s58
    s_sub_i32 s61, 15, s60
    s_lshl_b32 s61, s61, 10
    s_sub_i32 s62, 24, s60
    s_lshl_b32 s62, 1, s62
    s_cmp_lt_i32 s60, 15
    s_cselect_b32 s61, s61, s62
    s_cmp_gt_i32 s60, 24
    s_cselect_b32 s61, 0, s61
    s_mov_b32 s63, s61
    s_sub_i32 s60, s95, s58
    s_sub_i32 s61, 15, s60
    s_lshl_b32 s61, s61, 10
    s_sub_i32 s62, 24, s60
    s_lshl_b32 s62, 1, s62
    s_cmp_lt_i32 s60, 15
    s_cselect_b32 s61, s61, s62
    s_cmp_gt_i32 s60, 24
    s_cselect_b32 s61, 0, s61
    s_pack_ll_b32_b16 s47, s63, s61
    s_and_b32 s60, s65, 1
    s_cselect_b32 s80, s33, s32
    s_cselect_b32 s81, s34, s33
    s_cselect_b32 s82, s35, s34
    s_cselect_b32 s83, s32, s35
    s_mov_b32 s32, s80
    s_mov_b32 s33, s81
    s_mov_b32 s34, s82
    s_mov_b32 s35, s83
    s_cselect_b32 s80, s37, s36
    s_cselect_b32 s81, s38, s37
    s_cselect_b32 s82, s39, s38
    s_cselect_b32 s83, s36, s39
    s_mov_b32 s36, s80
    s_mov_b32 s37, s81
    s_mov_b32 s38, s82
    s_mov_b32 s39, s83
    s_cselect_b32 s80, s41, s40
    s_cselect_b32 s81, s42, s41
    s_cselect_b32 s82, s43, s42
    s_cselect_b32 s83, s40, s43
    s_mov_b32 s40, s80
    s_mov_b32 s41, s81
    s_mov_b32 s42, s82
    s_mov_b32 s43, s83
    s_cselect_b32 s80, s45, s44
    s_cselect_b32 s81, s46, s45
    s_cselect_b32 s82, s47, s46
    s_cselect_b32 s83, s44, s47
    s_mov_b32 s44, s80
    s_mov_b32 s45, s81
    s_mov_b32 s46, s82
    s_mov_b32 s47, s83
    s_and_b32 s60, s65, 2
    s_cselect_b32 s80, s34, s32
    s_cselect_b32 s81, s35, s33
    s_cselect_b32 s82, s32, s34
    s_cselect_b32 s83, s33, s35
    s_mov_b32 s32, s80
    s_mov_b32 s33, s81
    s_mov_b32 s34, s82
    s_mov_b32 s35, s83
    s_cselect_b32 s80, s38, s36
    s_cselect_b32 s81, s39, s37
    s_cselect_b32 s82, s36, s38
    s_cselect_b32 s83, s37, s39
    s_mov_b32 s36, s80
    s_mov_b32 s37, s81
    s_mov_b32 s38, s82
    s_mov_b32 s39, s83
    s_cselect_b32 s80, s42, s40
    s_cselect_b32 s81, s43, s41
    s_cselect_b32 s82, s40, s42
    s_cselect_b32 s83, s41, s43
    s_mov_b32 s40, s80
    s_mov_b32 s41, s81
    s_mov_b32 s42, s82
    s_mov_b32 s43, s83
    s_cselect_b32 s80, s46, s44
    s_cselect_b32 s81, s47, s45
    s_cselect_b32 s82, s44, s46
    s_cselect_b32 s83, s45, s47
    s_mov_b32 s44, s80
    s_mov_b32 s45, s81
    s_mov_b32 s46, s82
    s_mov_b32 s47, s83
    v_and_b32 v21, 32, v20
    v_lshrrev_b32 v21, 1, v21
    v_mov_b32 v19, v21
    s_mov_b32 s31, 0x01000100
    s_waitcnt vmcnt(26)
    s_barrier
    ds_read_b128 v[20:23], v4 offset:0
    ds_read_b128 v[24:27], v5 offset:0
    ds_read_b128 v[28:31], v4 offset:1088
    ds_read_b128 v[32:35], v5 offset:1088
    ds_read_b128 v[36:39], v4 offset:2176
    ds_read_b128 v[40:43], v5 offset:2176
    v_lshrrev_b32 v126, v19, s32
    v_perm_b32 v126, v126, v126, s31
    s_waitcnt lgkmcnt(4)
    v_pk_fma_f16 v60, v24, s28, v20
    v_pk_mul_f16 v60, v60, v126
    v_pk_fma_f16 v61, v25, s28, v21
    v_pk_mul_f16 v61, v61, v126
    v_pk_fma_f16 v62, v26, s28, v22
    v_pk_mul_f16 v62, v62, v126
    v_pk_fma_f16 v63, v27, s28, v23
    v_pk_mul_f16 v63, v63, v126
    s_waitcnt lgkmcnt(2)
    v_pk_fma_f16 v64, v32, s28, v28
    ds_read_b128 v[44:47], v4 offset:3264
    v_pk_mul_f16 v64, v64, v126
    v_pk_fma_f16 v65, v33, s28, v29
    ds_read_b128 v[48:51], v5 offset:3264
    v_pk_mul_f16 v65, v65, v126
    v_pk_fma_f16 v66, v34, s28, v30
    v_pk_mul_f16 v66, v66, v126
    v_pk_fma_f16 v67, v35, s28, v31
    s_waitcnt vmcnt(22)
    s_nop 1
    s_mov_b32 s26, 3
.p2align 3
L2_loops:
    v_mfma_f32_16x16x32_f16 v[128:131], a[0:3], v[60:63], v[128:131]
    v_pk_mul_f16 v67, v67, v126
    v_mfma_f32_16x16x32_f16 v[132:135], a[4:7], v[60:63], v[132:135]
    buffer_load_dwordx4 a[80:83], v3, s[12:15], s97 offen offset:0
    v_mfma_f32_16x16x32_f16 v[136:139], a[8:11], v[60:63], v[136:139]
    v_mfma_f32_16x16x32_f16 v[140:143], a[12:15], v[60:63], v[140:143]
    v_mfma_f32_16x16x32_f16 v[144:147], a[0:3], v[64:67], v[144:147]
    s_waitcnt lgkmcnt(2)
    v_pk_fma_f16 v68, v40, s28, v36
    v_mfma_f32_16x16x32_f16 v[148:151], a[4:7], v[64:67], v[148:151]
    v_pk_mul_f16 v68, v68, v126
    v_pk_fma_f16 v69, v41, s28, v37
    v_mfma_f32_16x16x32_f16 v[152:155], a[8:11], v[64:67], v[152:155]
    v_pk_mul_f16 v69, v69, v126
    v_pk_fma_f16 v70, v42, s28, v38
    v_mfma_f32_16x16x32_f16 v[156:159], a[12:15], v[64:67], v[156:159]
    v_pk_mul_f16 v70, v70, v126
    v_pk_fma_f16 v71, v43, s28, v39
    s_waitcnt vmcnt(19)
    v_mfma_f32_16x16x32_f16 v[128:131], a[16:19], v[64:67], v[128:131]
    v_pk_mul_f16 v71, v71, v126
    ds_read_b128 v[52:55], v4 offset:4352
    v_mfma_f32_16x16x32_f16 v[132:135], a[20:23], v[64:67], v[132:135]
    ds_read_b128 v[56:59], v5 offset:4352
    v_mfma_f32_16x16x32_f16 v[136:139], a[24:27], v[64:67], v[136:139]
    buffer_load_dwordx4 a[84:87], v3, s[12:15], s97 offen offset:1024
    v_mfma_f32_16x16x32_f16 v[140:143], a[28:31], v[64:67], v[140:143]
    v_mfma_f32_16x16x32_f16 v[160:163], a[0:3], v[68:71], v[160:163]
    v_mfma_f32_16x16x32_f16 v[164:167], a[4:7], v[68:71], v[164:167]
    v_mfma_f32_16x16x32_f16 v[168:171], a[8:11], v[68:71], v[168:171]
    buffer_load_dwordx4 a[88:91], v3, s[12:15], s97 offen offset:2048
    v_mfma_f32_16x16x32_f16 v[172:175], a[12:15], v[68:71], v[172:175]
    v_mfma_f32_16x16x32_f16 v[144:147], a[16:19], v[68:71], v[144:147]
    s_waitcnt lgkmcnt(2)
    v_pk_fma_f16 v72, v48, s28, v44
    v_mfma_f32_16x16x32_f16 v[148:151], a[20:23], v[68:71], v[148:151]
    v_pk_mul_f16 v72, v72, v126
    v_pk_fma_f16 v73, v49, s28, v45
    v_mfma_f32_16x16x32_f16 v[152:155], a[24:27], v[68:71], v[152:155]
    v_pk_mul_f16 v73, v73, v126
    v_pk_fma_f16 v74, v50, s28, v46
    v_mfma_f32_16x16x32_f16 v[156:159], a[28:31], v[68:71], v[156:159]
    v_pk_mul_f16 v74, v74, v126
    v_pk_fma_f16 v75, v51, s28, v47
    s_waitcnt vmcnt(17)
    v_mfma_f32_16x16x32_f16 v[128:131], a[32:35], v[68:71], v[128:131]
    v_pk_mul_f16 v75, v75, v126
    ds_read_b128 v[20:23], v4 offset:5440
    buffer_load_dwordx4 a[92:95], v3, s[12:15], s97 offen offset:3072
    v_mfma_f32_16x16x32_f16 v[132:135], a[36:39], v[68:71], v[132:135]
    ds_read_b128 v[24:27], v5 offset:5440
    s_add_u32 s97, s97, 49152
    v_mfma_f32_16x16x32_f16 v[136:139], a[40:43], v[68:71], v[136:139]
    v_mfma_f32_16x16x32_f16 v[140:143], a[44:47], v[68:71], v[140:143]
    s_add_u32 m0, s30, 49152
    v_mfma_f32_16x16x32_f16 v[176:179], a[0:3], v[72:75], v[176:179]
    buffer_load_dwordx4 v8, s[8:11], s68 offen lds
    v_mfma_f32_16x16x32_f16 v[180:183], a[4:7], v[72:75], v[180:183]
    v_mfma_f32_16x16x32_f16 v[184:187], a[8:11], v[72:75], v[184:187]
    v_mfma_f32_16x16x32_f16 v[188:191], a[12:15], v[72:75], v[188:191]
    v_mfma_f32_16x16x32_f16 v[160:163], a[16:19], v[72:75], v[160:163]
    s_waitcnt lgkmcnt(2)
    v_pk_fma_f16 v60, v56, s28, v52
    v_mfma_f32_16x16x32_f16 v[164:167], a[20:23], v[72:75], v[164:167]
    v_pk_mul_f16 v60, v60, v126
    v_pk_fma_f16 v61, v57, s28, v53
    s_add_u32 m0, s30, 53248
    v_mfma_f32_16x16x32_f16 v[168:171], a[24:27], v[72:75], v[168:171]
    v_pk_mul_f16 v61, v61, v126
    v_pk_fma_f16 v62, v58, s28, v54
    buffer_load_dwordx4 v9, s[8:11], s68 offen lds
    v_mfma_f32_16x16x32_f16 v[172:175], a[28:31], v[72:75], v[172:175]
    v_pk_mul_f16 v62, v62, v126
    v_pk_fma_f16 v63, v59, s28, v55
    v_mfma_f32_16x16x32_f16 v[144:147], a[32:35], v[72:75], v[144:147]
    v_pk_mul_f16 v63, v63, v126
    ds_read_b128 v[28:31], v4 offset:6528
    v_mfma_f32_16x16x32_f16 v[148:151], a[36:39], v[72:75], v[148:151]
    ds_read_b128 v[32:35], v5 offset:6528
    s_add_u32 m0, s30, 57344
    v_mfma_f32_16x16x32_f16 v[152:155], a[40:43], v[72:75], v[152:155]
    buffer_load_dwordx4 v10, s[8:11], s68 offen lds
    v_mfma_f32_16x16x32_f16 v[156:159], a[44:47], v[72:75], v[156:159]
    v_mfma_f32_16x16x32_f16 v[192:195], a[0:3], v[60:63], v[192:195]
    v_mfma_f32_16x16x32_f16 v[196:199], a[4:7], v[60:63], v[196:199]
    s_add_u32 m0, s30, 61440
    v_mfma_f32_16x16x32_f16 v[200:203], a[8:11], v[60:63], v[200:203]
    buffer_load_dwordx4 v11, s[8:11], s68 offen lds
    v_mfma_f32_16x16x32_f16 v[204:207], a[12:15], v[60:63], v[204:207]
    v_mfma_f32_16x16x32_f16 v[176:179], a[16:19], v[60:63], v[176:179]
    s_waitcnt lgkmcnt(2)
    v_pk_fma_f16 v64, v24, s28, v20
    v_mfma_f32_16x16x32_f16 v[180:183], a[20:23], v[60:63], v[180:183]
    v_pk_mul_f16 v64, v64, v126
    v_pk_fma_f16 v65, v25, s28, v21
    v_mfma_f32_16x16x32_f16 v[184:187], a[24:27], v[60:63], v[184:187]
    v_pk_mul_f16 v65, v65, v126
    v_pk_fma_f16 v66, v26, s28, v22
    v_mfma_f32_16x16x32_f16 v[188:191], a[28:31], v[60:63], v[188:191]
    v_pk_mul_f16 v66, v66, v126
    v_pk_fma_f16 v67, v27, s28, v23
    v_mfma_f32_16x16x32_f16 v[160:163], a[32:35], v[60:63], v[160:163]
    v_pk_mul_f16 v67, v67, v126
    ds_read_b128 v[36:39], v4 offset:7616
    v_mfma_f32_16x16x32_f16 v[164:167], a[36:39], v[60:63], v[164:167]
    ds_read_b128 v[40:43], v5 offset:7616
    s_add_u32 m0, s30, 65536
    v_mfma_f32_16x16x32_f16 v[168:171], a[40:43], v[60:63], v[168:171]
    buffer_load_dwordx4 v12, s[8:11], s68 offen lds
    v_mfma_f32_16x16x32_f16 v[172:175], a[44:47], v[60:63], v[172:175]
    v_mfma_f32_16x16x32_f16 v[208:211], a[0:3], v[64:67], v[208:211]
    v_mfma_f32_16x16x32_f16 v[212:215], a[4:7], v[64:67], v[212:215]
    s_add_u32 m0, s30, 69632
    v_mfma_f32_16x16x32_f16 v[216:219], a[8:11], v[64:67], v[216:219]
    buffer_load_dwordx4 v13, s[8:11], s68 offen lds
    v_mfma_f32_16x16x32_f16 v[220:223], a[12:15], v[64:67], v[220:223]
    s_add_u32 s68, s68, 2228224
    v_mfma_f32_16x16x32_f16 v[192:195], a[16:19], v[64:67], v[192:195]
    s_waitcnt lgkmcnt(2)
    v_pk_fma_f16 v68, v32, s28, v28
    v_mfma_f32_16x16x32_f16 v[196:199], a[20:23], v[64:67], v[196:199]
    v_pk_mul_f16 v68, v68, v126
    v_pk_fma_f16 v69, v33, s28, v29
    v_mfma_f32_16x16x32_f16 v[200:203], a[24:27], v[64:67], v[200:203]
    v_pk_mul_f16 v69, v69, v126
    v_pk_fma_f16 v70, v34, s28, v30
    v_mfma_f32_16x16x32_f16 v[204:207], a[28:31], v[64:67], v[204:207]
    v_pk_mul_f16 v70, v70, v126
    v_pk_fma_f16 v71, v35, s28, v31
    v_mfma_f32_16x16x32_f16 v[176:179], a[32:35], v[64:67], v[176:179]
    v_pk_mul_f16 v71, v71, v126
    ds_read_b128 v[44:47], v4 offset:8704
    buffer_load_dwordx4 a[96:99], v1, s[12:15], s98 offen offset:0
    v_mfma_f32_16x16x32_f16 v[180:183], a[36:39], v[64:67], v[180:183]
    ds_read_b128 v[48:51], v5 offset:8704
    v_mfma_f32_16x16x32_f16 v[184:187], a[40:43], v[64:67], v[184:187]
    v_mfma_f32_16x16x32_f16 v[188:191], a[44:47], v[64:67], v[188:191]
    s_waitcnt vmcnt(19)
    s_barrier
    v_mfma_f32_16x16x32_f16 v[224:227], a[0:3], v[68:71], v[224:227]
    v_mfma_f32_16x16x32_f16 v[228:231], a[4:7], v[68:71], v[228:231]
    v_mfma_f32_16x16x32_f16 v[232:235], a[8:11], v[68:71], v[232:235]
    buffer_load_dwordx4 a[100:103], v1, s[12:15], s98 offen offset:1024
    v_mfma_f32_16x16x32_f16 v[236:239], a[12:15], v[68:71], v[236:239]
    v_mfma_f32_16x16x32_f16 v[208:211], a[16:19], v[68:71], v[208:211]
    s_waitcnt lgkmcnt(2)
    v_pk_fma_f16 v72, v40, s28, v36
    ds_read_b128 v[52:55], v4 offset:9792
    v_mfma_f32_16x16x32_f16 v[212:215], a[20:23], v[68:71], v[212:215]
    v_pk_mul_f16 v72, v72, v126
    v_pk_fma_f16 v73, v41, s28, v37
    ds_read_b128 v[56:59], v5 offset:9792
    v_mfma_f32_16x16x32_f16 v[216:219], a[24:27], v[68:71], v[216:219]
    v_pk_mul_f16 v73, v73, v126
    v_pk_fma_f16 v74, v42, s28, v38
    buffer_load_dwordx4 a[104:107], v1, s[12:15], s98 offen offset:2048
    v_mfma_f32_16x16x32_f16 v[220:223], a[28:31], v[68:71], v[220:223]
    v_pk_mul_f16 v74, v74, v126
    v_pk_fma_f16 v75, v43, s28, v39
    v_mfma_f32_16x16x32_f16 v[192:195], a[32:35], v[68:71], v[192:195]
    v_pk_mul_f16 v75, v75, v126
    ds_read_b128 v[20:23], v4 offset:24576
    v_mfma_f32_16x16x32_f16 v[196:199], a[36:39], v[68:71], v[196:199]
    ds_read_b128 v[24:27], v5 offset:24576
    v_mfma_f32_16x16x32_f16 v[200:203], a[40:43], v[68:71], v[200:203]
    buffer_load_dwordx4 a[108:111], v1, s[12:15], s98 offen offset:3072
    v_mfma_f32_16x16x32_f16 v[204:207], a[44:47], v[68:71], v[204:207]
    v_mfma_f32_16x16x32_f16 v[240:243], a[0:3], v[72:75], v[240:243]
    ds_read_b128 v[28:31], v4 offset:25664
    v_mfma_f32_16x16x32_f16 v[244:247], a[4:7], v[72:75], v[244:247]
    ds_read_b128 v[32:35], v5 offset:25664
    v_mfma_f32_16x16x32_f16 v[248:251], a[8:11], v[72:75], v[248:251]
    v_mfma_f32_16x16x32_f16 v[252:255], a[12:15], v[72:75], v[252:255]
    buffer_load_dwordx4 a[112:115], v2, s[12:15], s98 offen offset:0
    v_mfma_f32_16x16x32_f16 v[224:227], a[16:19], v[72:75], v[224:227]
    s_waitcnt lgkmcnt(6)
    v_pk_fma_f16 v60, v48, s28, v44
    v_mfma_f32_16x16x32_f16 v[228:231], a[20:23], v[72:75], v[228:231]
    v_pk_mul_f16 v60, v60, v126
    v_pk_fma_f16 v61, v49, s28, v45
    v_mfma_f32_16x16x32_f16 v[232:235], a[24:27], v[72:75], v[232:235]
    v_pk_mul_f16 v61, v61, v126
    v_pk_fma_f16 v62, v50, s28, v46
    v_mfma_f32_16x16x32_f16 v[236:239], a[28:31], v[72:75], v[236:239]
    v_pk_mul_f16 v62, v62, v126
    v_pk_fma_f16 v63, v51, s28, v47
    buffer_load_dwordx4 a[116:119], v2, s[12:15], s98 offen offset:1024
    v_mfma_f32_16x16x32_f16 v[208:211], a[32:35], v[72:75], v[208:211]
    v_pk_mul_f16 v63, v63, v126
    ds_read_b128 v[36:39], v4 offset:26752
    v_mfma_f32_16x16x32_f16 v[212:215], a[36:39], v[72:75], v[212:215]
    ds_read_b128 v[40:43], v5 offset:26752
    v_mfma_f32_16x16x32_f16 v[216:219], a[40:43], v[72:75], v[216:219]
    v_mfma_f32_16x16x32_f16 v[220:223], a[44:47], v[72:75], v[220:223]
    buffer_load_dwordx4 a[120:123], v2, s[12:15], s98 offen offset:2048
    v_mfma_f32_16x16x32_f16 v[240:243], a[16:19], v[60:63], v[240:243]
    s_waitcnt lgkmcnt(6)
    v_pk_fma_f16 v64, v56, s28, v52
    v_mfma_f32_16x16x32_f16 v[244:247], a[20:23], v[60:63], v[244:247]
    v_pk_mul_f16 v64, v64, v126
    v_pk_fma_f16 v65, v57, s28, v53
    v_mfma_f32_16x16x32_f16 v[248:251], a[24:27], v[60:63], v[248:251]
    v_pk_mul_f16 v65, v65, v126
    v_pk_fma_f16 v66, v58, s28, v54
    v_lshrrev_b32 v127, v19, s33
    v_perm_b32 v127, v127, v127, s31
    v_mfma_f32_16x16x32_f16 v[252:255], a[28:31], v[60:63], v[252:255]
    v_pk_mul_f16 v66, v66, v126
    v_pk_fma_f16 v67, v59, s28, v55
    v_mfma_f32_16x16x32_f16 v[224:227], a[32:35], v[60:63], v[224:227]
    v_pk_mul_f16 v67, v67, v126
    s_waitcnt lgkmcnt(4)
    v_pk_fma_f16 v68, v24, s28, v20
    v_mfma_f32_16x16x32_f16 v[228:231], a[36:39], v[60:63], v[228:231]
    v_pk_mul_f16 v68, v68, v127
    v_pk_fma_f16 v69, v25, s28, v21
    v_mfma_f32_16x16x32_f16 v[232:235], a[40:43], v[60:63], v[232:235]
    buffer_load_dwordx4 a[124:127], v2, s[12:15], s98 offen offset:3072
    v_pk_mul_f16 v69, v69, v127
    v_pk_fma_f16 v70, v26, s28, v22
    v_mfma_f32_16x16x32_f16 v[236:239], a[44:47], v[60:63], v[236:239]
    v_pk_mul_f16 v70, v70, v127
    v_pk_fma_f16 v71, v27, s28, v23
    v_mfma_f32_16x16x32_f16 v[240:243], a[32:35], v[64:67], v[240:243]
    v_pk_mul_f16 v71, v71, v127
    s_waitcnt lgkmcnt(2)
    v_pk_fma_f16 v72, v32, s28, v28
    ds_read_b128 v[44:47], v4 offset:27840
    v_mfma_f32_16x16x32_f16 v[244:247], a[36:39], v[64:67], v[244:247]
    v_pk_mul_f16 v72, v72, v127
    v_pk_fma_f16 v73, v33, s28, v29
    ds_read_b128 v[48:51], v5 offset:27840
    v_mfma_f32_16x16x32_f16 v[248:251], a[40:43], v[64:67], v[248:251]
    v_pk_mul_f16 v73, v73, v127
    v_pk_fma_f16 v74, v34, s28, v30
    v_mfma_f32_16x16x32_f16 v[252:255], a[44:47], v[64:67], v[252:255]
    s_waitcnt vmcnt(22)
    v_pk_mul_f16 v74, v74, v127
    v_pk_fma_f16 v75, v35, s28, v31
    v_mfma_f32_16x16x32_f16 v[128:131], a[48:51], v[68:71], v[128:131]
    v_pk_mul_f16 v75, v75, v127
    v_mfma_f32_16x16x32_f16 v[132:135], a[52:55], v[68:71], v[132:135]
    buffer_load_dwordx4 a[128:131], v3, s[12:15], s98 offen offset:0
    v_mfma_f32_16x16x32_f16 v[136:139], a[56:59], v[68:71], v[136:139]
    v_mfma_f32_16x16x32_f16 v[140:143], a[60:63], v[68:71], v[140:143]
    v_mfma_f32_16x16x32_f16 v[144:147], a[48:51], v[72:75], v[144:147]
    s_waitcnt lgkmcnt(2)
    v_pk_fma_f16 v60, v40, s28, v36
    v_mfma_f32_16x16x32_f16 v[148:151], a[52:55], v[72:75], v[148:151]
    v_pk_mul_f16 v60, v60, v127
    v_pk_fma_f16 v61, v41, s28, v37
    v_mfma_f32_16x16x32_f16 v[152:155], a[56:59], v[72:75], v[152:155]
    v_pk_mul_f16 v61, v61, v127
    v_pk_fma_f16 v62, v42, s28, v38
    v_mfma_f32_16x16x32_f16 v[156:159], a[60:63], v[72:75], v[156:159]
    v_pk_mul_f16 v62, v62, v127
    v_pk_fma_f16 v63, v43, s28, v39
    s_waitcnt vmcnt(19)
    v_mfma_f32_16x16x32_f16 v[128:131], a[64:67], v[72:75], v[128:131]
    v_pk_mul_f16 v63, v63, v127
    ds_read_b128 v[52:55], v4 offset:28928
    v_mfma_f32_16x16x32_f16 v[132:135], a[68:71], v[72:75], v[132:135]
    ds_read_b128 v[56:59], v5 offset:28928
    v_mfma_f32_16x16x32_f16 v[136:139], a[72:75], v[72:75], v[136:139]
    buffer_load_dwordx4 a[132:135], v3, s[12:15], s98 offen offset:1024
    v_mfma_f32_16x16x32_f16 v[140:143], a[76:79], v[72:75], v[140:143]
    v_mfma_f32_16x16x32_f16 v[160:163], a[48:51], v[60:63], v[160:163]
    v_mfma_f32_16x16x32_f16 v[164:167], a[52:55], v[60:63], v[164:167]
    v_mfma_f32_16x16x32_f16 v[168:171], a[56:59], v[60:63], v[168:171]
    buffer_load_dwordx4 a[136:139], v3, s[12:15], s98 offen offset:2048
    v_mfma_f32_16x16x32_f16 v[172:175], a[60:63], v[60:63], v[172:175]
    v_mfma_f32_16x16x32_f16 v[144:147], a[64:67], v[60:63], v[144:147]
    s_waitcnt lgkmcnt(2)
    v_pk_fma_f16 v64, v48, s28, v44
    v_mfma_f32_16x16x32_f16 v[148:151], a[68:71], v[60:63], v[148:151]
    v_pk_mul_f16 v64, v64, v127
    v_pk_fma_f16 v65, v49, s28, v45
    v_mfma_f32_16x16x32_f16 v[152:155], a[72:75], v[60:63], v[152:155]
    v_pk_mul_f16 v65, v65, v127
    v_pk_fma_f16 v66, v50, s28, v46
    v_mfma_f32_16x16x32_f16 v[156:159], a[76:79], v[60:63], v[156:159]
    v_pk_mul_f16 v66, v66, v127
    v_pk_fma_f16 v67, v51, s28, v47
    s_waitcnt vmcnt(17)
    v_mfma_f32_16x16x32_f16 v[128:131], a[80:83], v[60:63], v[128:131]
    v_pk_mul_f16 v67, v67, v127
    ds_read_b128 v[20:23], v4 offset:30016
    buffer_load_dwordx4 a[140:143], v3, s[12:15], s98 offen offset:3072
    v_mfma_f32_16x16x32_f16 v[132:135], a[84:87], v[60:63], v[132:135]
    ds_read_b128 v[24:27], v5 offset:30016
    s_add_u32 s98, s98, 49152
    v_mfma_f32_16x16x32_f16 v[136:139], a[88:91], v[60:63], v[136:139]
    v_mfma_f32_16x16x32_f16 v[140:143], a[92:95], v[60:63], v[140:143]
    s_add_u32 m0, s30, 73728
    v_mfma_f32_16x16x32_f16 v[176:179], a[48:51], v[64:67], v[176:179]
    buffer_load_dwordx4 v8, s[8:11], s69 offen lds
    v_mfma_f32_16x16x32_f16 v[180:183], a[52:55], v[64:67], v[180:183]
    v_mfma_f32_16x16x32_f16 v[184:187], a[56:59], v[64:67], v[184:187]
    v_mfma_f32_16x16x32_f16 v[188:191], a[60:63], v[64:67], v[188:191]
    v_mfma_f32_16x16x32_f16 v[160:163], a[64:67], v[64:67], v[160:163]
    s_waitcnt lgkmcnt(2)
    v_pk_fma_f16 v68, v56, s28, v52
    v_mfma_f32_16x16x32_f16 v[164:167], a[68:71], v[64:67], v[164:167]
    v_pk_mul_f16 v68, v68, v127
    v_pk_fma_f16 v69, v57, s28, v53
    s_add_u32 m0, s30, 77824
    v_mfma_f32_16x16x32_f16 v[168:171], a[72:75], v[64:67], v[168:171]
    v_pk_mul_f16 v69, v69, v127
    v_pk_fma_f16 v70, v58, s28, v54
    buffer_load_dwordx4 v9, s[8:11], s69 offen lds
    v_mfma_f32_16x16x32_f16 v[172:175], a[76:79], v[64:67], v[172:175]
    v_pk_mul_f16 v70, v70, v127
    v_pk_fma_f16 v71, v59, s28, v55
    v_mfma_f32_16x16x32_f16 v[144:147], a[80:83], v[64:67], v[144:147]
    v_pk_mul_f16 v71, v71, v127
    ds_read_b128 v[28:31], v4 offset:31104
    v_mfma_f32_16x16x32_f16 v[148:151], a[84:87], v[64:67], v[148:151]
    ds_read_b128 v[32:35], v5 offset:31104
    s_add_u32 m0, s30, 81920
    v_mfma_f32_16x16x32_f16 v[152:155], a[88:91], v[64:67], v[152:155]
    buffer_load_dwordx4 v10, s[8:11], s69 offen lds
    v_mfma_f32_16x16x32_f16 v[156:159], a[92:95], v[64:67], v[156:159]
    v_mfma_f32_16x16x32_f16 v[192:195], a[48:51], v[68:71], v[192:195]
    v_mfma_f32_16x16x32_f16 v[196:199], a[52:55], v[68:71], v[196:199]
    s_add_u32 m0, s30, 86016
    v_mfma_f32_16x16x32_f16 v[200:203], a[56:59], v[68:71], v[200:203]
    buffer_load_dwordx4 v11, s[8:11], s69 offen lds
    v_mfma_f32_16x16x32_f16 v[204:207], a[60:63], v[68:71], v[204:207]
    v_mfma_f32_16x16x32_f16 v[176:179], a[64:67], v[68:71], v[176:179]
    s_waitcnt lgkmcnt(2)
    v_pk_fma_f16 v72, v24, s28, v20
    v_mfma_f32_16x16x32_f16 v[180:183], a[68:71], v[68:71], v[180:183]
    v_pk_mul_f16 v72, v72, v127
    v_pk_fma_f16 v73, v25, s28, v21
    v_mfma_f32_16x16x32_f16 v[184:187], a[72:75], v[68:71], v[184:187]
    v_pk_mul_f16 v73, v73, v127
    v_pk_fma_f16 v74, v26, s28, v22
    v_mfma_f32_16x16x32_f16 v[188:191], a[76:79], v[68:71], v[188:191]
    v_pk_mul_f16 v74, v74, v127
    v_pk_fma_f16 v75, v27, s28, v23
    v_mfma_f32_16x16x32_f16 v[160:163], a[80:83], v[68:71], v[160:163]
    v_pk_mul_f16 v75, v75, v127
    ds_read_b128 v[36:39], v4 offset:32192
    v_mfma_f32_16x16x32_f16 v[164:167], a[84:87], v[68:71], v[164:167]
    ds_read_b128 v[40:43], v5 offset:32192
    s_add_u32 m0, s30, 90112
    v_mfma_f32_16x16x32_f16 v[168:171], a[88:91], v[68:71], v[168:171]
    buffer_load_dwordx4 v12, s[8:11], s69 offen lds
    v_mfma_f32_16x16x32_f16 v[172:175], a[92:95], v[68:71], v[172:175]
    v_mfma_f32_16x16x32_f16 v[208:211], a[48:51], v[72:75], v[208:211]
    v_mfma_f32_16x16x32_f16 v[212:215], a[52:55], v[72:75], v[212:215]
    s_add_u32 m0, s30, 94208
    v_mfma_f32_16x16x32_f16 v[216:219], a[56:59], v[72:75], v[216:219]
    buffer_load_dwordx4 v13, s[8:11], s69 offen lds
    v_mfma_f32_16x16x32_f16 v[220:223], a[60:63], v[72:75], v[220:223]
    s_add_u32 s69, s69, 2228224
    v_mfma_f32_16x16x32_f16 v[192:195], a[64:67], v[72:75], v[192:195]
    s_waitcnt lgkmcnt(2)
    v_pk_fma_f16 v60, v32, s28, v28
    v_mfma_f32_16x16x32_f16 v[196:199], a[68:71], v[72:75], v[196:199]
    v_pk_mul_f16 v60, v60, v127
    v_pk_fma_f16 v61, v33, s28, v29
    v_mfma_f32_16x16x32_f16 v[200:203], a[72:75], v[72:75], v[200:203]
    v_pk_mul_f16 v61, v61, v127
    v_pk_fma_f16 v62, v34, s28, v30
    v_mfma_f32_16x16x32_f16 v[204:207], a[76:79], v[72:75], v[204:207]
    v_pk_mul_f16 v62, v62, v127
    v_pk_fma_f16 v63, v35, s28, v31
    v_mfma_f32_16x16x32_f16 v[176:179], a[80:83], v[72:75], v[176:179]
    v_pk_mul_f16 v63, v63, v127
    ds_read_b128 v[44:47], v4 offset:33280
    buffer_load_dwordx4 a[144:147], v1, s[12:15], s99 offen offset:0
    v_mfma_f32_16x16x32_f16 v[180:183], a[84:87], v[72:75], v[180:183]
    ds_read_b128 v[48:51], v5 offset:33280
    v_mfma_f32_16x16x32_f16 v[184:187], a[88:91], v[72:75], v[184:187]
    v_mfma_f32_16x16x32_f16 v[188:191], a[92:95], v[72:75], v[188:191]
    s_waitcnt vmcnt(19)
    s_barrier
    v_mfma_f32_16x16x32_f16 v[224:227], a[48:51], v[60:63], v[224:227]
    v_mfma_f32_16x16x32_f16 v[228:231], a[52:55], v[60:63], v[228:231]
    v_mfma_f32_16x16x32_f16 v[232:235], a[56:59], v[60:63], v[232:235]
    buffer_load_dwordx4 a[148:151], v1, s[12:15], s99 offen offset:1024
    v_mfma_f32_16x16x32_f16 v[236:239], a[60:63], v[60:63], v[236:239]
    v_mfma_f32_16x16x32_f16 v[208:211], a[64:67], v[60:63], v[208:211]
    s_waitcnt lgkmcnt(2)
    v_pk_fma_f16 v64, v40, s28, v36
    ds_read_b128 v[52:55], v4 offset:34368
    v_mfma_f32_16x16x32_f16 v[212:215], a[68:71], v[60:63], v[212:215]
    v_pk_mul_f16 v64, v64, v127
    v_pk_fma_f16 v65, v41, s28, v37
    ds_read_b128 v[56:59], v5 offset:34368
    v_mfma_f32_16x16x32_f16 v[216:219], a[72:75], v[60:63], v[216:219]
    v_pk_mul_f16 v65, v65, v127
    v_pk_fma_f16 v66, v42, s28, v38
    buffer_load_dwordx4 a[152:155], v1, s[12:15], s99 offen offset:2048
    v_mfma_f32_16x16x32_f16 v[220:223], a[76:79], v[60:63], v[220:223]
    v_pk_mul_f16 v66, v66, v127
    v_pk_fma_f16 v67, v43, s28, v39
    v_mfma_f32_16x16x32_f16 v[192:195], a[80:83], v[60:63], v[192:195]
    v_pk_mul_f16 v67, v67, v127
    ds_read_b128 v[20:23], v6 offset:0
    v_mfma_f32_16x16x32_f16 v[196:199], a[84:87], v[60:63], v[196:199]
    ds_read_b128 v[24:27], v7 offset:0
    v_mfma_f32_16x16x32_f16 v[200:203], a[88:91], v[60:63], v[200:203]
    buffer_load_dwordx4 a[156:159], v1, s[12:15], s99 offen offset:3072
    v_mfma_f32_16x16x32_f16 v[204:207], a[92:95], v[60:63], v[204:207]
    v_mfma_f32_16x16x32_f16 v[240:243], a[48:51], v[64:67], v[240:243]
    ds_read_b128 v[28:31], v6 offset:1088
    v_mfma_f32_16x16x32_f16 v[244:247], a[52:55], v[64:67], v[244:247]
    ds_read_b128 v[32:35], v7 offset:1088
    v_mfma_f32_16x16x32_f16 v[248:251], a[56:59], v[64:67], v[248:251]
    v_mfma_f32_16x16x32_f16 v[252:255], a[60:63], v[64:67], v[252:255]
    buffer_load_dwordx4 a[160:163], v2, s[12:15], s99 offen offset:0
    v_mfma_f32_16x16x32_f16 v[224:227], a[64:67], v[64:67], v[224:227]
    s_waitcnt lgkmcnt(6)
    v_pk_fma_f16 v68, v48, s28, v44
    v_mfma_f32_16x16x32_f16 v[228:231], a[68:71], v[64:67], v[228:231]
    v_pk_mul_f16 v68, v68, v127
    v_pk_fma_f16 v69, v49, s28, v45
    v_mfma_f32_16x16x32_f16 v[232:235], a[72:75], v[64:67], v[232:235]
    v_pk_mul_f16 v69, v69, v127
    v_pk_fma_f16 v70, v50, s28, v46
    v_mfma_f32_16x16x32_f16 v[236:239], a[76:79], v[64:67], v[236:239]
    v_pk_mul_f16 v70, v70, v127
    v_pk_fma_f16 v71, v51, s28, v47
    buffer_load_dwordx4 a[164:167], v2, s[12:15], s99 offen offset:1024
    v_mfma_f32_16x16x32_f16 v[208:211], a[80:83], v[64:67], v[208:211]
    v_pk_mul_f16 v71, v71, v127
    ds_read_b128 v[36:39], v6 offset:2176
    v_mfma_f32_16x16x32_f16 v[212:215], a[84:87], v[64:67], v[212:215]
    ds_read_b128 v[40:43], v7 offset:2176
    v_mfma_f32_16x16x32_f16 v[216:219], a[88:91], v[64:67], v[216:219]
    v_mfma_f32_16x16x32_f16 v[220:223], a[92:95], v[64:67], v[220:223]
    buffer_load_dwordx4 a[168:171], v2, s[12:15], s99 offen offset:2048
    v_mfma_f32_16x16x32_f16 v[240:243], a[64:67], v[68:71], v[240:243]
    s_waitcnt lgkmcnt(6)
    v_pk_fma_f16 v72, v56, s28, v52
    v_mfma_f32_16x16x32_f16 v[244:247], a[68:71], v[68:71], v[244:247]
    v_pk_mul_f16 v72, v72, v127
    v_pk_fma_f16 v73, v57, s28, v53
    v_mfma_f32_16x16x32_f16 v[248:251], a[72:75], v[68:71], v[248:251]
    v_pk_mul_f16 v73, v73, v127
    v_pk_fma_f16 v74, v58, s28, v54
    v_lshrrev_b32 v126, v19, s34
    v_perm_b32 v126, v126, v126, s31
    v_mfma_f32_16x16x32_f16 v[252:255], a[76:79], v[68:71], v[252:255]
    v_pk_mul_f16 v74, v74, v127
    v_pk_fma_f16 v75, v59, s28, v55
    v_mfma_f32_16x16x32_f16 v[224:227], a[80:83], v[68:71], v[224:227]
    v_pk_mul_f16 v75, v75, v127
    s_waitcnt lgkmcnt(4)
    v_pk_fma_f16 v60, v24, s28, v20
    v_mfma_f32_16x16x32_f16 v[228:231], a[84:87], v[68:71], v[228:231]
    v_pk_mul_f16 v60, v60, v126
    v_pk_fma_f16 v61, v25, s28, v21
    v_mfma_f32_16x16x32_f16 v[232:235], a[88:91], v[68:71], v[232:235]
    buffer_load_dwordx4 a[172:175], v2, s[12:15], s99 offen offset:3072
    v_pk_mul_f16 v61, v61, v126
    v_pk_fma_f16 v62, v26, s28, v22
    v_mfma_f32_16x16x32_f16 v[236:239], a[92:95], v[68:71], v[236:239]
    v_pk_mul_f16 v62, v62, v126
    v_pk_fma_f16 v63, v27, s28, v23
    v_mfma_f32_16x16x32_f16 v[240:243], a[80:83], v[72:75], v[240:243]
    v_pk_mul_f16 v63, v63, v126
    s_waitcnt lgkmcnt(2)
    v_pk_fma_f16 v64, v32, s28, v28
    ds_read_b128 v[44:47], v6 offset:3264
    v_mfma_f32_16x16x32_f16 v[244:247], a[84:87], v[72:75], v[244:247]
    v_pk_mul_f16 v64, v64, v126
    v_pk_fma_f16 v65, v33, s28, v29
    ds_read_b128 v[48:51], v7 offset:3264
    v_mfma_f32_16x16x32_f16 v[248:251], a[88:91], v[72:75], v[248:251]
    v_pk_mul_f16 v65, v65, v126
    v_pk_fma_f16 v66, v34, s28, v30
    v_mfma_f32_16x16x32_f16 v[252:255], a[92:95], v[72:75], v[252:255]
    s_waitcnt vmcnt(22)
    v_pk_mul_f16 v66, v66, v126
    v_pk_fma_f16 v67, v35, s28, v31
    v_mfma_f32_16x16x32_f16 v[128:131], a[96:99], v[60:63], v[128:131]
    v_pk_mul_f16 v67, v67, v126
    v_mfma_f32_16x16x32_f16 v[132:135], a[100:103], v[60:63], v[132:135]
    buffer_load_dwordx4 a[176:179], v3, s[12:15], s99 offen offset:0
    v_mfma_f32_16x16x32_f16 v[136:139], a[104:107], v[60:63], v[136:139]
    v_mfma_f32_16x16x32_f16 v[140:143], a[108:111], v[60:63], v[140:143]
    v_mfma_f32_16x16x32_f16 v[144:147], a[96:99], v[64:67], v[144:147]
    s_waitcnt lgkmcnt(2)
    v_pk_fma_f16 v68, v40, s28, v36
    v_mfma_f32_16x16x32_f16 v[148:151], a[100:103], v[64:67], v[148:151]
    v_pk_mul_f16 v68, v68, v126
    v_pk_fma_f16 v69, v41, s28, v37
    v_mfma_f32_16x16x32_f16 v[152:155], a[104:107], v[64:67], v[152:155]
    v_pk_mul_f16 v69, v69, v126
    v_pk_fma_f16 v70, v42, s28, v38
    v_mfma_f32_16x16x32_f16 v[156:159], a[108:111], v[64:67], v[156:159]
    v_pk_mul_f16 v70, v70, v126
    v_pk_fma_f16 v71, v43, s28, v39
    s_waitcnt vmcnt(19)
    v_mfma_f32_16x16x32_f16 v[128:131], a[112:115], v[64:67], v[128:131]
    v_pk_mul_f16 v71, v71, v126
    ds_read_b128 v[52:55], v6 offset:4352
    v_mfma_f32_16x16x32_f16 v[132:135], a[116:119], v[64:67], v[132:135]
    ds_read_b128 v[56:59], v7 offset:4352
    v_mfma_f32_16x16x32_f16 v[136:139], a[120:123], v[64:67], v[136:139]
    buffer_load_dwordx4 a[180:183], v3, s[12:15], s99 offen offset:1024
    v_mfma_f32_16x16x32_f16 v[140:143], a[124:127], v[64:67], v[140:143]
    v_mfma_f32_16x16x32_f16 v[160:163], a[96:99], v[68:71], v[160:163]
    v_mfma_f32_16x16x32_f16 v[164:167], a[100:103], v[68:71], v[164:167]
    v_mfma_f32_16x16x32_f16 v[168:171], a[104:107], v[68:71], v[168:171]
    buffer_load_dwordx4 a[184:187], v3, s[12:15], s99 offen offset:2048
    v_mfma_f32_16x16x32_f16 v[172:175], a[108:111], v[68:71], v[172:175]
    v_mfma_f32_16x16x32_f16 v[144:147], a[112:115], v[68:71], v[144:147]
    s_waitcnt lgkmcnt(2)
    v_pk_fma_f16 v72, v48, s28, v44
    v_mfma_f32_16x16x32_f16 v[148:151], a[116:119], v[68:71], v[148:151]
    v_pk_mul_f16 v72, v72, v126
    v_pk_fma_f16 v73, v49, s28, v45
    v_mfma_f32_16x16x32_f16 v[152:155], a[120:123], v[68:71], v[152:155]
    v_pk_mul_f16 v73, v73, v126
    v_pk_fma_f16 v74, v50, s28, v46
    v_mfma_f32_16x16x32_f16 v[156:159], a[124:127], v[68:71], v[156:159]
    v_pk_mul_f16 v74, v74, v126
    v_pk_fma_f16 v75, v51, s28, v47
    s_waitcnt vmcnt(17)
    v_mfma_f32_16x16x32_f16 v[128:131], a[128:131], v[68:71], v[128:131]
    v_pk_mul_f16 v75, v75, v126
    ds_read_b128 v[20:23], v6 offset:5440
    buffer_load_dwordx4 a[188:191], v3, s[12:15], s99 offen offset:3072
    v_mfma_f32_16x16x32_f16 v[132:135], a[132:135], v[68:71], v[132:135]
    ds_read_b128 v[24:27], v7 offset:5440
    s_add_u32 s99, s99, 49152
    v_mfma_f32_16x16x32_f16 v[136:139], a[136:139], v[68:71], v[136:139]
    v_mfma_f32_16x16x32_f16 v[140:143], a[140:143], v[68:71], v[140:143]
    s_add_u32 m0, s30, 0
    v_mfma_f32_16x16x32_f16 v[176:179], a[96:99], v[72:75], v[176:179]
    buffer_load_dwordx4 v8, s[8:11], s24 offen lds
    v_mfma_f32_16x16x32_f16 v[180:183], a[100:103], v[72:75], v[180:183]
    v_mfma_f32_16x16x32_f16 v[184:187], a[104:107], v[72:75], v[184:187]
    v_mfma_f32_16x16x32_f16 v[188:191], a[108:111], v[72:75], v[188:191]
    v_mfma_f32_16x16x32_f16 v[160:163], a[112:115], v[72:75], v[160:163]
    s_waitcnt lgkmcnt(2)
    v_pk_fma_f16 v60, v56, s28, v52
    v_mfma_f32_16x16x32_f16 v[164:167], a[116:119], v[72:75], v[164:167]
    v_pk_mul_f16 v60, v60, v126
    v_pk_fma_f16 v61, v57, s28, v53
    s_add_u32 m0, s30, 4096
    v_mfma_f32_16x16x32_f16 v[168:171], a[120:123], v[72:75], v[168:171]
    v_pk_mul_f16 v61, v61, v126
    v_pk_fma_f16 v62, v58, s28, v54
    buffer_load_dwordx4 v9, s[8:11], s24 offen lds
    v_mfma_f32_16x16x32_f16 v[172:175], a[124:127], v[72:75], v[172:175]
    v_pk_mul_f16 v62, v62, v126
    v_pk_fma_f16 v63, v59, s28, v55
    v_mfma_f32_16x16x32_f16 v[144:147], a[128:131], v[72:75], v[144:147]
    v_pk_mul_f16 v63, v63, v126
    ds_read_b128 v[28:31], v6 offset:6528
    v_mfma_f32_16x16x32_f16 v[148:151], a[132:135], v[72:75], v[148:151]
    ds_read_b128 v[32:35], v7 offset:6528
    s_add_u32 m0, s30, 8192
    v_mfma_f32_16x16x32_f16 v[152:155], a[136:139], v[72:75], v[152:155]
    buffer_load_dwordx4 v10, s[8:11], s24 offen lds
    v_mfma_f32_16x16x32_f16 v[156:159], a[140:143], v[72:75], v[156:159]
    v_mfma_f32_16x16x32_f16 v[192:195], a[96:99], v[60:63], v[192:195]
    v_mfma_f32_16x16x32_f16 v[196:199], a[100:103], v[60:63], v[196:199]
    s_add_u32 m0, s30, 12288
    v_mfma_f32_16x16x32_f16 v[200:203], a[104:107], v[60:63], v[200:203]
    buffer_load_dwordx4 v11, s[8:11], s24 offen lds
    v_mfma_f32_16x16x32_f16 v[204:207], a[108:111], v[60:63], v[204:207]
    v_mfma_f32_16x16x32_f16 v[176:179], a[112:115], v[60:63], v[176:179]
    s_waitcnt lgkmcnt(2)
    v_pk_fma_f16 v64, v24, s28, v20
    v_mfma_f32_16x16x32_f16 v[180:183], a[116:119], v[60:63], v[180:183]
    v_pk_mul_f16 v64, v64, v126
    v_pk_fma_f16 v65, v25, s28, v21
    v_mfma_f32_16x16x32_f16 v[184:187], a[120:123], v[60:63], v[184:187]
    v_pk_mul_f16 v65, v65, v126
    v_pk_fma_f16 v66, v26, s28, v22
    v_mfma_f32_16x16x32_f16 v[188:191], a[124:127], v[60:63], v[188:191]
    v_pk_mul_f16 v66, v66, v126
    v_pk_fma_f16 v67, v27, s28, v23
    v_mfma_f32_16x16x32_f16 v[160:163], a[128:131], v[60:63], v[160:163]
    v_pk_mul_f16 v67, v67, v126
    ds_read_b128 v[36:39], v6 offset:7616
    v_mfma_f32_16x16x32_f16 v[164:167], a[132:135], v[60:63], v[164:167]
    ds_read_b128 v[40:43], v7 offset:7616
    s_add_u32 m0, s30, 16384
    v_mfma_f32_16x16x32_f16 v[168:171], a[136:139], v[60:63], v[168:171]
    buffer_load_dwordx4 v12, s[8:11], s24 offen lds
    v_mfma_f32_16x16x32_f16 v[172:175], a[140:143], v[60:63], v[172:175]
    v_mfma_f32_16x16x32_f16 v[208:211], a[96:99], v[64:67], v[208:211]
    v_mfma_f32_16x16x32_f16 v[212:215], a[100:103], v[64:67], v[212:215]
    s_add_u32 m0, s30, 20480
    v_mfma_f32_16x16x32_f16 v[216:219], a[104:107], v[64:67], v[216:219]
    buffer_load_dwordx4 v13, s[8:11], s24 offen lds
    v_mfma_f32_16x16x32_f16 v[220:223], a[108:111], v[64:67], v[220:223]
    s_add_u32 s24, s24, 2228224
    v_mfma_f32_16x16x32_f16 v[192:195], a[112:115], v[64:67], v[192:195]
    s_waitcnt lgkmcnt(2)
    v_pk_fma_f16 v68, v32, s28, v28
    v_mfma_f32_16x16x32_f16 v[196:199], a[116:119], v[64:67], v[196:199]
    v_pk_mul_f16 v68, v68, v126
    v_pk_fma_f16 v69, v33, s28, v29
    v_mfma_f32_16x16x32_f16 v[200:203], a[120:123], v[64:67], v[200:203]
    v_pk_mul_f16 v69, v69, v126
    v_pk_fma_f16 v70, v34, s28, v30
    v_mfma_f32_16x16x32_f16 v[204:207], a[124:127], v[64:67], v[204:207]
    v_pk_mul_f16 v70, v70, v126
    v_pk_fma_f16 v71, v35, s28, v31
    v_mfma_f32_16x16x32_f16 v[176:179], a[128:131], v[64:67], v[176:179]
    v_pk_mul_f16 v71, v71, v126
    ds_read_b128 v[44:47], v6 offset:8704
    buffer_load_dwordx4 a[0:3], v1, s[12:15], s96 offen offset:0
    v_mfma_f32_16x16x32_f16 v[180:183], a[132:135], v[64:67], v[180:183]
    ds_read_b128 v[48:51], v7 offset:8704
    v_mfma_f32_16x16x32_f16 v[184:187], a[136:139], v[64:67], v[184:187]
    v_mfma_f32_16x16x32_f16 v[188:191], a[140:143], v[64:67], v[188:191]
    s_waitcnt vmcnt(19)
    s_barrier
    v_mfma_f32_16x16x32_f16 v[224:227], a[96:99], v[68:71], v[224:227]
    v_mfma_f32_16x16x32_f16 v[228:231], a[100:103], v[68:71], v[228:231]
    v_mfma_f32_16x16x32_f16 v[232:235], a[104:107], v[68:71], v[232:235]
    buffer_load_dwordx4 a[4:7], v1, s[12:15], s96 offen offset:1024
    v_mfma_f32_16x16x32_f16 v[236:239], a[108:111], v[68:71], v[236:239]
    v_mfma_f32_16x16x32_f16 v[208:211], a[112:115], v[68:71], v[208:211]
    s_waitcnt lgkmcnt(2)
    v_pk_fma_f16 v72, v40, s28, v36
    ds_read_b128 v[52:55], v6 offset:9792
    v_mfma_f32_16x16x32_f16 v[212:215], a[116:119], v[68:71], v[212:215]
    v_pk_mul_f16 v72, v72, v126
    v_pk_fma_f16 v73, v41, s28, v37
    ds_read_b128 v[56:59], v7 offset:9792
    v_mfma_f32_16x16x32_f16 v[216:219], a[120:123], v[68:71], v[216:219]
    v_pk_mul_f16 v73, v73, v126
    v_pk_fma_f16 v74, v42, s28, v38
    buffer_load_dwordx4 a[8:11], v1, s[12:15], s96 offen offset:2048
    v_mfma_f32_16x16x32_f16 v[220:223], a[124:127], v[68:71], v[220:223]
    v_pk_mul_f16 v74, v74, v126
    v_pk_fma_f16 v75, v43, s28, v39
    v_mfma_f32_16x16x32_f16 v[192:195], a[128:131], v[68:71], v[192:195]
    v_pk_mul_f16 v75, v75, v126
    ds_read_b128 v[20:23], v6 offset:24576
    v_mfma_f32_16x16x32_f16 v[196:199], a[132:135], v[68:71], v[196:199]
    ds_read_b128 v[24:27], v7 offset:24576
    v_mfma_f32_16x16x32_f16 v[200:203], a[136:139], v[68:71], v[200:203]
    buffer_load_dwordx4 a[12:15], v1, s[12:15], s96 offen offset:3072
    v_mfma_f32_16x16x32_f16 v[204:207], a[140:143], v[68:71], v[204:207]
    v_mfma_f32_16x16x32_f16 v[240:243], a[96:99], v[72:75], v[240:243]
    ds_read_b128 v[28:31], v6 offset:25664
    v_mfma_f32_16x16x32_f16 v[244:247], a[100:103], v[72:75], v[244:247]
    ds_read_b128 v[32:35], v7 offset:25664
    v_mfma_f32_16x16x32_f16 v[248:251], a[104:107], v[72:75], v[248:251]
    v_mfma_f32_16x16x32_f16 v[252:255], a[108:111], v[72:75], v[252:255]
    buffer_load_dwordx4 a[16:19], v2, s[12:15], s96 offen offset:0
    v_mfma_f32_16x16x32_f16 v[224:227], a[112:115], v[72:75], v[224:227]
    s_waitcnt lgkmcnt(6)
    v_pk_fma_f16 v60, v48, s28, v44
    v_mfma_f32_16x16x32_f16 v[228:231], a[116:119], v[72:75], v[228:231]
    v_pk_mul_f16 v60, v60, v126
    v_pk_fma_f16 v61, v49, s28, v45
    v_mfma_f32_16x16x32_f16 v[232:235], a[120:123], v[72:75], v[232:235]
    v_pk_mul_f16 v61, v61, v126
    v_pk_fma_f16 v62, v50, s28, v46
    v_mfma_f32_16x16x32_f16 v[236:239], a[124:127], v[72:75], v[236:239]
    v_pk_mul_f16 v62, v62, v126
    v_pk_fma_f16 v63, v51, s28, v47
    buffer_load_dwordx4 a[20:23], v2, s[12:15], s96 offen offset:1024
    v_mfma_f32_16x16x32_f16 v[208:211], a[128:131], v[72:75], v[208:211]
    v_pk_mul_f16 v63, v63, v126
    ds_read_b128 v[36:39], v6 offset:26752
    v_mfma_f32_16x16x32_f16 v[212:215], a[132:135], v[72:75], v[212:215]
    ds_read_b128 v[40:43], v7 offset:26752
    v_mfma_f32_16x16x32_f16 v[216:219], a[136:139], v[72:75], v[216:219]
    v_mfma_f32_16x16x32_f16 v[220:223], a[140:143], v[72:75], v[220:223]
    buffer_load_dwordx4 a[24:27], v2, s[12:15], s96 offen offset:2048
    v_mfma_f32_16x16x32_f16 v[240:243], a[112:115], v[60:63], v[240:243]
    s_waitcnt lgkmcnt(6)
    v_pk_fma_f16 v64, v56, s28, v52
    v_mfma_f32_16x16x32_f16 v[244:247], a[116:119], v[60:63], v[244:247]
    v_pk_mul_f16 v64, v64, v126
    v_pk_fma_f16 v65, v57, s28, v53
    v_mfma_f32_16x16x32_f16 v[248:251], a[120:123], v[60:63], v[248:251]
    v_pk_mul_f16 v65, v65, v126
    v_pk_fma_f16 v66, v58, s28, v54
    v_lshrrev_b32 v127, v19, s35
    v_perm_b32 v127, v127, v127, s31
    v_mfma_f32_16x16x32_f16 v[252:255], a[124:127], v[60:63], v[252:255]
    v_pk_mul_f16 v66, v66, v126
    v_pk_fma_f16 v67, v59, s28, v55
    v_mfma_f32_16x16x32_f16 v[224:227], a[128:131], v[60:63], v[224:227]
    v_pk_mul_f16 v67, v67, v126
    s_waitcnt lgkmcnt(4)
    v_pk_fma_f16 v68, v24, s28, v20
    v_mfma_f32_16x16x32_f16 v[228:231], a[132:135], v[60:63], v[228:231]
    v_pk_mul_f16 v68, v68, v127
    v_pk_fma_f16 v69, v25, s28, v21
    v_mfma_f32_16x16x32_f16 v[232:235], a[136:139], v[60:63], v[232:235]
    buffer_load_dwordx4 a[28:31], v2, s[12:15], s96 offen offset:3072
    v_pk_mul_f16 v69, v69, v127
    v_pk_fma_f16 v70, v26, s28, v22
    v_mfma_f32_16x16x32_f16 v[236:239], a[140:143], v[60:63], v[236:239]
    v_pk_mul_f16 v70, v70, v127
    v_pk_fma_f16 v71, v27, s28, v23
    v_mfma_f32_16x16x32_f16 v[240:243], a[128:131], v[64:67], v[240:243]
    v_pk_mul_f16 v71, v71, v127
    s_waitcnt lgkmcnt(2)
    v_pk_fma_f16 v72, v32, s28, v28
    ds_read_b128 v[44:47], v6 offset:27840
    v_mfma_f32_16x16x32_f16 v[244:247], a[132:135], v[64:67], v[244:247]
    v_pk_mul_f16 v72, v72, v127
    v_pk_fma_f16 v73, v33, s28, v29
    ds_read_b128 v[48:51], v7 offset:27840
    v_mfma_f32_16x16x32_f16 v[248:251], a[136:139], v[64:67], v[248:251]
    v_pk_mul_f16 v73, v73, v127
    v_pk_fma_f16 v74, v34, s28, v30
    v_mfma_f32_16x16x32_f16 v[252:255], a[140:143], v[64:67], v[252:255]
    s_waitcnt vmcnt(22)
    v_pk_mul_f16 v74, v74, v127
    v_pk_fma_f16 v75, v35, s28, v31
    v_mfma_f32_16x16x32_f16 v[128:131], a[144:147], v[68:71], v[128:131]
    v_pk_mul_f16 v75, v75, v127
    v_mfma_f32_16x16x32_f16 v[132:135], a[148:151], v[68:71], v[132:135]
    buffer_load_dwordx4 a[32:35], v3, s[12:15], s96 offen offset:0
    v_mfma_f32_16x16x32_f16 v[136:139], a[152:155], v[68:71], v[136:139]
    v_mfma_f32_16x16x32_f16 v[140:143], a[156:159], v[68:71], v[140:143]
    v_mfma_f32_16x16x32_f16 v[144:147], a[144:147], v[72:75], v[144:147]
    s_waitcnt lgkmcnt(2)
    v_pk_fma_f16 v60, v40, s28, v36
    v_mfma_f32_16x16x32_f16 v[148:151], a[148:151], v[72:75], v[148:151]
    v_pk_mul_f16 v60, v60, v127
    v_pk_fma_f16 v61, v41, s28, v37
    v_mfma_f32_16x16x32_f16 v[152:155], a[152:155], v[72:75], v[152:155]
    v_pk_mul_f16 v61, v61, v127
    v_pk_fma_f16 v62, v42, s28, v38
    v_mfma_f32_16x16x32_f16 v[156:159], a[156:159], v[72:75], v[156:159]
    v_pk_mul_f16 v62, v62, v127
    v_pk_fma_f16 v63, v43, s28, v39
    s_waitcnt vmcnt(19)
    v_mfma_f32_16x16x32_f16 v[128:131], a[160:163], v[72:75], v[128:131]
    v_pk_mul_f16 v63, v63, v127
    ds_read_b128 v[52:55], v6 offset:28928
    v_mfma_f32_16x16x32_f16 v[132:135], a[164:167], v[72:75], v[132:135]
    ds_read_b128 v[56:59], v7 offset:28928
    v_mfma_f32_16x16x32_f16 v[136:139], a[168:171], v[72:75], v[136:139]
    buffer_load_dwordx4 a[36:39], v3, s[12:15], s96 offen offset:1024
    v_mfma_f32_16x16x32_f16 v[140:143], a[172:175], v[72:75], v[140:143]
    v_mfma_f32_16x16x32_f16 v[160:163], a[144:147], v[60:63], v[160:163]
    v_mfma_f32_16x16x32_f16 v[164:167], a[148:151], v[60:63], v[164:167]
    v_mfma_f32_16x16x32_f16 v[168:171], a[152:155], v[60:63], v[168:171]
    buffer_load_dwordx4 a[40:43], v3, s[12:15], s96 offen offset:2048
    v_mfma_f32_16x16x32_f16 v[172:175], a[156:159], v[60:63], v[172:175]
    v_mfma_f32_16x16x32_f16 v[144:147], a[160:163], v[60:63], v[144:147]
    s_waitcnt lgkmcnt(2)
    v_pk_fma_f16 v64, v48, s28, v44
    v_mfma_f32_16x16x32_f16 v[148:151], a[164:167], v[60:63], v[148:151]
    v_pk_mul_f16 v64, v64, v127
    v_pk_fma_f16 v65, v49, s28, v45
    v_mfma_f32_16x16x32_f16 v[152:155], a[168:171], v[60:63], v[152:155]
    v_pk_mul_f16 v65, v65, v127
    v_pk_fma_f16 v66, v50, s28, v46
    v_mfma_f32_16x16x32_f16 v[156:159], a[172:175], v[60:63], v[156:159]
    v_pk_mul_f16 v66, v66, v127
    v_pk_fma_f16 v67, v51, s28, v47
    s_waitcnt vmcnt(17)
    v_mfma_f32_16x16x32_f16 v[128:131], a[176:179], v[60:63], v[128:131]
    v_pk_mul_f16 v67, v67, v127
    ds_read_b128 v[20:23], v6 offset:30016
    buffer_load_dwordx4 a[44:47], v3, s[12:15], s96 offen offset:3072
    v_mfma_f32_16x16x32_f16 v[132:135], a[180:183], v[60:63], v[132:135]
    ds_read_b128 v[24:27], v7 offset:30016
    s_add_u32 s96, s96, 49152
    v_mfma_f32_16x16x32_f16 v[136:139], a[184:187], v[60:63], v[136:139]
    v_mfma_f32_16x16x32_f16 v[140:143], a[188:191], v[60:63], v[140:143]
    s_add_u32 m0, s30, 24576
    v_mfma_f32_16x16x32_f16 v[176:179], a[144:147], v[64:67], v[176:179]
    buffer_load_dwordx4 v8, s[8:11], s51 offen lds
    v_mfma_f32_16x16x32_f16 v[180:183], a[148:151], v[64:67], v[180:183]
    v_mfma_f32_16x16x32_f16 v[184:187], a[152:155], v[64:67], v[184:187]
    v_mfma_f32_16x16x32_f16 v[188:191], a[156:159], v[64:67], v[188:191]
    v_mfma_f32_16x16x32_f16 v[160:163], a[160:163], v[64:67], v[160:163]
    s_waitcnt lgkmcnt(2)
    v_pk_fma_f16 v68, v56, s28, v52
    v_mfma_f32_16x16x32_f16 v[164:167], a[164:167], v[64:67], v[164:167]
    v_pk_mul_f16 v68, v68, v127
    v_pk_fma_f16 v69, v57, s28, v53
    s_add_u32 m0, s30, 28672
    v_mfma_f32_16x16x32_f16 v[168:171], a[168:171], v[64:67], v[168:171]
    v_pk_mul_f16 v69, v69, v127
    v_pk_fma_f16 v70, v58, s28, v54
    buffer_load_dwordx4 v9, s[8:11], s51 offen lds
    v_mfma_f32_16x16x32_f16 v[172:175], a[172:175], v[64:67], v[172:175]
    v_pk_mul_f16 v70, v70, v127
    v_pk_fma_f16 v71, v59, s28, v55
    v_mfma_f32_16x16x32_f16 v[144:147], a[176:179], v[64:67], v[144:147]
    v_pk_mul_f16 v71, v71, v127
    ds_read_b128 v[28:31], v6 offset:31104
    v_mfma_f32_16x16x32_f16 v[148:151], a[180:183], v[64:67], v[148:151]
    ds_read_b128 v[32:35], v7 offset:31104
    s_add_u32 m0, s30, 32768
    v_mfma_f32_16x16x32_f16 v[152:155], a[184:187], v[64:67], v[152:155]
    buffer_load_dwordx4 v10, s[8:11], s51 offen lds
    v_mfma_f32_16x16x32_f16 v[156:159], a[188:191], v[64:67], v[156:159]
    v_mfma_f32_16x16x32_f16 v[192:195], a[144:147], v[68:71], v[192:195]
    v_mfma_f32_16x16x32_f16 v[196:199], a[148:151], v[68:71], v[196:199]
    s_add_u32 m0, s30, 36864
    v_mfma_f32_16x16x32_f16 v[200:203], a[152:155], v[68:71], v[200:203]
    buffer_load_dwordx4 v11, s[8:11], s51 offen lds
    v_mfma_f32_16x16x32_f16 v[204:207], a[156:159], v[68:71], v[204:207]
    v_mfma_f32_16x16x32_f16 v[176:179], a[160:163], v[68:71], v[176:179]
    s_waitcnt lgkmcnt(2)
    v_pk_fma_f16 v72, v24, s28, v20
    v_mfma_f32_16x16x32_f16 v[180:183], a[164:167], v[68:71], v[180:183]
    v_pk_mul_f16 v72, v72, v127
    v_pk_fma_f16 v73, v25, s28, v21
    v_mfma_f32_16x16x32_f16 v[184:187], a[168:171], v[68:71], v[184:187]
    v_pk_mul_f16 v73, v73, v127
    v_pk_fma_f16 v74, v26, s28, v22
    v_mfma_f32_16x16x32_f16 v[188:191], a[172:175], v[68:71], v[188:191]
    v_pk_mul_f16 v74, v74, v127
    v_pk_fma_f16 v75, v27, s28, v23
    v_mfma_f32_16x16x32_f16 v[160:163], a[176:179], v[68:71], v[160:163]
    v_pk_mul_f16 v75, v75, v127
    ds_read_b128 v[36:39], v6 offset:32192
    v_mfma_f32_16x16x32_f16 v[164:167], a[180:183], v[68:71], v[164:167]
    ds_read_b128 v[40:43], v7 offset:32192
    s_add_u32 m0, s30, 40960
    v_mfma_f32_16x16x32_f16 v[168:171], a[184:187], v[68:71], v[168:171]
    buffer_load_dwordx4 v12, s[8:11], s51 offen lds
    v_mfma_f32_16x16x32_f16 v[172:175], a[188:191], v[68:71], v[172:175]
    v_mfma_f32_16x16x32_f16 v[208:211], a[144:147], v[72:75], v[208:211]
    v_mfma_f32_16x16x32_f16 v[212:215], a[148:151], v[72:75], v[212:215]
    s_add_u32 m0, s30, 45056
    v_mfma_f32_16x16x32_f16 v[216:219], a[152:155], v[72:75], v[216:219]
    buffer_load_dwordx4 v13, s[8:11], s51 offen lds
    v_mfma_f32_16x16x32_f16 v[220:223], a[156:159], v[72:75], v[220:223]
    s_add_u32 s51, s51, 2228224
    v_mfma_f32_16x16x32_f16 v[192:195], a[160:163], v[72:75], v[192:195]
    s_waitcnt lgkmcnt(2)
    v_pk_fma_f16 v60, v32, s28, v28
    v_mfma_f32_16x16x32_f16 v[196:199], a[164:167], v[72:75], v[196:199]
    v_pk_mul_f16 v60, v60, v127
    v_pk_fma_f16 v61, v33, s28, v29
    v_mfma_f32_16x16x32_f16 v[200:203], a[168:171], v[72:75], v[200:203]
    v_pk_mul_f16 v61, v61, v127
    v_pk_fma_f16 v62, v34, s28, v30
    v_mfma_f32_16x16x32_f16 v[204:207], a[172:175], v[72:75], v[204:207]
    v_pk_mul_f16 v62, v62, v127
    v_pk_fma_f16 v63, v35, s28, v31
    v_mfma_f32_16x16x32_f16 v[176:179], a[176:179], v[72:75], v[176:179]
    v_pk_mul_f16 v63, v63, v127
    ds_read_b128 v[44:47], v6 offset:33280
    buffer_load_dwordx4 a[48:51], v1, s[12:15], s97 offen offset:0
    v_mfma_f32_16x16x32_f16 v[180:183], a[180:183], v[72:75], v[180:183]
    ds_read_b128 v[48:51], v7 offset:33280
    v_mfma_f32_16x16x32_f16 v[184:187], a[184:187], v[72:75], v[184:187]
    v_mfma_f32_16x16x32_f16 v[188:191], a[188:191], v[72:75], v[188:191]
    s_waitcnt vmcnt(19)
    s_barrier
    v_mfma_f32_16x16x32_f16 v[224:227], a[144:147], v[60:63], v[224:227]
    v_mfma_f32_16x16x32_f16 v[228:231], a[148:151], v[60:63], v[228:231]
    v_mfma_f32_16x16x32_f16 v[232:235], a[152:155], v[60:63], v[232:235]
    buffer_load_dwordx4 a[52:55], v1, s[12:15], s97 offen offset:1024
    v_mfma_f32_16x16x32_f16 v[236:239], a[156:159], v[60:63], v[236:239]
    v_mfma_f32_16x16x32_f16 v[208:211], a[160:163], v[60:63], v[208:211]
    s_waitcnt lgkmcnt(2)
    v_pk_fma_f16 v64, v40, s28, v36
    ds_read_b128 v[52:55], v6 offset:34368
    v_mfma_f32_16x16x32_f16 v[212:215], a[164:167], v[60:63], v[212:215]
    v_pk_mul_f16 v64, v64, v127
    v_pk_fma_f16 v65, v41, s28, v37
    ds_read_b128 v[56:59], v7 offset:34368
    v_mfma_f32_16x16x32_f16 v[216:219], a[168:171], v[60:63], v[216:219]
    v_pk_mul_f16 v65, v65, v127
    v_pk_fma_f16 v66, v42, s28, v38
    buffer_load_dwordx4 a[56:59], v1, s[12:15], s97 offen offset:2048
    v_mfma_f32_16x16x32_f16 v[220:223], a[172:175], v[60:63], v[220:223]
    v_pk_mul_f16 v66, v66, v127
    v_pk_fma_f16 v67, v43, s28, v39
    v_mfma_f32_16x16x32_f16 v[192:195], a[176:179], v[60:63], v[192:195]
    v_pk_mul_f16 v67, v67, v127
    ds_read_b128 v[20:23], v4 offset:0
    v_mfma_f32_16x16x32_f16 v[196:199], a[180:183], v[60:63], v[196:199]
    ds_read_b128 v[24:27], v5 offset:0
    v_mfma_f32_16x16x32_f16 v[200:203], a[184:187], v[60:63], v[200:203]
    buffer_load_dwordx4 a[60:63], v1, s[12:15], s97 offen offset:3072
    v_mfma_f32_16x16x32_f16 v[204:207], a[188:191], v[60:63], v[204:207]
    v_mfma_f32_16x16x32_f16 v[240:243], a[144:147], v[64:67], v[240:243]
    ds_read_b128 v[28:31], v4 offset:1088
    v_mfma_f32_16x16x32_f16 v[244:247], a[148:151], v[64:67], v[244:247]
    ds_read_b128 v[32:35], v5 offset:1088
    v_mfma_f32_16x16x32_f16 v[248:251], a[152:155], v[64:67], v[248:251]
    v_mfma_f32_16x16x32_f16 v[252:255], a[156:159], v[64:67], v[252:255]
    buffer_load_dwordx4 a[64:67], v2, s[12:15], s97 offen offset:0
    v_mfma_f32_16x16x32_f16 v[224:227], a[160:163], v[64:67], v[224:227]
    s_waitcnt lgkmcnt(6)
    v_pk_fma_f16 v68, v48, s28, v44
    v_mfma_f32_16x16x32_f16 v[228:231], a[164:167], v[64:67], v[228:231]
    v_pk_mul_f16 v68, v68, v127
    v_pk_fma_f16 v69, v49, s28, v45
    v_mfma_f32_16x16x32_f16 v[232:235], a[168:171], v[64:67], v[232:235]
    v_pk_mul_f16 v69, v69, v127
    v_pk_fma_f16 v70, v50, s28, v46
    v_mfma_f32_16x16x32_f16 v[236:239], a[172:175], v[64:67], v[236:239]
    v_pk_mul_f16 v70, v70, v127
    v_pk_fma_f16 v71, v51, s28, v47
    buffer_load_dwordx4 a[68:71], v2, s[12:15], s97 offen offset:1024
    v_mfma_f32_16x16x32_f16 v[208:211], a[176:179], v[64:67], v[208:211]
    v_pk_mul_f16 v71, v71, v127
    ds_read_b128 v[36:39], v4 offset:2176
    v_mfma_f32_16x16x32_f16 v[212:215], a[180:183], v[64:67], v[212:215]
    ds_read_b128 v[40:43], v5 offset:2176
    v_mfma_f32_16x16x32_f16 v[216:219], a[184:187], v[64:67], v[216:219]
    v_mfma_f32_16x16x32_f16 v[220:223], a[188:191], v[64:67], v[220:223]
    buffer_load_dwordx4 a[72:75], v2, s[12:15], s97 offen offset:2048
    v_mfma_f32_16x16x32_f16 v[240:243], a[160:163], v[68:71], v[240:243]
    s_waitcnt lgkmcnt(6)
    v_pk_fma_f16 v72, v56, s28, v52
    v_mfma_f32_16x16x32_f16 v[244:247], a[164:167], v[68:71], v[244:247]
    v_pk_mul_f16 v72, v72, v127
    v_pk_fma_f16 v73, v57, s28, v53
    v_mfma_f32_16x16x32_f16 v[248:251], a[168:171], v[68:71], v[248:251]
    v_pk_mul_f16 v73, v73, v127
    v_pk_fma_f16 v74, v58, s28, v54
    v_lshrrev_b32 v126, v19, s36
    v_perm_b32 v126, v126, v126, s31
    v_mfma_f32_16x16x32_f16 v[252:255], a[172:175], v[68:71], v[252:255]
    v_pk_mul_f16 v74, v74, v127
    v_pk_fma_f16 v75, v59, s28, v55
    v_mfma_f32_16x16x32_f16 v[224:227], a[176:179], v[68:71], v[224:227]
    v_pk_mul_f16 v75, v75, v127
    s_waitcnt lgkmcnt(4)
    v_pk_fma_f16 v60, v24, s28, v20
    v_mfma_f32_16x16x32_f16 v[228:231], a[180:183], v[68:71], v[228:231]
    v_pk_mul_f16 v60, v60, v126
    v_pk_fma_f16 v61, v25, s28, v21
    v_mfma_f32_16x16x32_f16 v[232:235], a[184:187], v[68:71], v[232:235]
    buffer_load_dwordx4 a[76:79], v2, s[12:15], s97 offen offset:3072
    v_pk_mul_f16 v61, v61, v126
    v_pk_fma_f16 v62, v26, s28, v22
    v_mfma_f32_16x16x32_f16 v[236:239], a[188:191], v[68:71], v[236:239]
    v_pk_mul_f16 v62, v62, v126
    v_pk_fma_f16 v63, v27, s28, v23
    v_mfma_f32_16x16x32_f16 v[240:243], a[176:179], v[72:75], v[240:243]
    v_pk_mul_f16 v63, v63, v126
    s_waitcnt lgkmcnt(2)
    v_pk_fma_f16 v64, v32, s28, v28
    ds_read_b128 v[44:47], v4 offset:3264
    v_mfma_f32_16x16x32_f16 v[244:247], a[180:183], v[72:75], v[244:247]
    v_pk_mul_f16 v64, v64, v126
    v_pk_fma_f16 v65, v33, s28, v29
    ds_read_b128 v[48:51], v5 offset:3264
    v_mfma_f32_16x16x32_f16 v[248:251], a[184:187], v[72:75], v[248:251]
    v_pk_mul_f16 v65, v65, v126
    v_pk_fma_f16 v66, v34, s28, v30
    v_mfma_f32_16x16x32_f16 v[252:255], a[188:191], v[72:75], v[252:255]
    s_waitcnt vmcnt(22)
    v_pk_mul_f16 v66, v66, v126
    v_pk_fma_f16 v67, v35, s28, v31
    s_mov_b64 s[32:33], s[36:37]
    s_mov_b64 s[34:35], s[38:39]
    s_mov_b64 s[36:37], s[40:41]
    s_mov_b64 s[38:39], s[42:43]
    s_mov_b64 s[40:41], s[44:45]
    s_mov_b64 s[42:43], s[46:47]
    s_sub_u32 s26, s26, 1
    s_cmp_lg_u32 s26, 0
    s_cbranch_scc1 L2_loops
    v_mfma_f32_16x16x32_f16 v[128:131], a[0:3], v[60:63], v[128:131]
    v_pk_mul_f16 v67, v67, v126
    v_mfma_f32_16x16x32_f16 v[132:135], a[4:7], v[60:63], v[132:135]
    buffer_load_dwordx4 a[80:83], v3, s[12:15], s97 offen offset:0
    v_mfma_f32_16x16x32_f16 v[136:139], a[8:11], v[60:63], v[136:139]
    v_mfma_f32_16x16x32_f16 v[140:143], a[12:15], v[60:63], v[140:143]
    buffer_load_dwordx4 a[192:195], v1, s[12:15], s27 offen offset:0
    v_mfma_f32_16x16x32_f16 v[144:147], a[0:3], v[64:67], v[144:147]
    s_waitcnt lgkmcnt(2)
    v_pk_fma_f16 v68, v40, s28, v36
    v_mfma_f32_16x16x32_f16 v[148:151], a[4:7], v[64:67], v[148:151]
    v_pk_mul_f16 v68, v68, v126
    v_pk_fma_f16 v69, v41, s28, v37
    v_mfma_f32_16x16x32_f16 v[152:155], a[8:11], v[64:67], v[152:155]
    v_pk_mul_f16 v69, v69, v126
    v_pk_fma_f16 v70, v42, s28, v38
    v_mfma_f32_16x16x32_f16 v[156:159], a[12:15], v[64:67], v[156:159]
    v_pk_mul_f16 v70, v70, v126
    v_pk_fma_f16 v71, v43, s28, v39
    s_waitcnt vmcnt(20)
    v_mfma_f32_16x16x32_f16 v[128:131], a[16:19], v[64:67], v[128:131]
    v_pk_mul_f16 v71, v71, v126
    ds_read_b128 v[52:55], v4 offset:4352
    v_mfma_f32_16x16x32_f16 v[132:135], a[20:23], v[64:67], v[132:135]
    ds_read_b128 v[56:59], v5 offset:4352
    v_mfma_f32_16x16x32_f16 v[136:139], a[24:27], v[64:67], v[136:139]
    buffer_load_dwordx4 a[84:87], v3, s[12:15], s97 offen offset:1024
    v_mfma_f32_16x16x32_f16 v[140:143], a[28:31], v[64:67], v[140:143]
    v_mfma_f32_16x16x32_f16 v[160:163], a[0:3], v[68:71], v[160:163]
    v_mfma_f32_16x16x32_f16 v[164:167], a[4:7], v[68:71], v[164:167]
    v_mfma_f32_16x16x32_f16 v[168:171], a[8:11], v[68:71], v[168:171]
    buffer_load_dwordx4 a[88:91], v3, s[12:15], s97 offen offset:2048
    v_mfma_f32_16x16x32_f16 v[172:175], a[12:15], v[68:71], v[172:175]
    v_mfma_f32_16x16x32_f16 v[144:147], a[16:19], v[68:71], v[144:147]
    s_waitcnt lgkmcnt(2)
    v_pk_fma_f16 v72, v48, s28, v44
    v_mfma_f32_16x16x32_f16 v[148:151], a[20:23], v[68:71], v[148:151]
    v_pk_mul_f16 v72, v72, v126
    v_pk_fma_f16 v73, v49, s28, v45
    buffer_load_dwordx4 v[76:79], v18, s[16:19], 0 offen offset:0 nt
    v_mfma_f32_16x16x32_f16 v[152:155], a[24:27], v[68:71], v[152:155]
    v_pk_mul_f16 v73, v73, v126
    v_pk_fma_f16 v74, v50, s28, v46
    v_mfma_f32_16x16x32_f16 v[156:159], a[28:31], v[68:71], v[156:159]
    v_pk_mul_f16 v74, v74, v126
    v_pk_fma_f16 v75, v51, s28, v47
    s_waitcnt vmcnt(19)
    v_mfma_f32_16x16x32_f16 v[128:131], a[32:35], v[68:71], v[128:131]
    v_pk_mul_f16 v75, v75, v126
    ds_read_b128 v[20:23], v4 offset:5440
    buffer_load_dwordx4 a[92:95], v3, s[12:15], s97 offen offset:3072
    v_mfma_f32_16x16x32_f16 v[132:135], a[36:39], v[68:71], v[132:135]
    ds_read_b128 v[24:27], v5 offset:5440
    s_add_u32 s97, s97, 49152
    v_mfma_f32_16x16x32_f16 v[136:139], a[40:43], v[68:71], v[136:139]
    v_mfma_f32_16x16x32_f16 v[140:143], a[44:47], v[68:71], v[140:143]
    s_add_u32 m0, s30, 49152
    v_mfma_f32_16x16x32_f16 v[176:179], a[0:3], v[72:75], v[176:179]
    buffer_load_dwordx4 v8, s[8:11], s68 offen lds
    v_mfma_f32_16x16x32_f16 v[180:183], a[4:7], v[72:75], v[180:183]
    v_mfma_f32_16x16x32_f16 v[184:187], a[8:11], v[72:75], v[184:187]
    buffer_load_dwordx4 a[196:199], v1, s[12:15], s27 offen offset:1024
    v_mfma_f32_16x16x32_f16 v[188:191], a[12:15], v[72:75], v[188:191]
    v_mfma_f32_16x16x32_f16 v[160:163], a[16:19], v[72:75], v[160:163]
    s_waitcnt lgkmcnt(2)
    v_pk_fma_f16 v60, v56, s28, v52
    v_mfma_f32_16x16x32_f16 v[164:167], a[20:23], v[72:75], v[164:167]
    v_pk_mul_f16 v60, v60, v126
    v_pk_fma_f16 v61, v57, s28, v53
    s_add_u32 m0, s30, 53248
    v_mfma_f32_16x16x32_f16 v[168:171], a[24:27], v[72:75], v[168:171]
    v_pk_mul_f16 v61, v61, v126
    v_pk_fma_f16 v62, v58, s28, v54
    buffer_load_dwordx4 v9, s[8:11], s68 offen lds
    v_mfma_f32_16x16x32_f16 v[172:175], a[28:31], v[72:75], v[172:175]
    v_pk_mul_f16 v62, v62, v126
    v_pk_fma_f16 v63, v59, s28, v55
    v_mfma_f32_16x16x32_f16 v[144:147], a[32:35], v[72:75], v[144:147]
    v_pk_mul_f16 v63, v63, v126
    ds_read_b128 v[28:31], v4 offset:6528
    v_mfma_f32_16x16x32_f16 v[148:151], a[36:39], v[72:75], v[148:151]
    ds_read_b128 v[32:35], v5 offset:6528
    s_add_u32 m0, s30, 57344
    v_mfma_f32_16x16x32_f16 v[152:155], a[40:43], v[72:75], v[152:155]
    buffer_load_dwordx4 v10, s[8:11], s68 offen lds
    v_mfma_f32_16x16x32_f16 v[156:159], a[44:47], v[72:75], v[156:159]
    v_mfma_f32_16x16x32_f16 v[192:195], a[0:3], v[60:63], v[192:195]
    v_mfma_f32_16x16x32_f16 v[196:199], a[4:7], v[60:63], v[196:199]
    s_add_u32 m0, s30, 61440
    v_mfma_f32_16x16x32_f16 v[200:203], a[8:11], v[60:63], v[200:203]
    buffer_load_dwordx4 v11, s[8:11], s68 offen lds
    v_mfma_f32_16x16x32_f16 v[204:207], a[12:15], v[60:63], v[204:207]
    v_mfma_f32_16x16x32_f16 v[176:179], a[16:19], v[60:63], v[176:179]
    s_waitcnt lgkmcnt(2)
    v_pk_fma_f16 v64, v24, s28, v20
    v_mfma_f32_16x16x32_f16 v[180:183], a[20:23], v[60:63], v[180:183]
    v_pk_mul_f16 v64, v64, v126
    v_pk_fma_f16 v65, v25, s28, v21
    v_mfma_f32_16x16x32_f16 v[184:187], a[24:27], v[60:63], v[184:187]
    v_pk_mul_f16 v65, v65, v126
    v_pk_fma_f16 v66, v26, s28, v22
    v_mfma_f32_16x16x32_f16 v[188:191], a[28:31], v[60:63], v[188:191]
    v_pk_mul_f16 v66, v66, v126
    v_pk_fma_f16 v67, v27, s28, v23
    v_mfma_f32_16x16x32_f16 v[160:163], a[32:35], v[60:63], v[160:163]
    v_pk_mul_f16 v67, v67, v126
    ds_read_b128 v[36:39], v4 offset:7616
    v_mfma_f32_16x16x32_f16 v[164:167], a[36:39], v[60:63], v[164:167]
    ds_read_b128 v[40:43], v5 offset:7616
    s_add_u32 m0, s30, 65536
    v_mfma_f32_16x16x32_f16 v[168:171], a[40:43], v[60:63], v[168:171]
    buffer_load_dwordx4 v12, s[8:11], s68 offen lds
    v_mfma_f32_16x16x32_f16 v[172:175], a[44:47], v[60:63], v[172:175]
    v_mfma_f32_16x16x32_f16 v[208:211], a[0:3], v[64:67], v[208:211]
    buffer_load_dwordx4 a[200:203], v1, s[12:15], s27 offen offset:2048
    v_mfma_f32_16x16x32_f16 v[212:215], a[4:7], v[64:67], v[212:215]
    s_add_u32 m0, s30, 69632
    v_mfma_f32_16x16x32_f16 v[216:219], a[8:11], v[64:67], v[216:219]
    buffer_load_dwordx4 v13, s[8:11], s68 offen lds
    v_mfma_f32_16x16x32_f16 v[220:223], a[12:15], v[64:67], v[220:223]
    s_add_u32 s68, s68, 2228224
    v_mfma_f32_16x16x32_f16 v[192:195], a[16:19], v[64:67], v[192:195]
    s_waitcnt lgkmcnt(2)
    v_pk_fma_f16 v68, v32, s28, v28
    v_mfma_f32_16x16x32_f16 v[196:199], a[20:23], v[64:67], v[196:199]
    v_pk_mul_f16 v68, v68, v126
    v_pk_fma_f16 v69, v33, s28, v29
    v_mfma_f32_16x16x32_f16 v[200:203], a[24:27], v[64:67], v[200:203]
    v_pk_mul_f16 v69, v69, v126
    v_pk_fma_f16 v70, v34, s28, v30
    v_mfma_f32_16x16x32_f16 v[204:207], a[28:31], v[64:67], v[204:207]
    v_pk_mul_f16 v70, v70, v126
    v_pk_fma_f16 v71, v35, s28, v31
    v_mfma_f32_16x16x32_f16 v[176:179], a[32:35], v[64:67], v[176:179]
    v_pk_mul_f16 v71, v71, v126
    ds_read_b128 v[44:47], v4 offset:8704
    buffer_load_dwordx4 a[96:99], v1, s[12:15], s98 offen offset:0
    v_mfma_f32_16x16x32_f16 v[180:183], a[36:39], v[64:67], v[180:183]
    ds_read_b128 v[48:51], v5 offset:8704
    v_mfma_f32_16x16x32_f16 v[184:187], a[40:43], v[64:67], v[184:187]
    buffer_load_dwordx4 v[80:83], v18, s[16:19], 0 offen offset:1024 nt
    v_mfma_f32_16x16x32_f16 v[188:191], a[44:47], v[64:67], v[188:191]
    s_waitcnt vmcnt(24)
    s_barrier
    v_mfma_f32_16x16x32_f16 v[224:227], a[0:3], v[68:71], v[224:227]
    v_mfma_f32_16x16x32_f16 v[228:231], a[4:7], v[68:71], v[228:231]
    v_mfma_f32_16x16x32_f16 v[232:235], a[8:11], v[68:71], v[232:235]
    buffer_load_dwordx4 a[100:103], v1, s[12:15], s98 offen offset:1024
    v_mfma_f32_16x16x32_f16 v[236:239], a[12:15], v[68:71], v[236:239]
    v_mfma_f32_16x16x32_f16 v[208:211], a[16:19], v[68:71], v[208:211]
    s_waitcnt lgkmcnt(2)
    v_pk_fma_f16 v72, v40, s28, v36
    ds_read_b128 v[52:55], v4 offset:9792
    v_mfma_f32_16x16x32_f16 v[212:215], a[20:23], v[68:71], v[212:215]
    v_pk_mul_f16 v72, v72, v126
    v_pk_fma_f16 v73, v41, s28, v37
    ds_read_b128 v[56:59], v5 offset:9792
    v_mfma_f32_16x16x32_f16 v[216:219], a[24:27], v[68:71], v[216:219]
    v_pk_mul_f16 v73, v73, v126
    v_pk_fma_f16 v74, v42, s28, v38
    buffer_load_dwordx4 a[104:107], v1, s[12:15], s98 offen offset:2048
    v_mfma_f32_16x16x32_f16 v[220:223], a[28:31], v[68:71], v[220:223]
    v_pk_mul_f16 v74, v74, v126
    v_pk_fma_f16 v75, v43, s28, v39
    v_mfma_f32_16x16x32_f16 v[192:195], a[32:35], v[68:71], v[192:195]
    v_pk_mul_f16 v75, v75, v126
    ds_read_b128 v[20:23], v4 offset:24576
    v_mfma_f32_16x16x32_f16 v[196:199], a[36:39], v[68:71], v[196:199]
    ds_read_b128 v[24:27], v5 offset:24576
    v_mfma_f32_16x16x32_f16 v[200:203], a[40:43], v[68:71], v[200:203]
    buffer_load_dwordx4 a[108:111], v1, s[12:15], s98 offen offset:3072
    v_mfma_f32_16x16x32_f16 v[204:207], a[44:47], v[68:71], v[204:207]
    buffer_load_dwordx4 a[204:207], v1, s[12:15], s27 offen offset:3072
    v_mfma_f32_16x16x32_f16 v[240:243], a[0:3], v[72:75], v[240:243]
    ds_read_b128 v[28:31], v4 offset:25664
    v_mfma_f32_16x16x32_f16 v[244:247], a[4:7], v[72:75], v[244:247]
    ds_read_b128 v[32:35], v5 offset:25664
    v_mfma_f32_16x16x32_f16 v[248:251], a[8:11], v[72:75], v[248:251]
    v_mfma_f32_16x16x32_f16 v[252:255], a[12:15], v[72:75], v[252:255]
    buffer_load_dwordx4 a[112:115], v2, s[12:15], s98 offen offset:0
    v_mfma_f32_16x16x32_f16 v[224:227], a[16:19], v[72:75], v[224:227]
    s_waitcnt lgkmcnt(6)
    v_pk_fma_f16 v60, v48, s28, v44
    v_mfma_f32_16x16x32_f16 v[228:231], a[20:23], v[72:75], v[228:231]
    v_pk_mul_f16 v60, v60, v126
    v_pk_fma_f16 v61, v49, s28, v45
    v_mfma_f32_16x16x32_f16 v[232:235], a[24:27], v[72:75], v[232:235]
    v_pk_mul_f16 v61, v61, v126
    v_pk_fma_f16 v62, v50, s28, v46
    v_mfma_f32_16x16x32_f16 v[236:239], a[28:31], v[72:75], v[236:239]
    v_pk_mul_f16 v62, v62, v126
    v_pk_fma_f16 v63, v51, s28, v47
    buffer_load_dwordx4 a[116:119], v2, s[12:15], s98 offen offset:1024
    v_mfma_f32_16x16x32_f16 v[208:211], a[32:35], v[72:75], v[208:211]
    v_pk_mul_f16 v63, v63, v126
    ds_read_b128 v[36:39], v4 offset:26752
    v_mfma_f32_16x16x32_f16 v[212:215], a[36:39], v[72:75], v[212:215]
    ds_read_b128 v[40:43], v5 offset:26752
    v_mfma_f32_16x16x32_f16 v[216:219], a[40:43], v[72:75], v[216:219]
    v_mfma_f32_16x16x32_f16 v[220:223], a[44:47], v[72:75], v[220:223]
    buffer_load_dwordx4 a[120:123], v2, s[12:15], s98 offen offset:2048
    v_mfma_f32_16x16x32_f16 v[240:243], a[16:19], v[60:63], v[240:243]
    s_waitcnt lgkmcnt(6)
    v_pk_fma_f16 v64, v56, s28, v52
    v_mfma_f32_16x16x32_f16 v[244:247], a[20:23], v[60:63], v[244:247]
    v_pk_mul_f16 v64, v64, v126
    v_pk_fma_f16 v65, v57, s28, v53
    v_mfma_f32_16x16x32_f16 v[248:251], a[24:27], v[60:63], v[248:251]
    v_pk_mul_f16 v65, v65, v126
    v_pk_fma_f16 v66, v58, s28, v54
    v_lshrrev_b32 v127, v19, s33
    v_perm_b32 v127, v127, v127, s31
    v_mfma_f32_16x16x32_f16 v[252:255], a[28:31], v[60:63], v[252:255]
    v_pk_mul_f16 v66, v66, v126
    v_pk_fma_f16 v67, v59, s28, v55
    v_mfma_f32_16x16x32_f16 v[224:227], a[32:35], v[60:63], v[224:227]
    v_pk_mul_f16 v67, v67, v126
    s_waitcnt lgkmcnt(4)
    v_pk_fma_f16 v68, v24, s28, v20
    v_mfma_f32_16x16x32_f16 v[228:231], a[36:39], v[60:63], v[228:231]
    v_pk_mul_f16 v68, v68, v127
    v_pk_fma_f16 v69, v25, s28, v21
    v_mfma_f32_16x16x32_f16 v[232:235], a[40:43], v[60:63], v[232:235]
    buffer_load_dwordx4 a[124:127], v2, s[12:15], s98 offen offset:3072
    v_pk_mul_f16 v69, v69, v127
    v_pk_fma_f16 v70, v26, s28, v22
    v_mfma_f32_16x16x32_f16 v[236:239], a[44:47], v[60:63], v[236:239]
    v_pk_mul_f16 v70, v70, v127
    v_pk_fma_f16 v71, v27, s28, v23
    v_mfma_f32_16x16x32_f16 v[240:243], a[32:35], v[64:67], v[240:243]
    v_pk_mul_f16 v71, v71, v127
    s_waitcnt lgkmcnt(2)
    v_pk_fma_f16 v72, v32, s28, v28
    ds_read_b128 v[44:47], v4 offset:27840
    v_mfma_f32_16x16x32_f16 v[244:247], a[36:39], v[64:67], v[244:247]
    v_pk_mul_f16 v72, v72, v127
    v_pk_fma_f16 v73, v33, s28, v29
    ds_read_b128 v[48:51], v5 offset:27840
    v_mfma_f32_16x16x32_f16 v[248:251], a[40:43], v[64:67], v[248:251]
    v_pk_mul_f16 v73, v73, v127
    v_pk_fma_f16 v74, v34, s28, v30
    v_mfma_f32_16x16x32_f16 v[252:255], a[44:47], v[64:67], v[252:255]
    s_waitcnt vmcnt(28)
    v_pk_mul_f16 v74, v74, v127
    v_pk_fma_f16 v75, v35, s28, v31
    v_mfma_f32_16x16x32_f16 v[128:131], a[48:51], v[68:71], v[128:131]
    v_pk_mul_f16 v75, v75, v127
    v_mfma_f32_16x16x32_f16 v[132:135], a[52:55], v[68:71], v[132:135]
    buffer_load_dwordx4 a[128:131], v3, s[12:15], s98 offen offset:0
    v_mfma_f32_16x16x32_f16 v[136:139], a[56:59], v[68:71], v[136:139]
    v_mfma_f32_16x16x32_f16 v[140:143], a[60:63], v[68:71], v[140:143]
    buffer_load_dwordx4 a[208:211], v2, s[12:15], s27 offen offset:0
    v_mfma_f32_16x16x32_f16 v[144:147], a[48:51], v[72:75], v[144:147]
    s_waitcnt lgkmcnt(2)
    v_pk_fma_f16 v60, v40, s28, v36
    v_mfma_f32_16x16x32_f16 v[148:151], a[52:55], v[72:75], v[148:151]
    v_pk_mul_f16 v60, v60, v127
    v_pk_fma_f16 v61, v41, s28, v37
    v_mfma_f32_16x16x32_f16 v[152:155], a[56:59], v[72:75], v[152:155]
    v_pk_mul_f16 v61, v61, v127
    v_pk_fma_f16 v62, v42, s28, v38
    v_mfma_f32_16x16x32_f16 v[156:159], a[60:63], v[72:75], v[156:159]
    v_pk_mul_f16 v62, v62, v127
    v_pk_fma_f16 v63, v43, s28, v39
    s_waitcnt vmcnt(26)
    v_mfma_f32_16x16x32_f16 v[128:131], a[64:67], v[72:75], v[128:131]
    v_pk_mul_f16 v63, v63, v127
    ds_read_b128 v[52:55], v4 offset:28928
    v_mfma_f32_16x16x32_f16 v[132:135], a[68:71], v[72:75], v[132:135]
    ds_read_b128 v[56:59], v5 offset:28928
    v_mfma_f32_16x16x32_f16 v[136:139], a[72:75], v[72:75], v[136:139]
    buffer_load_dwordx4 a[132:135], v3, s[12:15], s98 offen offset:1024
    v_mfma_f32_16x16x32_f16 v[140:143], a[76:79], v[72:75], v[140:143]
    v_mfma_f32_16x16x32_f16 v[160:163], a[48:51], v[60:63], v[160:163]
    v_mfma_f32_16x16x32_f16 v[164:167], a[52:55], v[60:63], v[164:167]
    v_mfma_f32_16x16x32_f16 v[168:171], a[56:59], v[60:63], v[168:171]
    buffer_load_dwordx4 a[136:139], v3, s[12:15], s98 offen offset:2048
    v_mfma_f32_16x16x32_f16 v[172:175], a[60:63], v[60:63], v[172:175]
    v_mfma_f32_16x16x32_f16 v[144:147], a[64:67], v[60:63], v[144:147]
    s_waitcnt lgkmcnt(2)
    v_pk_fma_f16 v64, v48, s28, v44
    v_mfma_f32_16x16x32_f16 v[148:151], a[68:71], v[60:63], v[148:151]
    v_pk_mul_f16 v64, v64, v127
    v_pk_fma_f16 v65, v49, s28, v45
    buffer_load_dwordx4 v[84:87], v18, s[16:19], s48 offen offset:0 nt
    v_mfma_f32_16x16x32_f16 v[152:155], a[72:75], v[60:63], v[152:155]
    v_pk_mul_f16 v65, v65, v127
    v_pk_fma_f16 v66, v50, s28, v46
    v_mfma_f32_16x16x32_f16 v[156:159], a[76:79], v[60:63], v[156:159]
    v_pk_mul_f16 v66, v66, v127
    v_pk_fma_f16 v67, v51, s28, v47
    s_waitcnt vmcnt(23)
    v_mfma_f32_16x16x32_f16 v[128:131], a[80:83], v[60:63], v[128:131]
    v_pk_mul_f16 v67, v67, v127
    ds_read_b128 v[20:23], v4 offset:30016
    buffer_load_dwordx4 a[140:143], v3, s[12:15], s98 offen offset:3072
    v_mfma_f32_16x16x32_f16 v[132:135], a[84:87], v[60:63], v[132:135]
    ds_read_b128 v[24:27], v5 offset:30016
    s_add_u32 s98, s98, 49152
    v_mfma_f32_16x16x32_f16 v[136:139], a[88:91], v[60:63], v[136:139]
    v_mfma_f32_16x16x32_f16 v[140:143], a[92:95], v[60:63], v[140:143]
    s_add_u32 m0, s30, 73728
    v_mfma_f32_16x16x32_f16 v[176:179], a[48:51], v[64:67], v[176:179]
    buffer_load_dwordx4 v8, s[8:11], s69 offen lds
    v_mfma_f32_16x16x32_f16 v[180:183], a[52:55], v[64:67], v[180:183]
    v_mfma_f32_16x16x32_f16 v[184:187], a[56:59], v[64:67], v[184:187]
    buffer_load_dwordx4 a[212:215], v2, s[12:15], s27 offen offset:1024
    v_mfma_f32_16x16x32_f16 v[188:191], a[60:63], v[64:67], v[188:191]
    v_mfma_f32_16x16x32_f16 v[160:163], a[64:67], v[64:67], v[160:163]
    s_waitcnt lgkmcnt(2)
    v_pk_fma_f16 v68, v56, s28, v52
    v_mfma_f32_16x16x32_f16 v[164:167], a[68:71], v[64:67], v[164:167]
    v_pk_mul_f16 v68, v68, v127
    v_pk_fma_f16 v69, v57, s28, v53
    s_add_u32 m0, s30, 77824
    v_mfma_f32_16x16x32_f16 v[168:171], a[72:75], v[64:67], v[168:171]
    v_pk_mul_f16 v69, v69, v127
    v_pk_fma_f16 v70, v58, s28, v54
    buffer_load_dwordx4 v9, s[8:11], s69 offen lds
    v_mfma_f32_16x16x32_f16 v[172:175], a[76:79], v[64:67], v[172:175]
    v_pk_mul_f16 v70, v70, v127
    v_pk_fma_f16 v71, v59, s28, v55
    v_mfma_f32_16x16x32_f16 v[144:147], a[80:83], v[64:67], v[144:147]
    v_pk_mul_f16 v71, v71, v127
    ds_read_b128 v[28:31], v4 offset:31104
    v_mfma_f32_16x16x32_f16 v[148:151], a[84:87], v[64:67], v[148:151]
    ds_read_b128 v[32:35], v5 offset:31104
    s_add_u32 m0, s30, 81920
    v_mfma_f32_16x16x32_f16 v[152:155], a[88:91], v[64:67], v[152:155]
    buffer_load_dwordx4 v10, s[8:11], s69 offen lds
    v_mfma_f32_16x16x32_f16 v[156:159], a[92:95], v[64:67], v[156:159]
    v_mfma_f32_16x16x32_f16 v[192:195], a[48:51], v[68:71], v[192:195]
    v_mfma_f32_16x16x32_f16 v[196:199], a[52:55], v[68:71], v[196:199]
    s_add_u32 m0, s30, 86016
    v_mfma_f32_16x16x32_f16 v[200:203], a[56:59], v[68:71], v[200:203]
    buffer_load_dwordx4 v11, s[8:11], s69 offen lds
    v_mfma_f32_16x16x32_f16 v[204:207], a[60:63], v[68:71], v[204:207]
    v_mfma_f32_16x16x32_f16 v[176:179], a[64:67], v[68:71], v[176:179]
    s_waitcnt lgkmcnt(2)
    v_pk_fma_f16 v72, v24, s28, v20
    v_mfma_f32_16x16x32_f16 v[180:183], a[68:71], v[68:71], v[180:183]
    v_pk_mul_f16 v72, v72, v127
    v_pk_fma_f16 v73, v25, s28, v21
    v_mfma_f32_16x16x32_f16 v[184:187], a[72:75], v[68:71], v[184:187]
    v_pk_mul_f16 v73, v73, v127
    v_pk_fma_f16 v74, v26, s28, v22
    v_mfma_f32_16x16x32_f16 v[188:191], a[76:79], v[68:71], v[188:191]
    v_pk_mul_f16 v74, v74, v127
    v_pk_fma_f16 v75, v27, s28, v23
    v_mfma_f32_16x16x32_f16 v[160:163], a[80:83], v[68:71], v[160:163]
    v_pk_mul_f16 v75, v75, v127
    ds_read_b128 v[36:39], v4 offset:32192
    v_mfma_f32_16x16x32_f16 v[164:167], a[84:87], v[68:71], v[164:167]
    ds_read_b128 v[40:43], v5 offset:32192
    s_add_u32 m0, s30, 90112
    v_mfma_f32_16x16x32_f16 v[168:171], a[88:91], v[68:71], v[168:171]
    buffer_load_dwordx4 v12, s[8:11], s69 offen lds
    v_mfma_f32_16x16x32_f16 v[172:175], a[92:95], v[68:71], v[172:175]
    v_mfma_f32_16x16x32_f16 v[208:211], a[48:51], v[72:75], v[208:211]
    buffer_load_dwordx4 a[216:219], v2, s[12:15], s27 offen offset:2048
    v_mfma_f32_16x16x32_f16 v[212:215], a[52:55], v[72:75], v[212:215]
    s_add_u32 m0, s30, 94208
    v_mfma_f32_16x16x32_f16 v[216:219], a[56:59], v[72:75], v[216:219]
    buffer_load_dwordx4 v13, s[8:11], s69 offen lds
    v_mfma_f32_16x16x32_f16 v[220:223], a[60:63], v[72:75], v[220:223]
    s_add_u32 s69, s69, 2228224
    v_mfma_f32_16x16x32_f16 v[192:195], a[64:67], v[72:75], v[192:195]
    s_waitcnt lgkmcnt(2)
    v_pk_fma_f16 v60, v32, s28, v28
    v_mfma_f32_16x16x32_f16 v[196:199], a[68:71], v[72:75], v[196:199]
    v_pk_mul_f16 v60, v60, v127
    v_pk_fma_f16 v61, v33, s28, v29
    v_mfma_f32_16x16x32_f16 v[200:203], a[72:75], v[72:75], v[200:203]
    v_pk_mul_f16 v61, v61, v127
    v_pk_fma_f16 v62, v34, s28, v30
    v_mfma_f32_16x16x32_f16 v[204:207], a[76:79], v[72:75], v[204:207]
    v_pk_mul_f16 v62, v62, v127
    v_pk_fma_f16 v63, v35, s28, v31
    v_mfma_f32_16x16x32_f16 v[176:179], a[80:83], v[72:75], v[176:179]
    v_pk_mul_f16 v63, v63, v127
    ds_read_b128 v[44:47], v4 offset:33280
    buffer_load_dwordx4 a[144:147], v1, s[12:15], s99 offen offset:0
    v_mfma_f32_16x16x32_f16 v[180:183], a[84:87], v[72:75], v[180:183]
    ds_read_b128 v[48:51], v5 offset:33280
    v_mfma_f32_16x16x32_f16 v[184:187], a[88:91], v[72:75], v[184:187]
    buffer_load_dwordx4 v[88:91], v18, s[16:19], s48 offen offset:1024 nt
    v_mfma_f32_16x16x32_f16 v[188:191], a[92:95], v[72:75], v[188:191]
    s_waitcnt vmcnt(26)
    s_barrier
    v_mfma_f32_16x16x32_f16 v[224:227], a[48:51], v[60:63], v[224:227]
    v_mfma_f32_16x16x32_f16 v[228:231], a[52:55], v[60:63], v[228:231]
    v_mfma_f32_16x16x32_f16 v[232:235], a[56:59], v[60:63], v[232:235]
    buffer_load_dwordx4 a[148:151], v1, s[12:15], s99 offen offset:1024
    v_mfma_f32_16x16x32_f16 v[236:239], a[60:63], v[60:63], v[236:239]
    v_mfma_f32_16x16x32_f16 v[208:211], a[64:67], v[60:63], v[208:211]
    s_waitcnt lgkmcnt(2)
    v_pk_fma_f16 v64, v40, s28, v36
    ds_read_b128 v[52:55], v4 offset:34368
    v_mfma_f32_16x16x32_f16 v[212:215], a[68:71], v[60:63], v[212:215]
    v_pk_mul_f16 v64, v64, v127
    v_pk_fma_f16 v65, v41, s28, v37
    ds_read_b128 v[56:59], v5 offset:34368
    v_mfma_f32_16x16x32_f16 v[216:219], a[72:75], v[60:63], v[216:219]
    v_pk_mul_f16 v65, v65, v127
    v_pk_fma_f16 v66, v42, s28, v38
    buffer_load_dwordx4 a[152:155], v1, s[12:15], s99 offen offset:2048
    v_mfma_f32_16x16x32_f16 v[220:223], a[76:79], v[60:63], v[220:223]
    v_pk_mul_f16 v66, v66, v127
    v_pk_fma_f16 v67, v43, s28, v39
    v_mfma_f32_16x16x32_f16 v[192:195], a[80:83], v[60:63], v[192:195]
    v_pk_mul_f16 v67, v67, v127
    ds_read_b128 v[20:23], v6 offset:0
    v_mfma_f32_16x16x32_f16 v[196:199], a[84:87], v[60:63], v[196:199]
    ds_read_b128 v[24:27], v7 offset:0
    v_mfma_f32_16x16x32_f16 v[200:203], a[88:91], v[60:63], v[200:203]
    buffer_load_dwordx4 a[156:159], v1, s[12:15], s99 offen offset:3072
    v_mfma_f32_16x16x32_f16 v[204:207], a[92:95], v[60:63], v[204:207]
    buffer_load_dwordx4 a[220:223], v2, s[12:15], s27 offen offset:3072
    s_add_u32 s27, s27, 0x10000
    v_mfma_f32_16x16x32_f16 v[240:243], a[48:51], v[64:67], v[240:243]
    ds_read_b128 v[28:31], v6 offset:1088
    v_mfma_f32_16x16x32_f16 v[244:247], a[52:55], v[64:67], v[244:247]
    ds_read_b128 v[32:35], v7 offset:1088
    v_mfma_f32_16x16x32_f16 v[248:251], a[56:59], v[64:67], v[248:251]
    v_mfma_f32_16x16x32_f16 v[252:255], a[60:63], v[64:67], v[252:255]
    buffer_load_dwordx4 a[160:163], v2, s[12:15], s99 offen offset:0
    v_mfma_f32_16x16x32_f16 v[224:227], a[64:67], v[64:67], v[224:227]
    s_waitcnt lgkmcnt(6)
    v_pk_fma_f16 v68, v48, s28, v44
    v_mfma_f32_16x16x32_f16 v[228:231], a[68:71], v[64:67], v[228:231]
    v_pk_mul_f16 v68, v68, v127
    v_pk_fma_f16 v69, v49, s28, v45
    v_mfma_f32_16x16x32_f16 v[232:235], a[72:75], v[64:67], v[232:235]
    v_pk_mul_f16 v69, v69, v127
    v_pk_fma_f16 v70, v50, s28, v46
    v_mfma_f32_16x16x32_f16 v[236:239], a[76:79], v[64:67], v[236:239]
    v_pk_mul_f16 v70, v70, v127
    v_pk_fma_f16 v71, v51, s28, v47
    buffer_load_dwordx4 a[164:167], v2, s[12:15], s99 offen offset:1024
    v_mfma_f32_16x16x32_f16 v[208:211], a[80:83], v[64:67], v[208:211]
    v_pk_mul_f16 v71, v71, v127
    ds_read_b128 v[36:39], v6 offset:2176
    v_mfma_f32_16x16x32_f16 v[212:215], a[84:87], v[64:67], v[212:215]
    ds_read_b128 v[40:43], v7 offset:2176
    v_mfma_f32_16x16x32_f16 v[216:219], a[88:91], v[64:67], v[216:219]
    v_mfma_f32_16x16x32_f16 v[220:223], a[92:95], v[64:67], v[220:223]
    buffer_load_dwordx4 a[168:171], v2, s[12:15], s99 offen offset:2048
    v_mfma_f32_16x16x32_f16 v[240:243], a[64:67], v[68:71], v[240:243]
    s_waitcnt lgkmcnt(6)
    v_pk_fma_f16 v72, v56, s28, v52
    v_mfma_f32_16x16x32_f16 v[244:247], a[68:71], v[68:71], v[244:247]
    v_pk_mul_f16 v72, v72, v127
    v_pk_fma_f16 v73, v57, s28, v53
    v_mfma_f32_16x16x32_f16 v[248:251], a[72:75], v[68:71], v[248:251]
    v_pk_mul_f16 v73, v73, v127
    v_pk_fma_f16 v74, v58, s28, v54
    v_lshrrev_b32 v126, v19, s34
    v_perm_b32 v126, v126, v126, s31
    v_mfma_f32_16x16x32_f16 v[252:255], a[76:79], v[68:71], v[252:255]
    v_pk_mul_f16 v74, v74, v127
    v_pk_fma_f16 v75, v59, s28, v55
    v_mfma_f32_16x16x32_f16 v[224:227], a[80:83], v[68:71], v[224:227]
    v_pk_mul_f16 v75, v75, v127
    s_waitcnt lgkmcnt(4)
    v_pk_fma_f16 v60, v24, s28, v20
    v_mfma_f32_16x16x32_f16 v[228:231], a[84:87], v[68:71], v[228:231]
    v_pk_mul_f16 v60, v60, v126
    v_pk_fma_f16 v61, v25, s28, v21
    v_mfma_f32_16x16x32_f16 v[232:235], a[88:91], v[68:71], v[232:235]
    buffer_load_dwordx4 a[172:175], v2, s[12:15], s99 offen offset:3072
    v_pk_mul_f16 v61, v61, v126
    v_pk_fma_f16 v62, v26, s28, v22
    v_mfma_f32_16x16x32_f16 v[236:239], a[92:95], v[68:71], v[236:239]
    v_pk_mul_f16 v62, v62, v126
    v_pk_fma_f16 v63, v27, s28, v23
    v_mfma_f32_16x16x32_f16 v[240:243], a[80:83], v[72:75], v[240:243]
    v_pk_mul_f16 v63, v63, v126
    s_waitcnt lgkmcnt(2)
    v_pk_fma_f16 v64, v32, s28, v28
    ds_read_b128 v[44:47], v6 offset:3264
    v_mfma_f32_16x16x32_f16 v[244:247], a[84:87], v[72:75], v[244:247]
    v_pk_mul_f16 v64, v64, v126
    v_pk_fma_f16 v65, v33, s28, v29
    ds_read_b128 v[48:51], v7 offset:3264
    v_mfma_f32_16x16x32_f16 v[248:251], a[88:91], v[72:75], v[248:251]
    v_pk_mul_f16 v65, v65, v126
    v_pk_fma_f16 v66, v34, s28, v30
    v_mfma_f32_16x16x32_f16 v[252:255], a[92:95], v[72:75], v[252:255]
    s_waitcnt vmcnt(29)
    v_pk_mul_f16 v66, v66, v126
    v_pk_fma_f16 v67, v35, s28, v31
    v_mfma_f32_16x16x32_f16 v[128:131], a[96:99], v[60:63], v[128:131]
    v_pk_mul_f16 v67, v67, v126
    v_mfma_f32_16x16x32_f16 v[132:135], a[100:103], v[60:63], v[132:135]
    buffer_load_dwordx4 a[176:179], v3, s[12:15], s99 offen offset:0
    v_mfma_f32_16x16x32_f16 v[136:139], a[104:107], v[60:63], v[136:139]
    v_mfma_f32_16x16x32_f16 v[140:143], a[108:111], v[60:63], v[140:143]
    buffer_load_dwordx4 a[224:227], v1, s[12:15], s27 offen offset:0
    v_mfma_f32_16x16x32_f16 v[144:147], a[96:99], v[64:67], v[144:147]
    s_waitcnt lgkmcnt(2)
    v_pk_fma_f16 v68, v40, s28, v36
    v_mfma_f32_16x16x32_f16 v[148:151], a[100:103], v[64:67], v[148:151]
    v_pk_mul_f16 v68, v68, v126
    v_pk_fma_f16 v69, v41, s28, v37
    v_mfma_f32_16x16x32_f16 v[152:155], a[104:107], v[64:67], v[152:155]
    v_pk_mul_f16 v69, v69, v126
    v_pk_fma_f16 v70, v42, s28, v38
    v_mfma_f32_16x16x32_f16 v[156:159], a[108:111], v[64:67], v[156:159]
    v_pk_mul_f16 v70, v70, v126
    v_pk_fma_f16 v71, v43, s28, v39
    s_waitcnt vmcnt(26)
    v_mfma_f32_16x16x32_f16 v[128:131], a[112:115], v[64:67], v[128:131]
    v_pk_mul_f16 v71, v71, v126
    ds_read_b128 v[52:55], v6 offset:4352
    v_mfma_f32_16x16x32_f16 v[132:135], a[116:119], v[64:67], v[132:135]
    ds_read_b128 v[56:59], v7 offset:4352
    v_mfma_f32_16x16x32_f16 v[136:139], a[120:123], v[64:67], v[136:139]
    buffer_load_dwordx4 a[180:183], v3, s[12:15], s99 offen offset:1024
    v_mfma_f32_16x16x32_f16 v[140:143], a[124:127], v[64:67], v[140:143]
    v_mfma_f32_16x16x32_f16 v[160:163], a[96:99], v[68:71], v[160:163]
    v_mfma_f32_16x16x32_f16 v[164:167], a[100:103], v[68:71], v[164:167]
    v_mfma_f32_16x16x32_f16 v[168:171], a[104:107], v[68:71], v[168:171]
    buffer_load_dwordx4 a[184:187], v3, s[12:15], s99 offen offset:2048
    v_mfma_f32_16x16x32_f16 v[172:175], a[108:111], v[68:71], v[172:175]
    v_mfma_f32_16x16x32_f16 v[144:147], a[112:115], v[68:71], v[144:147]
    s_waitcnt lgkmcnt(2)
    v_pk_fma_f16 v72, v48, s28, v44
    v_mfma_f32_16x16x32_f16 v[148:151], a[116:119], v[68:71], v[148:151]
    v_pk_mul_f16 v72, v72, v126
    v_pk_fma_f16 v73, v49, s28, v45
    buffer_load_dwordx4 v[92:95], v18, s[16:19], s49 offen offset:0 nt
    v_mfma_f32_16x16x32_f16 v[152:155], a[120:123], v[68:71], v[152:155]
    v_pk_mul_f16 v73, v73, v126
    v_pk_fma_f16 v74, v50, s28, v46
    v_mfma_f32_16x16x32_f16 v[156:159], a[124:127], v[68:71], v[156:159]
    v_pk_mul_f16 v74, v74, v126
    v_pk_fma_f16 v75, v51, s28, v47
    s_waitcnt vmcnt(23)
    v_mfma_f32_16x16x32_f16 v[128:131], a[128:131], v[68:71], v[128:131]
    v_pk_mul_f16 v75, v75, v126
    ds_read_b128 v[20:23], v6 offset:5440
    buffer_load_dwordx4 a[188:191], v3, s[12:15], s99 offen offset:3072
    v_mfma_f32_16x16x32_f16 v[132:135], a[132:135], v[68:71], v[132:135]
    ds_read_b128 v[24:27], v7 offset:5440
    s_add_u32 s99, s99, 49152
    v_mfma_f32_16x16x32_f16 v[136:139], a[136:139], v[68:71], v[136:139]
    v_mfma_f32_16x16x32_f16 v[140:143], a[140:143], v[68:71], v[140:143]
    v_mfma_f32_16x16x32_f16 v[176:179], a[96:99], v[72:75], v[176:179]
    buffer_load_dwordx4 a[0:3], v1, s[12:15], s25 offen offset:0
    v_mfma_f32_16x16x32_f16 v[180:183], a[100:103], v[72:75], v[180:183]
    v_mfma_f32_16x16x32_f16 v[184:187], a[104:107], v[72:75], v[184:187]
    buffer_load_dwordx4 a[228:231], v1, s[12:15], s27 offen offset:1024
    v_mfma_f32_16x16x32_f16 v[188:191], a[108:111], v[72:75], v[188:191]
    v_mfma_f32_16x16x32_f16 v[160:163], a[112:115], v[72:75], v[160:163]
    s_waitcnt lgkmcnt(2)
    v_pk_fma_f16 v60, v56, s28, v52
    v_mfma_f32_16x16x32_f16 v[164:167], a[116:119], v[72:75], v[164:167]
    v_pk_mul_f16 v60, v60, v126
    v_pk_fma_f16 v61, v57, s28, v53
    v_mfma_f32_16x16x32_f16 v[168:171], a[120:123], v[72:75], v[168:171]
    v_pk_mul_f16 v61, v61, v126
    v_pk_fma_f16 v62, v58, s28, v54
    buffer_load_dwordx4 a[4:7], v1, s[12:15], s25 offen offset:1024
    v_mfma_f32_16x16x32_f16 v[172:175], a[124:127], v[72:75], v[172:175]
    v_pk_mul_f16 v62, v62, v126
    v_pk_fma_f16 v63, v59, s28, v55
    v_mfma_f32_16x16x32_f16 v[144:147], a[128:131], v[72:75], v[144:147]
    v_pk_mul_f16 v63, v63, v126
    ds_read_b128 v[28:31], v6 offset:6528
    v_mfma_f32_16x16x32_f16 v[148:151], a[132:135], v[72:75], v[148:151]
    ds_read_b128 v[32:35], v7 offset:6528
    v_mfma_f32_16x16x32_f16 v[152:155], a[136:139], v[72:75], v[152:155]
    buffer_load_dwordx4 a[8:11], v1, s[12:15], s25 offen offset:2048
    v_mfma_f32_16x16x32_f16 v[156:159], a[140:143], v[72:75], v[156:159]
    v_mfma_f32_16x16x32_f16 v[192:195], a[96:99], v[60:63], v[192:195]
    v_mfma_f32_16x16x32_f16 v[196:199], a[100:103], v[60:63], v[196:199]
    v_mfma_f32_16x16x32_f16 v[200:203], a[104:107], v[60:63], v[200:203]
    buffer_load_dwordx4 a[12:15], v1, s[12:15], s25 offen offset:3072
    v_mfma_f32_16x16x32_f16 v[204:207], a[108:111], v[60:63], v[204:207]
    v_mfma_f32_16x16x32_f16 v[176:179], a[112:115], v[60:63], v[176:179]
    s_waitcnt lgkmcnt(2)
    v_pk_fma_f16 v64, v24, s28, v20
    v_mfma_f32_16x16x32_f16 v[180:183], a[116:119], v[60:63], v[180:183]
    v_pk_mul_f16 v64, v64, v126
    v_pk_fma_f16 v65, v25, s28, v21
    v_mfma_f32_16x16x32_f16 v[184:187], a[120:123], v[60:63], v[184:187]
    v_pk_mul_f16 v65, v65, v126
    v_pk_fma_f16 v66, v26, s28, v22
    v_mfma_f32_16x16x32_f16 v[188:191], a[124:127], v[60:63], v[188:191]
    v_pk_mul_f16 v66, v66, v126
    v_pk_fma_f16 v67, v27, s28, v23
    v_mfma_f32_16x16x32_f16 v[160:163], a[128:131], v[60:63], v[160:163]
    v_pk_mul_f16 v67, v67, v126
    ds_read_b128 v[36:39], v6 offset:7616
    v_mfma_f32_16x16x32_f16 v[164:167], a[132:135], v[60:63], v[164:167]
    ds_read_b128 v[40:43], v7 offset:7616
    v_mfma_f32_16x16x32_f16 v[168:171], a[136:139], v[60:63], v[168:171]
    buffer_load_dwordx4 a[16:19], v2, s[12:15], s25 offen offset:0
    v_mfma_f32_16x16x32_f16 v[172:175], a[140:143], v[60:63], v[172:175]
    v_mfma_f32_16x16x32_f16 v[208:211], a[96:99], v[64:67], v[208:211]
    v_mfma_f32_16x16x32_f16 v[212:215], a[100:103], v[64:67], v[212:215]
    v_mfma_f32_16x16x32_f16 v[216:219], a[104:107], v[64:67], v[216:219]
    buffer_load_dwordx4 a[20:23], v2, s[12:15], s25 offen offset:1024
    v_mfma_f32_16x16x32_f16 v[220:223], a[108:111], v[64:67], v[220:223]
    v_mfma_f32_16x16x32_f16 v[192:195], a[112:115], v[64:67], v[192:195]
    s_waitcnt lgkmcnt(2)
    v_pk_fma_f16 v68, v32, s28, v28
    v_mfma_f32_16x16x32_f16 v[196:199], a[116:119], v[64:67], v[196:199]
    v_pk_mul_f16 v68, v68, v126
    v_pk_fma_f16 v69, v33, s28, v29
    v_mfma_f32_16x16x32_f16 v[200:203], a[120:123], v[64:67], v[200:203]
    v_pk_mul_f16 v69, v69, v126
    v_pk_fma_f16 v70, v34, s28, v30
    v_mfma_f32_16x16x32_f16 v[204:207], a[124:127], v[64:67], v[204:207]
    v_pk_mul_f16 v70, v70, v126
    v_pk_fma_f16 v71, v35, s28, v31
    v_mfma_f32_16x16x32_f16 v[176:179], a[128:131], v[64:67], v[176:179]
    v_pk_mul_f16 v71, v71, v126
    ds_read_b128 v[44:47], v6 offset:8704
    buffer_load_dwordx4 a[24:27], v2, s[12:15], s25 offen offset:2048
    v_mfma_f32_16x16x32_f16 v[180:183], a[132:135], v[64:67], v[180:183]
    ds_read_b128 v[48:51], v7 offset:8704
    v_mfma_f32_16x16x32_f16 v[184:187], a[136:139], v[64:67], v[184:187]
    buffer_load_dwordx4 v[96:99], v18, s[16:19], s49 offen offset:1024 nt
    v_mfma_f32_16x16x32_f16 v[188:191], a[140:143], v[64:67], v[188:191]
    s_waitcnt vmcnt(25)
    s_barrier
    v_mfma_f32_16x16x32_f16 v[224:227], a[96:99], v[68:71], v[224:227]
    v_mfma_f32_16x16x32_f16 v[228:231], a[100:103], v[68:71], v[228:231]
    v_mfma_f32_16x16x32_f16 v[232:235], a[104:107], v[68:71], v[232:235]
    buffer_load_dwordx4 a[28:31], v2, s[12:15], s25 offen offset:3072
    v_mfma_f32_16x16x32_f16 v[236:239], a[108:111], v[68:71], v[236:239]
    v_mfma_f32_16x16x32_f16 v[208:211], a[112:115], v[68:71], v[208:211]
    s_waitcnt lgkmcnt(2)
    v_pk_fma_f16 v72, v40, s28, v36
    ds_read_b128 v[52:55], v6 offset:9792
    v_mfma_f32_16x16x32_f16 v[212:215], a[116:119], v[68:71], v[212:215]
    v_pk_mul_f16 v72, v72, v126
    v_pk_fma_f16 v73, v41, s28, v37
    ds_read_b128 v[56:59], v7 offset:9792
    v_mfma_f32_16x16x32_f16 v[216:219], a[120:123], v[68:71], v[216:219]
    v_pk_mul_f16 v73, v73, v126
    v_pk_fma_f16 v74, v42, s28, v38
    buffer_load_dwordx4 a[32:35], v3, s[12:15], s25 offen offset:0
    v_mfma_f32_16x16x32_f16 v[220:223], a[124:127], v[68:71], v[220:223]
    v_pk_mul_f16 v74, v74, v126
    v_pk_fma_f16 v75, v43, s28, v39
    v_mfma_f32_16x16x32_f16 v[192:195], a[128:131], v[68:71], v[192:195]
    v_pk_mul_f16 v75, v75, v126
    ds_read_b128 v[20:23], v6 offset:24576
    v_mfma_f32_16x16x32_f16 v[196:199], a[132:135], v[68:71], v[196:199]
    ds_read_b128 v[24:27], v7 offset:24576
    v_mfma_f32_16x16x32_f16 v[200:203], a[136:139], v[68:71], v[200:203]
    buffer_load_dwordx4 a[36:39], v3, s[12:15], s25 offen offset:1024
    v_mfma_f32_16x16x32_f16 v[204:207], a[140:143], v[68:71], v[204:207]
    v_mfma_f32_16x16x32_f16 v[240:243], a[96:99], v[72:75], v[240:243]
    ds_read_b128 v[28:31], v6 offset:25664
    v_mfma_f32_16x16x32_f16 v[244:247], a[100:103], v[72:75], v[244:247]
    ds_read_b128 v[32:35], v7 offset:25664
    v_mfma_f32_16x16x32_f16 v[248:251], a[104:107], v[72:75], v[248:251]
    v_mfma_f32_16x16x32_f16 v[252:255], a[108:111], v[72:75], v[252:255]
    buffer_load_dwordx4 a[40:43], v3, s[12:15], s25 offen offset:2048
    v_mfma_f32_16x16x32_f16 v[224:227], a[112:115], v[72:75], v[224:227]
    s_waitcnt lgkmcnt(6)
    v_pk_fma_f16 v60, v48, s28, v44
    v_mfma_f32_16x16x32_f16 v[228:231], a[116:119], v[72:75], v[228:231]
    v_pk_mul_f16 v60, v60, v126
    v_pk_fma_f16 v61, v49, s28, v45
    v_mfma_f32_16x16x32_f16 v[232:235], a[120:123], v[72:75], v[232:235]
    v_pk_mul_f16 v61, v61, v126
    v_pk_fma_f16 v62, v50, s28, v46
    v_mfma_f32_16x16x32_f16 v[236:239], a[124:127], v[72:75], v[236:239]
    v_pk_mul_f16 v62, v62, v126
    v_pk_fma_f16 v63, v51, s28, v47
    buffer_load_dwordx4 a[44:47], v3, s[12:15], s25 offen offset:3072
    s_add_u32 s25, s25, 12288
    v_mfma_f32_16x16x32_f16 v[208:211], a[128:131], v[72:75], v[208:211]
    v_pk_mul_f16 v63, v63, v126
    ds_read_b128 v[36:39], v6 offset:26752
    v_mfma_f32_16x16x32_f16 v[212:215], a[132:135], v[72:75], v[212:215]
    ds_read_b128 v[40:43], v7 offset:26752
    v_mfma_f32_16x16x32_f16 v[216:219], a[136:139], v[72:75], v[216:219]
    v_mfma_f32_16x16x32_f16 v[220:223], a[140:143], v[72:75], v[220:223]
    buffer_load_dwordx4 a[48:51], v1, s[12:15], s25 offen offset:0
    v_mfma_f32_16x16x32_f16 v[240:243], a[112:115], v[60:63], v[240:243]
    s_waitcnt lgkmcnt(6)
    v_pk_fma_f16 v64, v56, s28, v52
    v_mfma_f32_16x16x32_f16 v[244:247], a[116:119], v[60:63], v[244:247]
    v_pk_mul_f16 v64, v64, v126
    v_pk_fma_f16 v65, v57, s28, v53
    v_mfma_f32_16x16x32_f16 v[248:251], a[120:123], v[60:63], v[248:251]
    v_pk_mul_f16 v65, v65, v126
    v_pk_fma_f16 v66, v58, s28, v54
    v_lshrrev_b32 v127, v19, s35
    v_perm_b32 v127, v127, v127, s31
    v_mfma_f32_16x16x32_f16 v[252:255], a[124:127], v[60:63], v[252:255]
    v_pk_mul_f16 v66, v66, v126
    v_pk_fma_f16 v67, v59, s28, v55
    v_mfma_f32_16x16x32_f16 v[224:227], a[128:131], v[60:63], v[224:227]
    v_pk_mul_f16 v67, v67, v126
    s_waitcnt lgkmcnt(4)
    v_pk_fma_f16 v68, v24, s28, v20
    v_mfma_f32_16x16x32_f16 v[228:231], a[132:135], v[60:63], v[228:231]
    v_pk_mul_f16 v68, v68, v127
    v_pk_fma_f16 v69, v25, s28, v21
    v_mfma_f32_16x16x32_f16 v[232:235], a[136:139], v[60:63], v[232:235]
    buffer_load_dwordx4 a[52:55], v1, s[12:15], s25 offen offset:1024
    v_pk_mul_f16 v69, v69, v127
    v_pk_fma_f16 v70, v26, s28, v22
    v_mfma_f32_16x16x32_f16 v[236:239], a[140:143], v[60:63], v[236:239]
    v_pk_mul_f16 v70, v70, v127
    v_pk_fma_f16 v71, v27, s28, v23
    v_mfma_f32_16x16x32_f16 v[240:243], a[128:131], v[64:67], v[240:243]
    v_pk_mul_f16 v71, v71, v127
    s_waitcnt lgkmcnt(2)
    v_pk_fma_f16 v72, v32, s28, v28
    ds_read_b128 v[44:47], v6 offset:27840
    v_mfma_f32_16x16x32_f16 v[244:247], a[132:135], v[64:67], v[244:247]
    v_pk_mul_f16 v72, v72, v127
    v_pk_fma_f16 v73, v33, s28, v29
    ds_read_b128 v[48:51], v7 offset:27840
    v_mfma_f32_16x16x32_f16 v[248:251], a[136:139], v[64:67], v[248:251]
    v_pk_mul_f16 v73, v73, v127
    v_pk_fma_f16 v74, v34, s28, v30
    v_mfma_f32_16x16x32_f16 v[252:255], a[140:143], v[64:67], v[252:255]
    s_waitcnt vmcnt(27)
    v_pk_mul_f16 v74, v74, v127
    v_pk_fma_f16 v75, v35, s28, v31
    v_mfma_f32_16x16x32_f16 v[128:131], a[144:147], v[68:71], v[128:131]
    v_pk_mul_f16 v75, v75, v127
    v_mfma_f32_16x16x32_f16 v[132:135], a[148:151], v[68:71], v[132:135]
    buffer_load_dwordx4 a[56:59], v1, s[12:15], s25 offen offset:2048
    v_mfma_f32_16x16x32_f16 v[136:139], a[152:155], v[68:71], v[136:139]
    v_mfma_f32_16x16x32_f16 v[140:143], a[156:159], v[68:71], v[140:143]
    v_mfma_f32_16x16x32_f16 v[144:147], a[144:147], v[72:75], v[144:147]
    s_waitcnt lgkmcnt(2)
    v_pk_fma_f16 v60, v40, s28, v36
    buffer_load_dwordx4 a[60:63], v1, s[12:15], s25 offen offset:3072
    v_mfma_f32_16x16x32_f16 v[148:151], a[148:151], v[72:75], v[148:151]
    v_pk_mul_f16 v60, v60, v127
    v_pk_fma_f16 v61, v41, s28, v37
    v_mfma_f32_16x16x32_f16 v[152:155], a[152:155], v[72:75], v[152:155]
    v_pk_mul_f16 v61, v61, v127
    v_pk_fma_f16 v62, v42, s28, v38
    v_mfma_f32_16x16x32_f16 v[156:159], a[156:159], v[72:75], v[156:159]
    v_pk_mul_f16 v62, v62, v127
    v_pk_fma_f16 v63, v43, s28, v39
    s_waitcnt vmcnt(24)
    v_mfma_f32_16x16x32_f16 v[128:131], a[160:163], v[72:75], v[128:131]
    v_pk_mul_f16 v63, v63, v127
    ds_read_b128 v[52:55], v6 offset:28928
    buffer_load_dwordx4 a[64:67], v2, s[12:15], s25 offen offset:0
    v_mfma_f32_16x16x32_f16 v[132:135], a[164:167], v[72:75], v[132:135]
    ds_read_b128 v[56:59], v7 offset:28928
    v_mfma_f32_16x16x32_f16 v[136:139], a[168:171], v[72:75], v[136:139]
    v_mfma_f32_16x16x32_f16 v[140:143], a[172:175], v[72:75], v[140:143]
    v_mfma_f32_16x16x32_f16 v[160:163], a[144:147], v[60:63], v[160:163]
    buffer_load_dwordx4 a[68:71], v2, s[12:15], s25 offen offset:1024
    v_mfma_f32_16x16x32_f16 v[164:167], a[148:151], v[60:63], v[164:167]
    v_mfma_f32_16x16x32_f16 v[168:171], a[152:155], v[60:63], v[168:171]
    v_mfma_f32_16x16x32_f16 v[172:175], a[156:159], v[60:63], v[172:175]
    v_mfma_f32_16x16x32_f16 v[144:147], a[160:163], v[60:63], v[144:147]
    s_waitcnt lgkmcnt(2)
    v_pk_fma_f16 v64, v48, s28, v44
    buffer_load_dwordx4 a[72:75], v2, s[12:15], s25 offen offset:2048
    v_mfma_f32_16x16x32_f16 v[148:151], a[164:167], v[60:63], v[148:151]
    v_pk_mul_f16 v64, v64, v127
    v_pk_fma_f16 v65, v49, s28, v45
    buffer_load_dwordx4 v[100:103], v18, s[16:19], s50 offen offset:0 nt
    v_mfma_f32_16x16x32_f16 v[152:155], a[168:171], v[60:63], v[152:155]
    v_pk_mul_f16 v65, v65, v127
    v_pk_fma_f16 v66, v50, s28, v46
    v_mfma_f32_16x16x32_f16 v[156:159], a[172:175], v[60:63], v[156:159]
    v_pk_mul_f16 v66, v66, v127
    v_pk_fma_f16 v67, v51, s28, v47
    s_waitcnt vmcnt(22)
    v_mfma_f32_16x16x32_f16 v[128:131], a[176:179], v[60:63], v[128:131]
    v_pk_mul_f16 v67, v67, v127
    ds_read_b128 v[20:23], v6 offset:30016
    buffer_load_dwordx4 a[76:79], v2, s[12:15], s25 offen offset:3072
    v_mfma_f32_16x16x32_f16 v[132:135], a[180:183], v[60:63], v[132:135]
    ds_read_b128 v[24:27], v7 offset:30016
    v_mfma_f32_16x16x32_f16 v[136:139], a[184:187], v[60:63], v[136:139]
    v_mfma_f32_16x16x32_f16 v[140:143], a[188:191], v[60:63], v[140:143]
    v_mfma_f32_16x16x32_f16 v[176:179], a[144:147], v[64:67], v[176:179]
    buffer_load_dwordx4 a[80:83], v3, s[12:15], s25 offen offset:0
    v_mfma_f32_16x16x32_f16 v[180:183], a[148:151], v[64:67], v[180:183]
    v_mfma_f32_16x16x32_f16 v[184:187], a[152:155], v[64:67], v[184:187]
    v_mfma_f32_16x16x32_f16 v[188:191], a[156:159], v[64:67], v[188:191]
    v_mfma_f32_16x16x32_f16 v[160:163], a[160:163], v[64:67], v[160:163]
    s_waitcnt lgkmcnt(2)
    v_pk_fma_f16 v68, v56, s28, v52
    buffer_load_dwordx4 a[84:87], v3, s[12:15], s25 offen offset:1024
    v_mfma_f32_16x16x32_f16 v[164:167], a[164:167], v[64:67], v[164:167]
    v_pk_mul_f16 v68, v68, v127
    v_pk_fma_f16 v69, v57, s28, v53
    v_mfma_f32_16x16x32_f16 v[168:171], a[168:171], v[64:67], v[168:171]
    v_pk_mul_f16 v69, v69, v127
    v_pk_fma_f16 v70, v58, s28, v54
    v_mfma_f32_16x16x32_f16 v[172:175], a[172:175], v[64:67], v[172:175]
    v_pk_mul_f16 v70, v70, v127
    v_pk_fma_f16 v71, v59, s28, v55
    v_mfma_f32_16x16x32_f16 v[144:147], a[176:179], v[64:67], v[144:147]
    v_pk_mul_f16 v71, v71, v127
    ds_read_b128 v[28:31], v6 offset:31104
    buffer_load_dwordx4 a[88:91], v3, s[12:15], s25 offen offset:2048
    v_mfma_f32_16x16x32_f16 v[148:151], a[180:183], v[64:67], v[148:151]
    ds_read_b128 v[32:35], v7 offset:31104
    v_mfma_f32_16x16x32_f16 v[152:155], a[184:187], v[64:67], v[152:155]
    v_mfma_f32_16x16x32_f16 v[156:159], a[188:191], v[64:67], v[156:159]
    v_mfma_f32_16x16x32_f16 v[192:195], a[144:147], v[68:71], v[192:195]
    buffer_load_dwordx4 a[92:95], v3, s[12:15], s25 offen offset:3072
    s_add_u32 s25, s25, 12288
    v_mfma_f32_16x16x32_f16 v[196:199], a[148:151], v[68:71], v[196:199]
    v_mfma_f32_16x16x32_f16 v[200:203], a[152:155], v[68:71], v[200:203]
    v_mfma_f32_16x16x32_f16 v[204:207], a[156:159], v[68:71], v[204:207]
    v_mfma_f32_16x16x32_f16 v[176:179], a[160:163], v[68:71], v[176:179]
    s_waitcnt lgkmcnt(2)
    v_pk_fma_f16 v72, v24, s28, v20
    buffer_load_dwordx4 a[96:99], v1, s[12:15], s25 offen offset:0
    v_mul_f32 v128, s29, v128
    v_mfma_f32_16x16x32_f16 v[180:183], a[164:167], v[68:71], v[180:183]
    v_pk_mul_f16 v72, v72, v127
    v_pk_fma_f16 v73, v25, s28, v21
    v_mul_f32 v129, s29, v129
    v_mfma_f32_16x16x32_f16 v[184:187], a[168:171], v[68:71], v[184:187]
    v_pk_mul_f16 v73, v73, v127
    v_pk_fma_f16 v74, v26, s28, v22
    v_mul_f32 v130, s29, v130
    v_mfma_f32_16x16x32_f16 v[188:191], a[172:175], v[68:71], v[188:191]
    v_pk_mul_f16 v74, v74, v127
    v_pk_fma_f16 v75, v27, s28, v23
    v_mul_f32 v131, s29, v131
    v_mfma_f32_16x16x32_f16 v[160:163], a[176:179], v[68:71], v[160:163]
    v_pk_mul_f16 v75, v75, v127
    ds_read_b128 v[36:39], v6 offset:32192
    buffer_load_dwordx4 a[100:103], v1, s[12:15], s25 offen offset:1024
    v_mul_f32 v132, s29, v132
    v_mfma_f32_16x16x32_f16 v[164:167], a[180:183], v[68:71], v[164:167]
    ds_read_b128 v[40:43], v7 offset:32192
    v_mul_f32 v133, s29, v133
    v_mfma_f32_16x16x32_f16 v[168:171], a[184:187], v[68:71], v[168:171]
    v_mul_f32 v134, s29, v134
    v_mfma_f32_16x16x32_f16 v[172:175], a[188:191], v[68:71], v[172:175]
    v_mul_f32 v135, s29, v135
    v_mfma_f32_16x16x32_f16 v[208:211], a[144:147], v[72:75], v[208:211]
    buffer_load_dwordx4 a[104:107], v1, s[12:15], s25 offen offset:2048
    v_mul_f32 v136, s29, v136
    v_mfma_f32_16x16x32_f16 v[212:215], a[148:151], v[72:75], v[212:215]
    v_mul_f32 v137, s29, v137
    v_mfma_f32_16x16x32_f16 v[216:219], a[152:155], v[72:75], v[216:219]
    v_mul_f32 v138, s29, v138
    v_mfma_f32_16x16x32_f16 v[220:223], a[156:159], v[72:75], v[220:223]
    buffer_load_dwordx4 a[108:111], v1, s[12:15], s25 offen offset:3072
    v_mul_f32 v139, s29, v139
    v_mfma_f32_16x16x32_f16 v[192:195], a[160:163], v[72:75], v[192:195]
    s_waitcnt lgkmcnt(2)
    v_pk_fma_f16 v60, v32, s28, v28
    v_mul_f32 v140, s29, v140
    v_mfma_f32_16x16x32_f16 v[196:199], a[164:167], v[72:75], v[196:199]
    v_pk_mul_f16 v60, v60, v127
    v_pk_fma_f16 v61, v33, s28, v29
    v_mul_f32 v141, s29, v141
    v_mfma_f32_16x16x32_f16 v[200:203], a[168:171], v[72:75], v[200:203]
    v_pk_mul_f16 v61, v61, v127
    v_pk_fma_f16 v62, v34, s28, v30
    v_mul_f32 v142, s29, v142
    v_mfma_f32_16x16x32_f16 v[204:207], a[172:175], v[72:75], v[204:207]
    v_pk_mul_f16 v62, v62, v127
    v_pk_fma_f16 v63, v35, s28, v31
    buffer_load_dwordx4 a[112:115], v2, s[12:15], s25 offen offset:0
    v_mul_f32 v143, s29, v143
    v_mfma_f32_16x16x32_f16 v[176:179], a[176:179], v[72:75], v[176:179]
    v_pk_mul_f16 v63, v63, v127
    ds_read_b128 v[44:47], v6 offset:33280
    v_mfma_f32_16x16x32_f16 v[180:183], a[180:183], v[72:75], v[180:183]
    ds_read_b128 v[48:51], v7 offset:33280
    v_mfma_f32_16x16x32_f16 v[184:187], a[184:187], v[72:75], v[184:187]
    buffer_load_dwordx4 v[104:107], v18, s[16:19], s50 offen offset:1024 nt
    v_mfma_f32_16x16x32_f16 v[188:191], a[188:191], v[72:75], v[188:191]
    buffer_load_dwordx4 a[116:119], v2, s[12:15], s25 offen offset:1024
    v_mfma_f32_16x16x32_f16 v[224:227], a[144:147], v[60:63], v[224:227]
    v_mfma_f32_16x16x32_f16 v[228:231], a[148:151], v[60:63], v[228:231]
    v_mfma_f32_16x16x32_f16 v[232:235], a[152:155], v[60:63], v[232:235]
    v_mfma_f32_16x16x32_f16 v[236:239], a[156:159], v[60:63], v[236:239]
    buffer_load_dwordx4 a[120:123], v2, s[12:15], s25 offen offset:2048
    v_mfma_f32_16x16x32_f16 v[208:211], a[160:163], v[60:63], v[208:211]
    s_waitcnt lgkmcnt(2)
    v_pk_fma_f16 v64, v40, s28, v36
    ds_read_b128 v[52:55], v6 offset:34368
    v_mfma_f32_16x16x32_f16 v[212:215], a[164:167], v[60:63], v[212:215]
    v_pk_mul_f16 v64, v64, v127
    v_pk_fma_f16 v65, v41, s28, v37
    ds_read_b128 v[56:59], v7 offset:34368
    v_mfma_f32_16x16x32_f16 v[216:219], a[168:171], v[60:63], v[216:219]
    v_pk_mul_f16 v65, v65, v127
    v_pk_fma_f16 v66, v42, s28, v38
    v_mfma_f32_16x16x32_f16 v[220:223], a[172:175], v[60:63], v[220:223]
    v_pk_mul_f16 v66, v66, v127
    v_pk_fma_f16 v67, v43, s28, v39
    buffer_load_dwordx4 a[124:127], v2, s[12:15], s25 offen offset:3072
    v_mfma_f32_16x16x32_f16 v[192:195], a[176:179], v[60:63], v[192:195]
    v_pk_mul_f16 v67, v67, v127
    v_mfma_f32_16x16x32_f16 v[196:199], a[180:183], v[60:63], v[196:199]
    v_mfma_f32_16x16x32_f16 v[200:203], a[184:187], v[60:63], v[200:203]
    v_mfma_f32_16x16x32_f16 v[204:207], a[188:191], v[60:63], v[204:207]
    buffer_load_dwordx4 a[232:235], v1, s[12:15], s27 offen offset:2048
    v_mfma_f32_16x16x32_f16 v[240:243], a[144:147], v[64:67], v[240:243]
    v_mfma_f32_16x16x32_f16 v[244:247], a[148:151], v[64:67], v[244:247]
    v_mfma_f32_16x16x32_f16 v[248:251], a[152:155], v[64:67], v[248:251]
    v_mfma_f32_16x16x32_f16 v[252:255], a[156:159], v[64:67], v[252:255]
    buffer_load_dwordx4 a[236:239], v1, s[12:15], s27 offen offset:3072
    v_mfma_f32_16x16x32_f16 v[224:227], a[160:163], v[64:67], v[224:227]
    s_waitcnt lgkmcnt(2)
    v_pk_fma_f16 v68, v48, s28, v44
    v_mfma_f32_16x16x32_f16 v[228:231], a[164:167], v[64:67], v[228:231]
    v_pk_mul_f16 v68, v68, v127
    v_pk_fma_f16 v69, v49, s28, v45
    v_mfma_f32_16x16x32_f16 v[232:235], a[168:171], v[64:67], v[232:235]
    v_pk_mul_f16 v69, v69, v127
    v_pk_fma_f16 v70, v50, s28, v46
    v_mfma_f32_16x16x32_f16 v[236:239], a[172:175], v[64:67], v[236:239]
    v_pk_mul_f16 v70, v70, v127
    v_pk_fma_f16 v71, v51, s28, v47
    buffer_load_dwordx4 a[240:243], v2, s[12:15], s27 offen offset:0
    v_mfma_f32_16x16x32_f16 v[208:211], a[176:179], v[64:67], v[208:211]
    v_pk_mul_f16 v71, v71, v127
    v_mfma_f32_16x16x32_f16 v[212:215], a[180:183], v[64:67], v[212:215]
    v_mfma_f32_16x16x32_f16 v[216:219], a[184:187], v[64:67], v[216:219]
    v_mfma_f32_16x16x32_f16 v[220:223], a[188:191], v[64:67], v[220:223]
    buffer_load_dwordx4 a[244:247], v2, s[12:15], s27 offen offset:1024
    v_mfma_f32_16x16x32_f16 v[240:243], a[160:163], v[68:71], v[240:243]
    s_waitcnt lgkmcnt(0)
    v_pk_fma_f16 v72, v56, s28, v52
    v_mfma_f32_16x16x32_f16 v[244:247], a[164:167], v[68:71], v[244:247]
    v_pk_mul_f16 v72, v72, v127
    v_pk_fma_f16 v73, v57, s28, v53
    v_mfma_f32_16x16x32_f16 v[248:251], a[168:171], v[68:71], v[248:251]
    v_pk_mul_f16 v73, v73, v127
    v_pk_fma_f16 v74, v58, s28, v54
    v_mfma_f32_16x16x32_f16 v[252:255], a[172:175], v[68:71], v[252:255]
    v_pk_mul_f16 v74, v74, v127
    v_pk_fma_f16 v75, v59, s28, v55
    buffer_load_dwordx4 a[248:251], v2, s[12:15], s27 offen offset:2048
    v_mfma_f32_16x16x32_f16 v[224:227], a[176:179], v[68:71], v[224:227]
    v_pk_mul_f16 v75, v75, v127
    v_mfma_f32_16x16x32_f16 v[228:231], a[180:183], v[68:71], v[228:231]
    v_mfma_f32_16x16x32_f16 v[232:235], a[184:187], v[68:71], v[232:235]
    v_mfma_f32_16x16x32_f16 v[236:239], a[188:191], v[68:71], v[236:239]
    buffer_load_dwordx4 a[252:255], v2, s[12:15], s27 offen offset:3072
    s_add_u32 s27, s27, 0x10000
    v_mfma_f32_16x16x32_f16 v[240:243], a[176:179], v[72:75], v[240:243]
    v_mfma_f32_16x16x32_f16 v[244:247], a[180:183], v[72:75], v[244:247]
    v_mfma_f32_16x16x32_f16 v[248:251], a[184:187], v[72:75], v[248:251]
    v_mfma_f32_16x16x32_f16 v[252:255], a[188:191], v[72:75], v[252:255]
    s_waitcnt vmcnt(6)
    v_mfma_f32_16x16x32_bf16 v[128:131], a[0:3], a[192:195], v[128:131]
    v_mfma_f32_16x16x32_bf16 v[132:135], a[4:7], a[192:195], v[132:135]
    buffer_load_dwordx4 v[20:23], v1, s[12:15], s27 offen offset:0
    v_mfma_f32_16x16x32_bf16 v[136:139], a[8:11], a[192:195], v[136:139]
    v_mul_f32 v144, s29, v144
    v_mul_f32 v145, s29, v145
    v_mfma_f32_16x16x32_bf16 v[140:143], a[12:15], a[192:195], v[140:143]
    v_mul_f32 v146, s29, v146
    v_mfma_f32_16x16x32_bf16 v[128:131], a[16:19], a[196:199], v[128:131]
    v_mul_f32 v147, s29, v147
    v_mfma_f32_16x16x32_bf16 v[132:135], a[20:23], a[196:199], v[132:135]
    v_mul_f32 v148, s29, v148
    v_mul_f32 v149, s29, v149
    v_mfma_f32_16x16x32_bf16 v[136:139], a[24:27], a[196:199], v[136:139]
    v_mul_f32 v150, s29, v150
    buffer_load_dwordx4 v[24:27], v1, s[12:15], s27 offen offset:1024
    v_mfma_f32_16x16x32_bf16 v[140:143], a[28:31], a[196:199], v[140:143]
    v_mul_f32 v151, s29, v151
    v_mfma_f32_16x16x32_bf16 v[128:131], a[32:35], a[200:203], v[128:131]
    v_mfma_f32_16x16x32_bf16 v[132:135], a[36:39], a[200:203], v[132:135]
    v_mul_f32 v152, s29, v152
    v_mul_f32 v153, s29, v153
    v_mfma_f32_16x16x32_bf16 v[136:139], a[40:43], a[200:203], v[136:139]
    v_mul_f32 v154, s29, v154
    v_mfma_f32_16x16x32_bf16 v[140:143], a[44:47], a[200:203], v[140:143]
    v_mul_f32 v155, s29, v155
    buffer_load_dwordx4 v[28:31], v1, s[12:15], s27 offen offset:2048
    v_mfma_f32_16x16x32_bf16 v[128:131], a[48:51], a[204:207], v[128:131]
    v_mul_f32 v156, s29, v156
    v_mul_f32 v157, s29, v157
    v_mfma_f32_16x16x32_bf16 v[132:135], a[52:55], a[204:207], v[132:135]
    v_mul_f32 v158, s29, v158
    v_mfma_f32_16x16x32_bf16 v[136:139], a[56:59], a[204:207], v[136:139]
    v_mfma_f32_16x16x32_bf16 v[140:143], a[60:63], a[204:207], v[140:143]
    v_mul_f32 v159, s29, v159
    v_mfma_f32_16x16x32_bf16 v[128:131], a[64:67], a[208:211], v[128:131]
    v_mul_f32 v160, s29, v160
    v_mul_f32 v161, s29, v161
    buffer_load_dwordx4 v[32:35], v1, s[12:15], s27 offen offset:3072
    v_mfma_f32_16x16x32_bf16 v[132:135], a[68:71], a[208:211], v[132:135]
    v_mul_f32 v162, s29, v162
    v_mfma_f32_16x16x32_bf16 v[136:139], a[72:75], a[208:211], v[136:139]
    v_mul_f32 v163, s29, v163
    v_mfma_f32_16x16x32_bf16 v[140:143], a[76:79], a[208:211], v[140:143]
    v_mul_f32 v164, s29, v164
    v_mul_f32 v165, s29, v165
    v_mfma_f32_16x16x32_bf16 v[128:131], a[80:83], a[212:215], v[128:131]
    s_barrier
    v_mfma_f32_16x16x32_bf16 v[132:135], a[84:87], a[212:215], v[132:135]
    v_mul_f32 v166, s29, v166
    buffer_load_dwordx4 v[36:39], v2, s[12:15], s27 offen offset:0
    v_mfma_f32_16x16x32_bf16 v[136:139], a[88:91], a[212:215], v[136:139]
    v_mul_f32 v167, s29, v167
    v_mfma_f32_16x16x32_bf16 v[140:143], a[92:95], a[212:215], v[140:143]
    v_mul_f32 v168, s29, v168
    v_mul_f32 v169, s29, v169
    v_mfma_f32_16x16x32_bf16 v[128:131], a[96:99], a[216:219], v[128:131]
    v_mul_f32 v170, s29, v170
    v_mfma_f32_16x16x32_bf16 v[132:135], a[100:103], a[216:219], v[132:135]
    v_mul_f32 v171, s29, v171
    v_mfma_f32_16x16x32_bf16 v[136:139], a[104:107], a[216:219], v[136:139]
    buffer_load_dwordx4 v[40:43], v2, s[12:15], s27 offen offset:1024
    v_mfma_f32_16x16x32_bf16 v[140:143], a[108:111], a[216:219], v[140:143]
    v_mul_f32 v172, s29, v172
    v_mul_f32 v173, s29, v173
    v_mfma_f32_16x16x32_bf16 v[128:131], a[112:115], a[220:223], v[128:131]
    v_mul_f32 v174, s29, v174
    v_mfma_f32_16x16x32_bf16 v[132:135], a[116:119], a[220:223], v[132:135]
    v_mul_f32 v175, s29, v175
    v_mfma_f32_16x16x32_bf16 v[136:139], a[120:123], a[220:223], v[136:139]
    v_mfma_f32_16x16x32_bf16 v[140:143], a[124:127], a[220:223], v[140:143]
    buffer_load_dwordx4 v[44:47], v2, s[12:15], s27 offen offset:2048
    s_waitcnt vmcnt(11)
    v_mfma_f32_16x16x32_bf16 v[144:147], a[0:3], a[224:227], v[144:147]
    v_mfma_f32_16x16x32_bf16 v[148:151], a[4:7], a[224:227], v[148:151]
    v_mfma_f32_16x16x32_bf16 v[152:155], a[8:11], a[224:227], v[152:155]
    v_mul_f32 v176, s29, v176
    v_mul_f32 v177, s29, v177
    v_mfma_f32_16x16x32_bf16 v[156:159], a[12:15], a[224:227], v[156:159]
    v_mul_f32 v178, s29, v178
    v_mfma_f32_16x16x32_bf16 v[144:147], a[16:19], a[228:231], v[144:147]
    v_mul_f32 v179, s29, v179
    buffer_load_dwordx4 v[48:51], v2, s[12:15], s27 offen offset:3072
    s_add_u32 s27, s27, 0x10000
    v_mfma_f32_16x16x32_bf16 v[148:151], a[20:23], a[228:231], v[148:151]
    v_mul_f32 v180, s29, v180
    v_mul_f32 v181, s29, v181
    v_mfma_f32_16x16x32_bf16 v[152:155], a[24:27], a[228:231], v[152:155]
    v_mul_f32 v182, s29, v182
    v_mfma_f32_16x16x32_bf16 v[156:159], a[28:31], a[228:231], v[156:159]
    v_mul_f32 v183, s29, v183
    v_mfma_f32_16x16x32_bf16 v[144:147], a[32:35], a[232:235], v[144:147]
    ds_write_b128 v14, v[128:131] offset:0
    v_mfma_f32_16x16x32_bf16 v[148:151], a[36:39], a[232:235], v[148:151]
    v_mul_f32 v184, s29, v184
    v_mul_f32 v185, s29, v185
    buffer_load_dwordx4 v[52:55], v1, s[12:15], s27 offen offset:0
    v_mfma_f32_16x16x32_bf16 v[152:155], a[40:43], a[232:235], v[152:155]
    v_mul_f32 v186, s29, v186
    v_mfma_f32_16x16x32_bf16 v[156:159], a[44:47], a[232:235], v[156:159]
    v_mul_f32 v187, s29, v187
    v_mfma_f32_16x16x32_bf16 v[144:147], a[48:51], a[236:239], v[144:147]
    v_mul_f32 v188, s29, v188
    v_mul_f32 v189, s29, v189
    v_mfma_f32_16x16x32_bf16 v[148:151], a[52:55], a[236:239], v[148:151]
    v_mul_f32 v190, s29, v190
    v_mfma_f32_16x16x32_bf16 v[152:155], a[56:59], a[236:239], v[152:155]
    ds_write_b128 v14, v[132:135] offset:1024
    buffer_load_dwordx4 v[56:59], v1, s[12:15], s27 offen offset:1024
    v_mfma_f32_16x16x32_bf16 v[156:159], a[60:63], a[236:239], v[156:159]
    v_mul_f32 v191, s29, v191
    s_waitcnt vmcnt(10)
    v_mfma_f32_16x16x32_bf16 v[144:147], a[64:67], a[240:243], v[144:147]
    v_mul_f32 v192, s29, v192
    v_mul_f32 v193, s29, v193
    v_mfma_f32_16x16x32_bf16 v[148:151], a[68:71], a[240:243], v[148:151]
    v_mul_f32 v194, s29, v194
    v_mfma_f32_16x16x32_bf16 v[152:155], a[72:75], a[240:243], v[152:155]
    v_mul_f32 v195, s29, v195
    v_mfma_f32_16x16x32_bf16 v[156:159], a[76:79], a[240:243], v[156:159]
    v_mul_f32 v196, s29, v196
    v_mul_f32 v197, s29, v197
    buffer_load_dwordx4 v[108:111], v1, s[12:15], s27 offen offset:2048
    v_mfma_f32_16x16x32_bf16 v[144:147], a[80:83], a[244:247], v[144:147]
    ds_write_b128 v15, v[136:139] offset:0
    v_mfma_f32_16x16x32_bf16 v[148:151], a[84:87], a[244:247], v[148:151]
    v_mul_f32 v198, s29, v198
    v_mfma_f32_16x16x32_bf16 v[152:155], a[88:91], a[244:247], v[152:155]
    v_mul_f32 v199, s29, v199
    v_mfma_f32_16x16x32_bf16 v[156:159], a[92:95], a[244:247], v[156:159]
    v_mul_f32 v200, s29, v200
    v_mul_f32 v201, s29, v201
    v_mfma_f32_16x16x32_bf16 v[144:147], a[96:99], a[248:251], v[144:147]
    v_mul_f32 v202, s29, v202
    buffer_load_dwordx4 v[112:115], v1, s[12:15], s27 offen offset:3072
    v_mfma_f32_16x16x32_bf16 v[148:151], a[100:103], a[248:251], v[148:151]
    v_mul_f32 v203, s29, v203
    v_mfma_f32_16x16x32_bf16 v[152:155], a[104:107], a[248:251], v[152:155]
    ds_write_b128 v15, v[140:143] offset:1024
    v_mfma_f32_16x16x32_bf16 v[156:159], a[108:111], a[248:251], v[156:159]
    v_mul_f32 v204, s29, v204
    v_mul_f32 v205, s29, v205
    v_mfma_f32_16x16x32_bf16 v[144:147], a[112:115], a[252:255], v[144:147]
    v_mul_f32 v206, s29, v206
    v_mfma_f32_16x16x32_bf16 v[148:151], a[116:119], a[252:255], v[148:151]
    v_mul_f32 v207, s29, v207
    buffer_load_dwordx4 v[116:119], v2, s[12:15], s27 offen offset:0
    v_mfma_f32_16x16x32_bf16 v[152:155], a[120:123], a[252:255], v[152:155]
    v_mfma_f32_16x16x32_bf16 v[156:159], a[124:127], a[252:255], v[156:159]
    s_waitcnt vmcnt(9)
    v_mfma_f32_16x16x32_bf16 v[160:163], a[0:3], v[20:23], v[160:163]
    v_mfma_f32_16x16x32_bf16 v[164:167], a[4:7], v[20:23], v[164:167]
    v_mfma_f32_16x16x32_bf16 v[168:171], a[8:11], v[20:23], v[168:171]
    v_mul_f32 v208, s29, v208
    v_mul_f32 v209, s29, v209
    buffer_load_dwordx4 v[120:123], v2, s[12:15], s27 offen offset:1024
    v_mfma_f32_16x16x32_bf16 v[172:175], a[12:15], v[20:23], v[172:175]
    v_mul_f32 v210, s29, v210
    v_mfma_f32_16x16x32_bf16 v[160:163], a[16:19], v[24:27], v[160:163]
    v_mul_f32 v211, s29, v211
    v_mfma_f32_16x16x32_bf16 v[164:167], a[20:23], v[24:27], v[164:167]
    v_mul_f32 v212, s29, v212
    v_mul_f32 v213, s29, v213
    v_mfma_f32_16x16x32_bf16 v[168:171], a[24:27], v[24:27], v[168:171]
    v_mul_f32 v214, s29, v214
    v_mfma_f32_16x16x32_bf16 v[172:175], a[28:31], v[24:27], v[172:175]
    v_mul_f32 v215, s29, v215
    buffer_load_dwordx4 a[128:131], v2, s[12:15], s27 offen offset:2048
    v_mfma_f32_16x16x32_bf16 v[160:163], a[32:35], v[28:31], v[160:163]
    ds_write_b128 v14, v[144:147] offset:16384
    v_mfma_f32_16x16x32_bf16 v[164:167], a[36:39], v[28:31], v[164:167]
    v_mul_f32 v216, s29, v216
    v_mul_f32 v217, s29, v217
    v_mfma_f32_16x16x32_bf16 v[168:171], a[40:43], v[28:31], v[168:171]
    v_mul_f32 v218, s29, v218
    v_mfma_f32_16x16x32_bf16 v[172:175], a[44:47], v[28:31], v[172:175]
    v_mul_f32 v219, s29, v219
    v_mfma_f32_16x16x32_bf16 v[160:163], a[48:51], v[32:35], v[160:163]
    v_mul_f32 v220, s29, v220
    v_mul_f32 v221, s29, v221
    buffer_load_dwordx4 a[132:135], v2, s[12:15], s27 offen offset:3072
    s_add_u32 s27, s27, 0x10000
    v_mfma_f32_16x16x32_bf16 v[164:167], a[52:55], v[32:35], v[164:167]
    v_mul_f32 v222, s29, v222
    v_mfma_f32_16x16x32_bf16 v[168:171], a[56:59], v[32:35], v[168:171]
    ds_write_b128 v14, v[148:151] offset:17408
    v_mfma_f32_16x16x32_bf16 v[172:175], a[60:63], v[32:35], v[172:175]
    v_mul_f32 v223, s29, v223
    s_waitcnt vmcnt(8)
    v_mfma_f32_16x16x32_bf16 v[160:163], a[64:67], v[36:39], v[160:163]
    v_mul_f32 v224, s29, v224
    v_mul_f32 v225, s29, v225
    v_mfma_f32_16x16x32_bf16 v[164:167], a[68:71], v[36:39], v[164:167]
    v_mul_f32 v226, s29, v226
    buffer_load_dwordx4 a[136:139], v1, s[12:15], s27 offen offset:0
    v_mfma_f32_16x16x32_bf16 v[168:171], a[72:75], v[36:39], v[168:171]
    v_mul_f32 v227, s29, v227
    v_mfma_f32_16x16x32_bf16 v[172:175], a[76:79], v[36:39], v[172:175]
    v_mul_f32 v228, s29, v228
    v_mul_f32 v229, s29, v229
    v_mfma_f32_16x16x32_bf16 v[160:163], a[80:83], v[40:43], v[160:163]
    ds_write_b128 v15, v[152:155] offset:16384
    v_mfma_f32_16x16x32_bf16 v[164:167], a[84:87], v[40:43], v[164:167]
    v_mul_f32 v230, s29, v230
    v_mfma_f32_16x16x32_bf16 v[168:171], a[88:91], v[40:43], v[168:171]
    v_mul_f32 v231, s29, v231
    buffer_load_dwordx4 a[140:143], v1, s[12:15], s27 offen offset:1024
    v_mfma_f32_16x16x32_bf16 v[172:175], a[92:95], v[40:43], v[172:175]
    v_mul_f32 v232, s29, v232
    v_mul_f32 v233, s29, v233
    v_mfma_f32_16x16x32_bf16 v[160:163], a[96:99], v[44:47], v[160:163]
    v_mul_f32 v234, s29, v234
    v_mfma_f32_16x16x32_bf16 v[164:167], a[100:103], v[44:47], v[164:167]
    v_mul_f32 v235, s29, v235
    v_mfma_f32_16x16x32_bf16 v[168:171], a[104:107], v[44:47], v[168:171]
    ds_write_b128 v15, v[156:159] offset:17408
    v_mfma_f32_16x16x32_bf16 v[172:175], a[108:111], v[44:47], v[172:175]
    v_mul_f32 v236, s29, v236
    v_mul_f32 v237, s29, v237
    buffer_load_dwordx4 a[144:147], v1, s[12:15], s27 offen offset:2048
    v_mfma_f32_16x16x32_bf16 v[160:163], a[112:115], v[48:51], v[160:163]
    v_mul_f32 v238, s29, v238
    v_mfma_f32_16x16x32_bf16 v[164:167], a[116:119], v[48:51], v[164:167]
    v_mul_f32 v239, s29, v239
    v_mfma_f32_16x16x32_bf16 v[168:171], a[120:123], v[48:51], v[168:171]
    v_mfma_f32_16x16x32_bf16 v[172:175], a[124:127], v[48:51], v[172:175]
    s_waitcnt lgkmcnt(0)
    s_barrier
    s_waitcnt vmcnt(7)
    v_mfma_f32_16x16x32_bf16 v[176:179], a[0:3], v[52:55], v[176:179]
    buffer_load_dwordx4 a[148:151], v1, s[12:15], s27 offen offset:3072
    ds_read_b128 v[128:131], v16 offset:0
    ds_read_b128 v[136:139], v16 offset:4096
    v_mfma_f32_16x16x32_bf16 v[180:183], a[4:7], v[52:55], v[180:183]
    ds_read_b128 v[144:147], v16 offset:8192
    ds_read_b128 v[152:155], v16 offset:12288
    v_mfma_f32_16x16x32_bf16 v[184:187], a[8:11], v[52:55], v[184:187]
    v_mul_f32 v240, s29, v240
    ds_read_b128 v[132:135], v16 offset:1024
    ds_read_b128 v[140:143], v16 offset:5120
    v_mfma_f32_16x16x32_bf16 v[188:191], a[12:15], v[52:55], v[188:191]
    v_mul_f32 v241, s29, v241
    ds_read_b128 v[148:151], v16 offset:9216
    ds_read_b128 v[156:159], v16 offset:13312
    v_mfma_f32_16x16x32_bf16 v[176:179], a[16:19], v[56:59], v[176:179]
    v_mfma_f32_16x16x32_bf16 v[180:183], a[20:23], v[56:59], v[180:183]
    v_mul_f32 v242, s29, v242
    buffer_load_dwordx4 a[152:155], v2, s[12:15], s27 offen offset:0
    v_mfma_f32_16x16x32_bf16 v[184:187], a[24:27], v[56:59], v[184:187]
    v_mul_f32 v243, s29, v243
    v_mfma_f32_16x16x32_bf16 v[188:191], a[28:31], v[56:59], v[188:191]
    v_mfma_f32_16x16x32_bf16 v[176:179], a[32:35], v[108:111], v[176:179]
    ds_write_b128 v14, v[160:163] offset:32768
    v_mfma_f32_16x16x32_bf16 v[180:183], a[36:39], v[108:111], v[180:183]
    v_mul_f32 v244, s29, v244
    v_mfma_f32_16x16x32_bf16 v[184:187], a[40:43], v[108:111], v[184:187]
    v_mul_f32 v245, s29, v245
    buffer_load_dwordx4 a[156:159], v2, s[12:15], s27 offen offset:1024
    s_waitcnt lgkmcnt(5)
    v_fmac_f32 v128, 0.5, v136
    v_mfma_f32_16x16x32_bf16 v[188:191], a[44:47], v[108:111], v[188:191]
    v_fma_f32 v152, v136, 0.5, -v152
    v_fmac_f32 v128, 0.5, v144
    v_mfma_f32_16x16x32_bf16 v[176:179], a[48:51], v[112:115], v[176:179]
    v_mul_f32 v246, s29, v246
    v_fmac_f32 v152, -0.5, v144
    v_fmac_f32 v129, 0.5, v137
    v_mfma_f32_16x16x32_bf16 v[180:183], a[52:55], v[112:115], v[180:183]
    v_mul_f32 v247, s29, v247
    v_fma_f32 v153, v137, 0.5, -v153
    v_fmac_f32 v129, 0.5, v145
    v_mfma_f32_16x16x32_bf16 v[184:187], a[56:59], v[112:115], v[184:187]
    ds_write_b128 v14, v[164:167] offset:33792
    v_mfma_f32_16x16x32_bf16 v[188:191], a[60:63], v[112:115], v[188:191]
    buffer_load_dwordx4 a[160:163], v2, s[12:15], s27 offen offset:2048
    v_fmac_f32 v153, -0.5, v145
    v_fmac_f32 v130, 0.5, v138
    s_waitcnt vmcnt(7)
    v_mfma_f32_16x16x32_bf16 v[176:179], a[64:67], v[116:119], v[176:179]
    v_mul_f32 v248, s29, v248
    v_fma_f32 v154, v138, 0.5, -v154
    v_mfma_f32_16x16x32_bf16 v[180:183], a[68:71], v[116:119], v[180:183]
    v_mul_f32 v249, s29, v249
    v_fmac_f32 v130, 0.5, v146
    v_fmac_f32 v154, -0.5, v146
    v_mfma_f32_16x16x32_bf16 v[184:187], a[72:75], v[116:119], v[184:187]
    v_fmac_f32 v131, 0.5, v139
    v_fma_f32 v155, v139, 0.5, -v155
    v_mfma_f32_16x16x32_bf16 v[188:191], a[76:79], v[116:119], v[188:191]
    v_mul_f32 v250, s29, v250
    v_fmac_f32 v131, 0.5, v147
    v_fmac_f32 v155, -0.5, v147
    v_mfma_f32_16x16x32_bf16 v[176:179], a[80:83], v[120:123], v[176:179]
    ds_write_b128 v15, v[168:171] offset:32768
    buffer_load_dwordx4 a[164:167], v2, s[12:15], s27 offen offset:3072
    s_add_u32 s27, s27, 0x10000
    v_mfma_f32_16x16x32_bf16 v[180:183], a[84:87], v[120:123], v[180:183]
    v_mul_f32 v251, s29, v251
    s_waitcnt lgkmcnt(3)
    v_fmac_f32 v132, 0.5, v140
    v_mfma_f32_16x16x32_bf16 v[184:187], a[88:91], v[120:123], v[184:187]
    v_fma_f32 v156, v140, 0.5, -v156
    v_fmac_f32 v132, 0.5, v148
    v_mfma_f32_16x16x32_bf16 v[188:191], a[92:95], v[120:123], v[188:191]
    v_mul_f32 v252, s29, v252
    v_fmac_f32 v156, -0.5, v148
    v_mfma_f32_16x16x32_bf16 v[176:179], a[96:99], a[128:131], v[176:179]
    v_mul_f32 v253, s29, v253
    v_fmac_f32 v133, 0.5, v141
    v_fma_f32 v157, v141, 0.5, -v157
    v_mfma_f32_16x16x32_bf16 v[180:183], a[100:103], a[128:131], v[180:183]
    buffer_load_dwordx4 a[168:171], v1, s[12:15], s27 offen offset:0
    v_fmac_f32 v133, 0.5, v149
    v_fmac_f32 v157, -0.5, v149
    v_mfma_f32_16x16x32_bf16 v[184:187], a[104:107], a[128:131], v[184:187]
    ds_write_b128 v15, v[172:175] offset:33792
    v_mfma_f32_16x16x32_bf16 v[188:191], a[108:111], a[128:131], v[188:191]
    v_mul_f32 v254, s29, v254
    v_fmac_f32 v134, 0.5, v142
    v_fma_f32 v158, v142, 0.5, -v158
    v_mfma_f32_16x16x32_bf16 v[176:179], a[112:115], a[132:135], v[176:179]
    v_mul_f32 v255, s29, v255
    v_fmac_f32 v134, 0.5, v150
    v_fmac_f32 v158, -0.5, v150
    v_mfma_f32_16x16x32_bf16 v[180:183], a[116:119], a[132:135], v[180:183]
    v_fmac_f32 v135, 0.5, v143
    v_fma_f32 v159, v143, 0.5, -v159
    v_mfma_f32_16x16x32_bf16 v[184:187], a[120:123], a[132:135], v[184:187]
    buffer_load_dwordx4 a[172:175], v1, s[12:15], s27 offen offset:1024
    v_fmac_f32 v135, 0.5, v151
    v_mfma_f32_16x16x32_bf16 v[188:191], a[124:127], a[132:135], v[188:191]
    v_fmac_f32 v159, -0.5, v151
    s_waitcnt vmcnt(6)
    v_mfma_f32_16x16x32_bf16 v[192:195], a[0:3], a[136:139], v[192:195]
    v_lshlrev_b32 v60, 16, v76
    v_and_b32 v61, 0xffff0000, v76
    v_mfma_f32_16x16x32_bf16 v[196:199], a[4:7], a[136:139], v[196:199]
    v_add_f32 v128, v128, v60
    v_add_f32 v129, v129, v61
    v_mfma_f32_16x16x32_bf16 v[200:203], a[8:11], a[136:139], v[200:203]
    v_cvt_pk_bf16_f32 v76, v128, v129
    v_lshlrev_b32 v62, 16, v77
    v_mfma_f32_16x16x32_bf16 v[204:207], a[12:15], a[136:139], v[204:207]
    buffer_load_dwordx4 a[176:179], v1, s[12:15], s27 offen offset:2048
    v_and_b32 v63, 0xffff0000, v77
    v_add_f32 v130, v130, v62
    v_mfma_f32_16x16x32_bf16 v[192:195], a[16:19], a[140:143], v[192:195]
    v_add_f32 v131, v131, v63
    v_mfma_f32_16x16x32_bf16 v[196:199], a[20:23], a[140:143], v[196:199]
    v_cvt_pk_bf16_f32 v77, v130, v131
    v_lshlrev_b32 v64, 16, v78
    v_mfma_f32_16x16x32_bf16 v[200:203], a[24:27], a[140:143], v[200:203]
    v_and_b32 v65, 0xffff0000, v78
    v_add_f32 v132, v132, v64
    v_mfma_f32_16x16x32_bf16 v[204:207], a[28:31], a[140:143], v[204:207]
    v_add_f32 v133, v133, v65
    v_cvt_pk_bf16_f32 v78, v132, v133
    v_mfma_f32_16x16x32_bf16 v[192:195], a[32:35], a[144:147], v[192:195]
    ds_write_b128 v14, v[176:179] offset:49152
    buffer_load_dwordx4 a[180:183], v1, s[12:15], s27 offen offset:3072
    v_mfma_f32_16x16x32_bf16 v[196:199], a[36:39], a[144:147], v[196:199]
    v_lshlrev_b32 v66, 16, v79
    v_and_b32 v67, 0xffff0000, v79
    v_mfma_f32_16x16x32_bf16 v[200:203], a[40:43], a[144:147], v[200:203]
    v_add_f32 v134, v134, v66
    v_add_f32 v135, v135, v67
    v_mfma_f32_16x16x32_bf16 v[204:207], a[44:47], a[144:147], v[204:207]
    v_cvt_pk_bf16_f32 v79, v134, v135
    v_mfma_f32_16x16x32_bf16 v[192:195], a[48:51], a[148:151], v[192:195]
    buffer_store_dwordx4 v[76:79], v18, s[20:23], 0 offen offset:0 sc1
    v_lshlrev_b32 v68, 16, v80
    v_mfma_f32_16x16x32_bf16 v[196:199], a[52:55], a[148:151], v[196:199]
    buffer_load_dwordx4 a[184:187], v2, s[12:15], s27 offen offset:0
    v_and_b32 v69, 0xffff0000, v80
    v_add_f32 v152, v152, v68
    v_mfma_f32_16x16x32_bf16 v[200:203], a[56:59], a[148:151], v[200:203]
    ds_write_b128 v14, v[180:183] offset:50176
    v_mfma_f32_16x16x32_bf16 v[204:207], a[60:63], a[148:151], v[204:207]
    v_add_f32 v153, v153, v69
    v_cvt_pk_bf16_f32 v80, v152, v153
    s_waitcnt vmcnt(6)
    v_mfma_f32_16x16x32_bf16 v[192:195], a[64:67], a[152:155], v[192:195]
    v_lshlrev_b32 v70, 16, v81
    v_and_b32 v71, 0xffff0000, v81
    v_mfma_f32_16x16x32_bf16 v[196:199], a[68:71], a[152:155], v[196:199]
    v_add_f32 v154, v154, v70
    v_add_f32 v155, v155, v71
    v_mfma_f32_16x16x32_bf16 v[200:203], a[72:75], a[152:155], v[200:203]
    buffer_load_dwordx4 a[188:191], v2, s[12:15], s27 offen offset:1024
    v_cvt_pk_bf16_f32 v81, v154, v155
    v_mfma_f32_16x16x32_bf16 v[204:207], a[76:79], a[152:155], v[204:207]
    v_lshlrev_b32 v72, 16, v82
    v_and_b32 v73, 0xffff0000, v82
    v_mfma_f32_16x16x32_bf16 v[192:195], a[80:83], a[156:159], v[192:195]
    ds_write_b128 v15, v[184:187] offset:49152
    v_mfma_f32_16x16x32_bf16 v[196:199], a[84:87], a[156:159], v[196:199]
    v_add_f32 v156, v156, v72
    v_add_f32 v157, v157, v73
    v_mfma_f32_16x16x32_bf16 v[200:203], a[88:91], a[156:159], v[200:203]
    v_cvt_pk_bf16_f32 v82, v156, v157
    v_lshlrev_b32 v74, 16, v83
    v_mfma_f32_16x16x32_bf16 v[204:207], a[92:95], a[156:159], v[204:207]
    buffer_load_dwordx4 a[192:195], v2, s[12:15], s27 offen offset:2048
    v_and_b32 v75, 0xffff0000, v83
    v_add_f32 v158, v158, v74
    v_mfma_f32_16x16x32_bf16 v[192:195], a[96:99], a[160:163], v[192:195]
    v_add_f32 v159, v159, v75
    v_cvt_pk_bf16_f32 v83, v158, v159
    v_mfma_f32_16x16x32_bf16 v[196:199], a[100:103], a[160:163], v[196:199]
    buffer_load_dwordx4 a[196:199], v2, s[12:15], s27 offen offset:3072
    s_add_u32 s27, s27, 0x10000
    buffer_store_dwordx4 v[80:83], v18, s[20:23], 0 offen offset:1024 sc1
    v_mfma_f32_16x16x32_bf16 v[200:203], a[104:107], a[160:163], v[200:203]
    ds_write_b128 v15, v[188:191] offset:50176
    v_mfma_f32_16x16x32_bf16 v[204:207], a[108:111], a[160:163], v[204:207]
    buffer_load_dwordx4 a[200:203], v1, s[12:15], s27 offen offset:0
    v_mfma_f32_16x16x32_bf16 v[192:195], a[112:115], a[164:167], v[192:195]
    v_mfma_f32_16x16x32_bf16 v[196:199], a[116:119], a[164:167], v[196:199]
    buffer_load_dwordx4 a[204:207], v1, s[12:15], s27 offen offset:1024
    v_mfma_f32_16x16x32_bf16 v[200:203], a[120:123], a[164:167], v[200:203]
    v_mfma_f32_16x16x32_bf16 v[204:207], a[124:127], a[164:167], v[204:207]
    buffer_load_dwordx4 a[208:211], v1, s[12:15], s27 offen offset:2048
    s_waitcnt lgkmcnt(0)
    s_barrier
    s_waitcnt vmcnt(9)
    v_mfma_f32_16x16x32_bf16 v[208:211], a[0:3], a[168:171], v[208:211]
    ds_read_b128 v[160:163], v16 offset:32768
    ds_read_b128 v[168:171], v16 offset:36864
    v_mfma_f32_16x16x32_bf16 v[212:215], a[4:7], a[168:171], v[212:215]
    buffer_load_dwordx4 a[212:215], v1, s[12:15], s27 offen offset:3072
    ds_read_b128 v[176:179], v16 offset:40960
    ds_read_b128 v[184:187], v16 offset:45056
    v_mfma_f32_16x16x32_bf16 v[216:219], a[8:11], a[168:171], v[216:219]
    ds_read_b128 v[164:167], v16 offset:33792
    ds_read_b128 v[172:175], v16 offset:37888
    v_mfma_f32_16x16x32_bf16 v[220:223], a[12:15], a[168:171], v[220:223]
    buffer_load_dwordx4 a[216:219], v2, s[12:15], s27 offen offset:0
    ds_read_b128 v[180:183], v16 offset:41984
    ds_read_b128 v[188:191], v16 offset:46080
    v_mfma_f32_16x16x32_bf16 v[208:211], a[16:19], a[172:175], v[208:211]
    v_mfma_f32_16x16x32_bf16 v[212:215], a[20:23], a[172:175], v[212:215]
    buffer_load_dwordx4 a[220:223], v2, s[12:15], s27 offen offset:1024
    v_mfma_f32_16x16x32_bf16 v[216:219], a[24:27], a[172:175], v[216:219]
    v_mfma_f32_16x16x32_bf16 v[220:223], a[28:31], a[172:175], v[220:223]
    buffer_load_dwordx4 a[224:227], v2, s[12:15], s27 offen offset:2048
    v_mfma_f32_16x16x32_bf16 v[208:211], a[32:35], a[176:179], v[208:211]
    ds_write_b128 v124, v[192:195] offset:0
    v_mfma_f32_16x16x32_bf16 v[212:215], a[36:39], a[176:179], v[212:215]
    buffer_load_dwordx4 a[228:231], v2, s[12:15], s27 offen offset:3072
    s_add_u32 s27, s27, 0x10000
    v_mfma_f32_16x16x32_bf16 v[216:219], a[40:43], a[176:179], v[216:219]
    s_waitcnt lgkmcnt(5)
    v_fmac_f32 v160, 0.5, v168
    v_mfma_f32_16x16x32_bf16 v[220:223], a[44:47], a[176:179], v[220:223]
    buffer_load_dwordx4 a[232:235], v1, s[12:15], s27 offen offset:0
    v_fma_f32 v184, v168, 0.5, -v184
    v_fmac_f32 v160, 0.5, v176
    v_mfma_f32_16x16x32_bf16 v[208:211], a[48:51], a[180:183], v[208:211]
    v_fmac_f32 v184, -0.5, v176
    v_fmac_f32 v161, 0.5, v169
    v_mfma_f32_16x16x32_bf16 v[212:215], a[52:55], a[180:183], v[212:215]
    buffer_load_dwordx4 a[236:239], v1, s[12:15], s27 offen offset:1024
    v_fma_f32 v185, v169, 0.5, -v185
    v_fmac_f32 v161, 0.5, v177
    v_mfma_f32_16x16x32_bf16 v[216:219], a[56:59], a[180:183], v[216:219]
    ds_write_b128 v124, v[196:199] offset:1024
    v_mfma_f32_16x16x32_bf16 v[220:223], a[60:63], a[180:183], v[220:223]
    buffer_load_dwordx4 a[240:243], v1, s[12:15], s27 offen offset:2048
    v_fmac_f32 v185, -0.5, v177
    v_fmac_f32 v162, 0.5, v170
    s_waitcnt vmcnt(12)
    v_mfma_f32_16x16x32_bf16 v[208:211], a[64:67], a[184:187], v[208:211]
    v_fma_f32 v186, v170, 0.5, -v186
    v_mfma_f32_16x16x32_bf16 v[212:215], a[68:71], a[184:187], v[212:215]
    buffer_load_dwordx4 a[244:247], v1, s[12:15], s27 offen offset:3072
    v_fmac_f32 v162, 0.5, v178
    v_fmac_f32 v186, -0.5, v178
    v_mfma_f32_16x16x32_bf16 v[216:219], a[72:75], a[184:187], v[216:219]
    v_fmac_f32 v163, 0.5, v171
    v_fma_f32 v187, v171, 0.5, -v187
    v_mfma_f32_16x16x32_bf16 v[220:223], a[76:79], a[184:187], v[220:223]
    buffer_load_dwordx4 a[248:251], v2, s[12:15], s27 offen offset:0
    v_fmac_f32 v163, 0.5, v179
    v_fmac_f32 v187, -0.5, v179
    v_mfma_f32_16x16x32_bf16 v[208:211], a[80:83], a[188:191], v[208:211]
    ds_write_b128 v125, v[200:203] offset:0
    v_mfma_f32_16x16x32_bf16 v[212:215], a[84:87], a[188:191], v[212:215]
    buffer_load_dwordx4 a[252:255], v2, s[12:15], s27 offen offset:1024
    s_waitcnt lgkmcnt(3)
    v_fmac_f32 v164, 0.5, v172
    v_mfma_f32_16x16x32_bf16 v[216:219], a[88:91], a[188:191], v[216:219]
    v_fma_f32 v188, v172, 0.5, -v188
    v_fmac_f32 v164, 0.5, v180
    v_mfma_f32_16x16x32_bf16 v[220:223], a[92:95], a[188:191], v[220:223]
    buffer_load_dwordx4 v[20:23], v2, s[12:15], s27 offen offset:2048
    v_fmac_f32 v188, -0.5, v180
    v_mfma_f32_16x16x32_bf16 v[208:211], a[96:99], a[192:195], v[208:211]
    v_fmac_f32 v165, 0.5, v173
    v_fma_f32 v189, v173, 0.5, -v189
    v_mfma_f32_16x16x32_bf16 v[212:215], a[100:103], a[192:195], v[212:215]
    buffer_load_dwordx4 v[24:27], v2, s[12:15], s27 offen offset:3072
    s_add_u32 s27, s27, 0x10000
    v_fmac_f32 v165, 0.5, v181
    v_fmac_f32 v189, -0.5, v181
    v_mfma_f32_16x16x32_bf16 v[216:219], a[104:107], a[192:195], v[216:219]
    ds_write_b128 v125, v[204:207] offset:1024
    v_mfma_f32_16x16x32_bf16 v[220:223], a[108:111], a[192:195], v[220:223]
    v_fmac_f32 v166, 0.5, v174
    v_fma_f32 v190, v174, 0.5, -v190
    v_mfma_f32_16x16x32_bf16 v[208:211], a[112:115], a[196:199], v[208:211]
    v_fmac_f32 v166, 0.5, v182
    v_fmac_f32 v190, -0.5, v182
    v_mfma_f32_16x16x32_bf16 v[212:215], a[116:119], a[196:199], v[212:215]
    v_fmac_f32 v167, 0.5, v175
    v_fma_f32 v191, v175, 0.5, -v191
    v_mfma_f32_16x16x32_bf16 v[216:219], a[120:123], a[196:199], v[216:219]
    v_fmac_f32 v167, 0.5, v183
    v_mfma_f32_16x16x32_bf16 v[220:223], a[124:127], a[196:199], v[220:223]
    v_fmac_f32 v191, -0.5, v183
    s_waitcnt vmcnt(12)
    v_mfma_f32_16x16x32_bf16 v[224:227], a[0:3], a[200:203], v[224:227]
    v_lshlrev_b32 v60, 16, v84
    v_and_b32 v61, 0xffff0000, v84
    v_mfma_f32_16x16x32_bf16 v[228:231], a[4:7], a[200:203], v[228:231]
    v_add_f32 v160, v160, v60
    v_add_f32 v161, v161, v61
    v_mfma_f32_16x16x32_bf16 v[232:235], a[8:11], a[200:203], v[232:235]
    v_cvt_pk_bf16_f32 v84, v160, v161
    v_lshlrev_b32 v62, 16, v85
    v_mfma_f32_16x16x32_bf16 v[236:239], a[12:15], a[200:203], v[236:239]
    v_and_b32 v63, 0xffff0000, v85
    v_add_f32 v162, v162, v62
    v_mfma_f32_16x16x32_bf16 v[224:227], a[16:19], a[204:207], v[224:227]
    v_add_f32 v163, v163, v63
    v_mfma_f32_16x16x32_bf16 v[228:231], a[20:23], a[204:207], v[228:231]
    v_cvt_pk_bf16_f32 v85, v162, v163
    v_lshlrev_b32 v64, 16, v86
    v_mfma_f32_16x16x32_bf16 v[232:235], a[24:27], a[204:207], v[232:235]
    v_and_b32 v65, 0xffff0000, v86
    v_add_f32 v164, v164, v64
    v_mfma_f32_16x16x32_bf16 v[236:239], a[28:31], a[204:207], v[236:239]
    v_add_f32 v165, v165, v65
    v_cvt_pk_bf16_f32 v86, v164, v165
    v_mfma_f32_16x16x32_bf16 v[224:227], a[32:35], a[208:211], v[224:227]
    ds_write_b128 v124, v[208:211] offset:16384
    v_mfma_f32_16x16x32_bf16 v[228:231], a[36:39], a[208:211], v[228:231]
    v_lshlrev_b32 v66, 16, v87
    v_and_b32 v67, 0xffff0000, v87
    v_mfma_f32_16x16x32_bf16 v[232:235], a[40:43], a[208:211], v[232:235]
    v_add_f32 v166, v166, v66
    v_add_f32 v167, v167, v67
    v_mfma_f32_16x16x32_bf16 v[236:239], a[44:47], a[208:211], v[236:239]
    v_cvt_pk_bf16_f32 v87, v166, v167
    v_mfma_f32_16x16x32_bf16 v[224:227], a[48:51], a[212:215], v[224:227]
    buffer_store_dwordx4 v[84:87], v18, s[20:23], s48 offen offset:0 sc1
    v_lshlrev_b32 v68, 16, v88
    v_mfma_f32_16x16x32_bf16 v[228:231], a[52:55], a[212:215], v[228:231]
    v_and_b32 v69, 0xffff0000, v88
    v_add_f32 v184, v184, v68
    v_mfma_f32_16x16x32_bf16 v[232:235], a[56:59], a[212:215], v[232:235]
    ds_write_b128 v124, v[212:215] offset:17408
    v_mfma_f32_16x16x32_bf16 v[236:239], a[60:63], a[212:215], v[236:239]
    v_add_f32 v185, v185, v69
    v_cvt_pk_bf16_f32 v88, v184, v185
    s_waitcnt vmcnt(9)
    v_mfma_f32_16x16x32_bf16 v[224:227], a[64:67], a[216:219], v[224:227]
    v_lshlrev_b32 v70, 16, v89
    v_and_b32 v71, 0xffff0000, v89
    v_mfma_f32_16x16x32_bf16 v[228:231], a[68:71], a[216:219], v[228:231]
    v_add_f32 v186, v186, v70
    v_add_f32 v187, v187, v71
    v_mfma_f32_16x16x32_bf16 v[232:235], a[72:75], a[216:219], v[232:235]
    v_cvt_pk_bf16_f32 v89, v186, v187
    v_mfma_f32_16x16x32_bf16 v[236:239], a[76:79], a[216:219], v[236:239]
    v_lshlrev_b32 v72, 16, v90
    v_and_b32 v73, 0xffff0000, v90
    v_mfma_f32_16x16x32_bf16 v[224:227], a[80:83], a[220:223], v[224:227]
    ds_write_b128 v125, v[216:219] offset:16384
    v_mfma_f32_16x16x32_bf16 v[228:231], a[84:87], a[220:223], v[228:231]
    v_add_f32 v188, v188, v72
    v_add_f32 v189, v189, v73
    v_mfma_f32_16x16x32_bf16 v[232:235], a[88:91], a[220:223], v[232:235]
    v_cvt_pk_bf16_f32 v90, v188, v189
    v_lshlrev_b32 v74, 16, v91
    v_mfma_f32_16x16x32_bf16 v[236:239], a[92:95], a[220:223], v[236:239]
    v_and_b32 v75, 0xffff0000, v91
    v_add_f32 v190, v190, v74
    v_mfma_f32_16x16x32_bf16 v[224:227], a[96:99], a[224:227], v[224:227]
    v_add_f32 v191, v191, v75
    v_cvt_pk_bf16_f32 v91, v190, v191
    v_mfma_f32_16x16x32_bf16 v[228:231], a[100:103], a[224:227], v[228:231]
    buffer_store_dwordx4 v[88:91], v18, s[20:23], s48 offen offset:1024 sc1
    v_mfma_f32_16x16x32_bf16 v[232:235], a[104:107], a[224:227], v[232:235]
    ds_write_b128 v125, v[220:223] offset:17408
    v_mfma_f32_16x16x32_bf16 v[236:239], a[108:111], a[224:227], v[236:239]
    v_mfma_f32_16x16x32_bf16 v[224:227], a[112:115], a[228:231], v[224:227]
    v_mfma_f32_16x16x32_bf16 v[228:231], a[116:119], a[228:231], v[228:231]
    v_mfma_f32_16x16x32_bf16 v[232:235], a[120:123], a[228:231], v[232:235]
    v_mfma_f32_16x16x32_bf16 v[236:239], a[124:127], a[228:231], v[236:239]
    s_waitcnt lgkmcnt(0)
    s_barrier
    s_waitcnt vmcnt(6)
    v_mfma_f32_16x16x32_bf16 v[240:243], a[0:3], a[232:235], v[240:243]
    ds_read_b128 v[192:195], v17 offset:0
    ds_read_b128 v[200:203], v17 offset:4096
    v_mfma_f32_16x16x32_bf16 v[244:247], a[4:7], a[232:235], v[244:247]
    ds_read_b128 v[208:211], v17 offset:8192
    ds_read_b128 v[216:219], v17 offset:12288
    v_mfma_f32_16x16x32_bf16 v[248:251], a[8:11], a[232:235], v[248:251]
    ds_read_b128 v[196:199], v17 offset:1024
    ds_read_b128 v[204:207], v17 offset:5120
    v_mfma_f32_16x16x32_bf16 v[252:255], a[12:15], a[232:235], v[252:255]
    ds_read_b128 v[212:215], v17 offset:9216
    ds_read_b128 v[220:223], v17 offset:13312
    v_mfma_f32_16x16x32_bf16 v[240:243], a[16:19], a[236:239], v[240:243]
    v_mfma_f32_16x16x32_bf16 v[244:247], a[20:23], a[236:239], v[244:247]
    v_mfma_f32_16x16x32_bf16 v[248:251], a[24:27], a[236:239], v[248:251]
    v_mfma_f32_16x16x32_bf16 v[252:255], a[28:31], a[236:239], v[252:255]
    v_mfma_f32_16x16x32_bf16 v[240:243], a[32:35], a[240:243], v[240:243]
    ds_write_b128 v124, v[224:227] offset:32768
    v_mfma_f32_16x16x32_bf16 v[244:247], a[36:39], a[240:243], v[244:247]
    v_mfma_f32_16x16x32_bf16 v[248:251], a[40:43], a[240:243], v[248:251]
    s_waitcnt lgkmcnt(5)
    v_fmac_f32 v192, 0.5, v200
    v_fma_f32 v216, v200, 0.5, -v216
    v_fmac_f32 v192, 0.5, v208
    v_mfma_f32_16x16x32_bf16 v[252:255], a[44:47], a[240:243], v[252:255]
    v_fmac_f32 v216, -0.5, v208
    v_fmac_f32 v193, 0.5, v201
    v_fma_f32 v217, v201, 0.5, -v217
    v_mfma_f32_16x16x32_bf16 v[240:243], a[48:51], a[244:247], v[240:243]
    v_fmac_f32 v193, 0.5, v209
    v_fmac_f32 v217, -0.5, v209
    v_fmac_f32 v194, 0.5, v202
    v_fma_f32 v218, v202, 0.5, -v218
    v_mfma_f32_16x16x32_bf16 v[244:247], a[52:55], a[244:247], v[244:247]
    v_fmac_f32 v194, 0.5, v210
    v_fmac_f32 v218, -0.5, v210
    v_fmac_f32 v195, 0.5, v203
    v_mfma_f32_16x16x32_bf16 v[248:251], a[56:59], a[244:247], v[248:251]
    ds_write_b128 v124, v[228:231] offset:33792
    v_mfma_f32_16x16x32_bf16 v[252:255], a[60:63], a[244:247], v[252:255]
    v_fma_f32 v219, v203, 0.5, -v219
    v_fmac_f32 v195, 0.5, v211
    v_fmac_f32 v219, -0.5, v211
    s_waitcnt vmcnt(2)
    v_mfma_f32_16x16x32_bf16 v[240:243], a[64:67], a[248:251], v[240:243]
    s_waitcnt lgkmcnt(2)
    v_fmac_f32 v196, 0.5, v204
    v_fma_f32 v220, v204, 0.5, -v220
    v_fmac_f32 v196, 0.5, v212
    v_mfma_f32_16x16x32_bf16 v[244:247], a[68:71], a[248:251], v[244:247]
    v_fmac_f32 v220, -0.5, v212
    v_fmac_f32 v197, 0.5, v205
    v_fma_f32 v221, v205, 0.5, -v221
    v_mfma_f32_16x16x32_bf16 v[248:251], a[72:75], a[248:251], v[248:251]
    v_fmac_f32 v197, 0.5, v213
    v_fmac_f32 v221, -0.5, v213
    v_fmac_f32 v198, 0.5, v206
    v_mfma_f32_16x16x32_bf16 v[252:255], a[76:79], a[248:251], v[252:255]
    v_fma_f32 v222, v206, 0.5, -v222
    v_fmac_f32 v198, 0.5, v214
    v_fmac_f32 v222, -0.5, v214
    v_fmac_f32 v199, 0.5, v207
    v_mfma_f32_16x16x32_bf16 v[240:243], a[80:83], a[252:255], v[240:243]
    ds_write_b128 v125, v[232:235] offset:32768
    v_mfma_f32_16x16x32_bf16 v[244:247], a[84:87], a[252:255], v[244:247]
    v_fma_f32 v223, v207, 0.5, -v223
    v_fmac_f32 v199, 0.5, v215
    v_fmac_f32 v223, -0.5, v215
    v_mfma_f32_16x16x32_bf16 v[248:251], a[88:91], a[252:255], v[248:251]
    v_lshlrev_b32 v60, 16, v92
    v_and_b32 v61, 0xffff0000, v92
    v_add_f32 v192, v192, v60
    v_mfma_f32_16x16x32_bf16 v[252:255], a[92:95], a[252:255], v[252:255]
    v_add_f32 v193, v193, v61
    v_cvt_pk_bf16_f32 v92, v192, v193
    v_lshlrev_b32 v62, 16, v93
    v_mfma_f32_16x16x32_bf16 v[240:243], a[96:99], v[20:23], v[240:243]
    v_and_b32 v63, 0xffff0000, v93
    v_add_f32 v194, v194, v62
    v_add_f32 v195, v195, v63
    v_mfma_f32_16x16x32_bf16 v[244:247], a[100:103], v[20:23], v[244:247]
    v_cvt_pk_bf16_f32 v93, v194, v195
    v_lshlrev_b32 v64, 16, v94
    v_and_b32 v65, 0xffff0000, v94
    v_add_f32 v196, v196, v64
    v_mfma_f32_16x16x32_bf16 v[248:251], a[104:107], v[20:23], v[248:251]
    ds_write_b128 v125, v[236:239] offset:33792
    v_mfma_f32_16x16x32_bf16 v[252:255], a[108:111], v[20:23], v[252:255]
    v_add_f32 v197, v197, v65
    v_cvt_pk_bf16_f32 v94, v196, v197
    v_lshlrev_b32 v66, 16, v95
    v_mfma_f32_16x16x32_bf16 v[240:243], a[112:115], v[24:27], v[240:243]
    v_and_b32 v67, 0xffff0000, v95
    v_add_f32 v198, v198, v66
    v_add_f32 v199, v199, v67
    v_mfma_f32_16x16x32_bf16 v[244:247], a[116:119], v[24:27], v[244:247]
    v_cvt_pk_bf16_f32 v95, v198, v199
    buffer_store_dwordx4 v[92:95], v18, s[20:23], s49 offen offset:0 sc1
    v_lshlrev_b32 v68, 16, v96
    v_and_b32 v69, 0xffff0000, v96
    v_mfma_f32_16x16x32_bf16 v[248:251], a[120:123], v[24:27], v[248:251]
    v_add_f32 v216, v216, v68
    v_add_f32 v217, v217, v69
    v_cvt_pk_bf16_f32 v96, v216, v217
    v_mfma_f32_16x16x32_bf16 v[252:255], a[124:127], v[24:27], v[252:255]
    v_lshlrev_b32 v70, 16, v97
    v_and_b32 v71, 0xffff0000, v97
    v_add_f32 v218, v218, v70
    v_add_f32 v219, v219, v71
    v_cvt_pk_bf16_f32 v97, v218, v219
    v_lshlrev_b32 v72, 16, v98
    v_and_b32 v73, 0xffff0000, v98
    v_add_f32 v220, v220, v72
    v_add_f32 v221, v221, v73
    v_cvt_pk_bf16_f32 v98, v220, v221
    v_lshlrev_b32 v74, 16, v99
    v_and_b32 v75, 0xffff0000, v99
    v_add_f32 v222, v222, v74
    ds_write_b128 v124, v[240:243] offset:49152
    ds_write_b128 v124, v[244:247] offset:50176
    ds_write_b128 v125, v[248:251] offset:49152
    ds_write_b128 v125, v[252:255] offset:50176
    v_add_f32 v223, v223, v75
    v_cvt_pk_bf16_f32 v99, v222, v223
    buffer_store_dwordx4 v[96:99], v18, s[20:23], s49 offen offset:1024 sc1
    s_waitcnt lgkmcnt(0)
    s_barrier
    ds_read_b128 v[224:227], v17 offset:32768
    ds_read_b128 v[232:235], v17 offset:36864
    ds_read_b128 v[240:243], v17 offset:40960
    ds_read_b128 v[248:251], v17 offset:45056
    ds_read_b128 v[228:231], v17 offset:33792
    ds_read_b128 v[236:239], v17 offset:37888
    ds_read_b128 v[244:247], v17 offset:41984
    ds_read_b128 v[252:255], v17 offset:46080
    s_waitcnt lgkmcnt(4)
    v_pk_fma_f32 v[224:225], v[232:233], 0.5, v[224:225] op_sel_hi:[1,0,1]
    v_pk_fma_f32 v[248:249], v[232:233], 0.5, v[248:249] op_sel_hi:[1,0,1] neg_lo:[0,0,1] neg_hi:[0,0,1]
    v_pk_fma_f32 v[224:225], v[240:241], 0.5, v[224:225] op_sel_hi:[1,0,1]
    v_pk_fma_f32 v[248:249], v[240:241], -0.5, v[248:249] op_sel_hi:[1,0,1]
    v_pk_fma_f32 v[226:227], v[234:235], 0.5, v[226:227] op_sel_hi:[1,0,1]
    v_pk_fma_f32 v[250:251], v[234:235], 0.5, v[250:251] op_sel_hi:[1,0,1] neg_lo:[0,0,1] neg_hi:[0,0,1]
    v_pk_fma_f32 v[226:227], v[242:243], 0.5, v[226:227] op_sel_hi:[1,0,1]
    v_pk_fma_f32 v[250:251], v[242:243], -0.5, v[250:251] op_sel_hi:[1,0,1]
    s_waitcnt lgkmcnt(0)
    v_pk_fma_f32 v[228:229], v[236:237], 0.5, v[228:229] op_sel_hi:[1,0,1]
    v_pk_fma_f32 v[252:253], v[236:237], 0.5, v[252:253] op_sel_hi:[1,0,1] neg_lo:[0,0,1] neg_hi:[0,0,1]
    v_pk_fma_f32 v[228:229], v[244:245], 0.5, v[228:229] op_sel_hi:[1,0,1]
    v_pk_fma_f32 v[252:253], v[244:245], -0.5, v[252:253] op_sel_hi:[1,0,1]
    v_pk_fma_f32 v[230:231], v[238:239], 0.5, v[230:231] op_sel_hi:[1,0,1]
    v_pk_fma_f32 v[254:255], v[238:239], 0.5, v[254:255] op_sel_hi:[1,0,1] neg_lo:[0,0,1] neg_hi:[0,0,1]
    v_pk_fma_f32 v[230:231], v[246:247], 0.5, v[230:231] op_sel_hi:[1,0,1]
    v_pk_fma_f32 v[254:255], v[246:247], -0.5, v[254:255] op_sel_hi:[1,0,1]
    v_lshlrev_b32 v60, 16, v100
    v_and_b32 v61, 0xffff0000, v100
    v_pk_add_f32 v[224:225], v[224:225], v[60:61]
    v_cvt_pk_bf16_f32 v100, v224, v225
    v_lshlrev_b32 v62, 16, v101
    v_and_b32 v63, 0xffff0000, v101
    v_pk_add_f32 v[226:227], v[226:227], v[62:63]
    v_cvt_pk_bf16_f32 v101, v226, v227
    v_lshlrev_b32 v64, 16, v102
    v_and_b32 v65, 0xffff0000, v102
    v_pk_add_f32 v[228:229], v[228:229], v[64:65]
    v_cvt_pk_bf16_f32 v102, v228, v229
    v_lshlrev_b32 v66, 16, v103
    v_and_b32 v67, 0xffff0000, v103
    v_pk_add_f32 v[230:231], v[230:231], v[66:67]
    v_cvt_pk_bf16_f32 v103, v230, v231
    buffer_store_dwordx4 v[100:103], v18, s[20:23], s50 offen offset:0 sc1
    v_lshlrev_b32 v68, 16, v104
    v_and_b32 v69, 0xffff0000, v104
    v_pk_add_f32 v[248:249], v[248:249], v[68:69]
    v_cvt_pk_bf16_f32 v104, v248, v249
    v_lshlrev_b32 v70, 16, v105
    v_and_b32 v71, 0xffff0000, v105
    v_pk_add_f32 v[250:251], v[250:251], v[70:71]
    v_cvt_pk_bf16_f32 v105, v250, v251
    v_lshlrev_b32 v72, 16, v106
    v_and_b32 v73, 0xffff0000, v106
    v_pk_add_f32 v[252:253], v[252:253], v[72:73]
    v_cvt_pk_bf16_f32 v106, v252, v253
    v_lshlrev_b32 v74, 16, v107
    v_and_b32 v75, 0xffff0000, v107
    v_pk_add_f32 v[254:255], v[254:255], v[74:75]
    v_cvt_pk_bf16_f32 v107, v254, v255
    buffer_store_dwordx4 v[104:107], v18, s[20:23], s50 offen offset:1024 sc1
    s_endpgm
L2_end:
    s_endpgm
.section .rodata,"a"
.p2align 6
.amdhsa_kernel cn_prep_kernel
  .amdhsa_next_free_vgpr 256
  .amdhsa_next_free_sgpr 102
  .amdhsa_accum_offset 224
  .amdhsa_group_segment_fixed_size 0
  .amdhsa_kernarg_size 72
  .amdhsa_user_sgpr_count 2
  .amdhsa_user_sgpr_kernarg_segment_ptr 1
  .amdhsa_system_sgpr_workgroup_id_x 1
  .amdhsa_float_denorm_mode_32 3
.end_amdhsa_kernel
.section .rodata,"a"
.p2align 6
.amdhsa_kernel cn_conv_kernel
  .amdhsa_next_free_vgpr 512
  .amdhsa_next_free_sgpr 102
  .amdhsa_accum_offset 256
  .amdhsa_group_segment_fixed_size 0
  .amdhsa_kernarg_size 72
  .amdhsa_user_sgpr_count 2
  .amdhsa_user_sgpr_kernarg_segment_ptr 1
  .amdhsa_system_sgpr_workgroup_id_x 1
  .amdhsa_float_denorm_mode_32 3
.end_amdhsa_kernel
```
